```python
import torch

def _softmax(x, axis=-1):
    return torch.softmax(x, dim=axis)

def _gelu(x):
    return torch.nn.functional.gelu(x, approximate='tanh')

def _silu(x):
    return torch.nn.functional.silu(x)

def _sigmoid(x):
    return torch.sigmoid(x)

def _layernorm(x, axis=-1, eps=1e-05):
    m = x.mean(dim=axis, keepdim=True)
    v = x.var(dim=axis, keepdim=True, unbiased=False)
    return (x - m) / torch.sqrt(v + eps)

def _scatter_add(tgt, idx, src, axis=0):
    return tgt.clone().index_add_(axis, idx, src)

def _segment_sum(src, seg, n):
    out = torch.zeros((n,) + src.shape[1:], dtype=src.dtype)
    return out.index_add_(0, seg, src)

def _pad(x, pw):
    flat = tuple((v for pair in reversed(pw) for v in pair))
    return torch.nn.functional.pad(x, flat)
kernel_name = 'standalone__memory_aug_recurrent_mem_tr__prompt'

def setup_inputs():

    _w = lambda a: (lambda t: t.to(torch.bfloat16) if t.is_floating_point() else t)(torch.as_tensor(a))
    B, S, Dm = (1, 2048, 640)
    H, Dh = (32, 128)
    M, seg = (8, 32)
    seg = min(seg, S)
    S = S // seg * seg
    return {'x': _w((lambda *s: torch.randn(*s, dtype=torch.bfloat16) * 0.05)(B, S, Dm)), 'mem0': _w((lambda *s: torch.randn(*s, dtype=torch.bfloat16) * 0.4)(B, M, Dm)), 'Wq': _w((lambda *s: torch.randn(*s, dtype=torch.bfloat16) * 6.4)(Dm, H, Dh) * Dm ** (-0.5)), 'Wk': _w((lambda *s: torch.randn(*s, dtype=torch.bfloat16) * 6.4)(Dm, H, Dh) * Dm ** (-0.5)), 'Wv': _w((lambda *s: torch.randn(*s, dtype=torch.bfloat16) * 0.4)(Dm, H, Dh) * Dm ** (-0.5)), 'Wo': _w((lambda *s: torch.randn(*s, dtype=torch.bfloat16) * 0.4)(H, Dh, Dm) * (H * Dh) ** (-0.5)), 'seg_len': seg}

def reference(x, mem0, Wq, Wk, Wv, Wo, seg_len):
    B, S, Dm = x.shape
    H, Dh = (Wq.shape[1], Wq.shape[2])
    M = mem0.shape[1]
    scale = Dh ** (-0.5)
    n_seg = S // seg_len
    L = M + seg_len
    idx = torch.arange(L)
    mask = (idx[:, None] < M) | (idx[:, None] >= idx[None, :])
    mem = mem0
    outs = []
    for s in range(n_seg):
        xs = x[:, s * seg_len:(s + 1) * seg_len, :].clone()
        h = torch.concatenate([mem, xs], axis=1)
        q = torch.einsum('btd,dhe->bhte', h, Wq)
        k = torch.einsum('btd,dhe->bhte', h, Wk)
        v = torch.einsum('btd,dhe->bhte', h, Wv)
        scores = torch.einsum('bhqe,bhke->bhqk', q, k) * scale
        scores = torch.where(mask[None, None], scores, -1000000000.0)
        p = _softmax(scores, axis=-1)
        o = torch.einsum('bhqk,bhke->bhqe', p, v)
        o = torch.einsum('bhte,hed->btd', o, Wo)
        mem = o[:, :M, :].clone()
        outs.append(o[:, M:, :])
    return torch.concatenate(outs, axis=1)
```

```asm
; @launch grid=(256,1,1) block=(256,1,1) lds=163840
.amdgcn_target "amdgcn-amd-amdhsa--gfx950"
.text
.globl standalone__memory_aug_recurrent_mem_tr__prompt_kernel
.p2align 8
.type standalone__memory_aug_recurrent_mem_tr__prompt_kernel,@function
standalone__memory_aug_recurrent_mem_tr__prompt_kernel:
  s_cmp_ge_u32 s2, 256
  s_cbranch_scc1 L_end
  s_load_dwordx2 s[16:17], s[0:1], 64
  s_load_dwordx2 s[4:5], s[0:1], 72
  s_getreg_b32 s18, hwreg(HW_REG_XCC_ID)
  s_and_b32 s18, s18, 7
  v_lshrrev_b32 v1, 6, v0
  s_nop 0
  v_readfirstlane_b32 s20, v1
  v_mov_b32 v5, 0
  s_lshl_b32 s23, s18, 2
  s_add_u32 s62, s23, 160
  s_cmp_lt_u32 s18, 2
  s_cselect_b32 s23, s23, s62
  v_mov_b32 v1, s23
  v_mov_b32 v2, 1
  s_waitcnt lgkmcnt(0)
  s_cmp_lg_u32 s20, 0
  s_cbranch_scc1 L_el_done
  s_mov_b64 exec, 1
  global_atomic_add v3, v1, v2, s[16:17] sc0 sc1
  s_waitcnt vmcnt(0)
  ds_write_b32 v5, v3
  s_waitcnt lgkmcnt(0)
  s_mov_b64 exec, -1
L_el_done:
  s_and_b32 s5, s5, 0xffff
  s_mov_b32 s6, 268435456
  s_mov_b32 s7, 0x00020000
  s_barrier
  ds_read_b32 v2, v5
  s_waitcnt lgkmcnt(0)
  v_readfirstlane_b32 s25, v2
  s_barrier
  s_min_u32 s25, s25, 255
  s_and_b32 s24, s18, 1
  s_mov_b32 s64, 1
  s_cmp_lt_u32 s18, 2
  s_cselect_b32 s63, 0, 0x100
  s_or_b32 s25, s25, s63
  s_cmp_ge_u32 s25, 32
  s_cbranch_scc1 L_helper
  v_and_b32 v100, 63, v0
  v_and_b32 v101, 15, v100
  v_lshrrev_b32 v102, 4, v100
  v_and_b32 v103, 7, v100
  v_bfe_u32 v104, v100, 3, 1
  v_lshlrev_b32 v0, 4, v100
  v_lshlrev_b32 v22, 2, v100
  v_lshlrev_b32 v1, 7, v102
  v_lshl_add_u32 v1, v103, 4, v1
  s_add_u32 s23, s20, 1
  s_and_b32 s23, s23, 3
  s_lshl_b32 s23, s23, 10
  v_add_u32 v180, s23, v0
  s_add_u32 s23, s20, 2
  s_and_b32 s23, s23, 3
  s_lshl_b32 s23, s23, 10
  v_add_u32 v181, s23, v0
  s_add_u32 s23, s20, 3
  s_and_b32 s23, s23, 3
  s_lshl_b32 s23, s23, 10
  v_add_u32 v182, s23, v0
  v_mov_b32 v3, 0x3F80
  v_mov_b32 v18, 0x3F800000
  v_lshlrev_b32 v183, 5, v104
  v_and_b32 v107, 1, v100
  v_lshl_add_u32 v183, v107, 4, v183
  v_bfe_u32 v107, v100, 1, 2
  v_add_u32 v183, v183, v107
  v_lshlrev_b32 v183, 2, v183
  s_movk_i32 s23, 10368
  v_mul_lo_u32 v4, v102, s23
  v_lshl_add_u32 v4, v101, 3, v4
  v_lshrrev_b32 v105, 1, v102
  v_and_b32 v106, 1, v102
  v_and_b32 v107, 3, v100
  v_lshlrev_b32 v5, 4, v107
  v_lshlrev_b32 v188, 3, v100
  v_lshl_add_u32 v5, v105, 7, v5
  v_lshl_add_u32 v5, v106, 3, v5
  s_lshl_b32 s23, s20, 10
  v_add_u32 v10, s23, v0
  v_lshrrev_b32 v11, 1, v10
  v_lshlrev_b32 v6, 8, v106
  v_lshl_add_u32 v6, v104, 7, v6
  v_lshl_add_u32 v6, v103, 4, v6
  v_lshl_add_u32 v6, v105, 3, v6
  v_mov_b32 v107, 0x8888
  v_mov_b32 v108, 0xDDDD
  v_cmp_eq_u32 vcc, 0, v104
  s_nop 1
  v_cndmask_b32 v7, v108, v107, vcc
  v_lshlrev_b32 v107, 2, v102
  v_sub_u32 v107, v101, v107
  v_mov_b32 v108, 0x3F80
  v_mov_b32 v109, 0x3F800000
  v_mov_b32 v8, 0
  v_mov_b32 v9, 0
  v_cmp_eq_u32 vcc, 0, v107
  s_nop 1
  v_cndmask_b32 v8, v8, v108, vcc
  v_cmp_eq_u32 vcc, 1, v107
  s_nop 1
  v_cndmask_b32 v8, v8, v109, vcc
  v_cmp_eq_u32 vcc, 2, v107
  s_nop 1
  v_cndmask_b32 v9, v9, v108, vcc
  v_cmp_eq_u32 vcc, 3, v107
  s_nop 1
  v_cndmask_b32 v9, v9, v109, vcc
  s_mov_b32 s56, 0x3F80
  s_mov_b32 s57, 0
  v_lshlrev_b64 v[184:185], v0, s[56:57]
  v_lshlrev_b64 v[186:187], v0, s[56:57]
  v_lshlrev_b32 v12, 4, v101
  v_lshl_add_u32 v12, v105, 8, v12
  v_lshl_add_u32 v12, v106, 3, v12
  s_lshl_b32 s23, s20, 9
  v_add_u32 v12, s23, v12
  v_lshrrev_b32 v107, 3, v100
  v_lshlrev_b32 v189, 8, v107
  v_lshl_add_u32 v189, v103, 4, v189
  v_lshlrev_b32 v107, 8, v102
  v_lshl_add_u32 v13, v103, 4, v107
  v_bfe_u32 v108, v101, 2, 1
  v_lshlrev_b32 v108, 2, v108
  v_lshl_add_u32 v108, v104, 1, v108
  v_and_b32 v109, 1, v101
  v_add3_u32 v108, v108, v109, 8
  v_lshl_add_u32 v14, v108, 4, v107
  v_lshlrev_b32 v15, 7, v105
  v_lshl_add_u32 v15, v103, 4, v15
  v_lshl_add_u32 v15, v106, 3, v15
  s_lshl_b32 s23, s20, 8
  v_add_u32 v15, s23, v15
  v_mov_b32 v179, 0
  v_mov_b32 v177, 0
  s_mov_b32 s48, 0x00FF00FF
  s_mov_b32 s49, 0x00FF00FF
  s_mov_b32 s50, 0xFF00FF00
  s_mov_b32 s51, 0xFF00FF00
  s_mov_b32 s52, 0x000F000F
  s_mov_b32 s53, 0x000F000F
  s_mov_b32 s68, 0x33333333
  s_mov_b32 s69, 0x33333333
  s_mov_b32 s58, 0x3e0293ee
  s_and_b32 s26, s25, 1
  s_lshr_b32 s19, s25, 1
  s_lshl_b32 s23, s24, 4
  s_add_u32 s19, s19, s23
  s_lshl_b32 s28, s19, 13
  s_lshl_b32 s23, s26, 12
  s_add_u32 s23, s23, 0x1000000
  s_lshl_b32 s62, s20, 12
  s_cmp_eq_u32 s20, 2
  s_cselect_b32 s23, s23, s62
  s_add_u32 s28, s28, s23
  s_lshl_b32 s30, s19, 11
  s_lshl_b32 s23, s26, 10
  s_add_u32 s30, s30, s23
  s_add_u32 s31, s30, 0x3400000
  s_add_u32 s30, s30, 0x3000000
  s_mul_i32 s32, s25, 10368
  s_mul_i32 s23, s20, 2560
  s_add_u32 s32, s32, s23
  s_mul_i32 s65, s24, 524288
  s_add_u32 s65, s65, 0x4000000
  s_add_u32 s32, s32, s65
  s_lshl_b32 s23, s20, 1
  s_lshr_b32 s62, s25, 4
  s_add_u32 s23, s23, s62
  s_cmp_le_u32 s23, 4
  s_cselect_b32 s33, 1, 0
  s_cselect_b32 s23, s23, 4
  s_sub_u32 s23, 4, s23
  s_bfe_u32 s62, s25, 0x20002
  s_bfe_u32 s63, s25, 0x10001
  s_and_b32 s64, s25, 1
  s_mul_i32 s34, s62, 5
  s_add_u32 s34, s34, s23
  s_lshl_b32 s34, s34, 9
  s_add_u32 s34, s34, s65
  s_lshl_b32 s65, s63, 8
  s_add_u32 s34, s34, s65
  s_lshl_b32 s65, s64, 7
  s_add_u32 s34, s34, s65
  s_add_u32 s35, s34, 41472
  s_add_u32 s36, s35, 41472
  s_add_u32 s37, s36, 41472
  s_add_u32 s38, s37, 41472
  s_add_u32 s39, s38, 41472
  s_add_u32 s40, s39, 41472
  s_add_u32 s41, s40, 41472
  s_lshl_b32 s42, s23, 11
  s_lshl_b32 s65, s62, 9
  s_add_u32 s42, s42, s65
  s_lshl_b32 s65, s64, 8
  s_add_u32 s42, s42, s65
  s_lshl_b32 s65, s63, 6
  s_add_u32 s42, s42, s65
  s_and_b32 s65, s42, 0x2000
  s_add_u32 s42, s42, s65
  s_lshl_b32 s65, s24, 16
  s_add_u32 s44, s65, 0x41a0000
  s_lshl_b32 s65, s24, 22
  s_sub_u32 s81, 0, s4
  s_and_b32 s81, s81, 0x1FFFFF
  s_add_u32 s81, s81, 0x4400000
  s_add_u32 s45, s65, s81
  s_xor_b32 s65, s65, 0x400000
  s_add_u32 s43, s42, s65
  s_add_u32 s43, s43, s81
  s_add_u32 s42, s42, s44
  s_mov_b32 s59, 32768
  v_and_b32 v107, 0xFFFFFF3F, v10
  v_bfe_u32 v108, v10, 6, 1
  v_lshl_add_u32 v107, v108, 7, v107
  v_bfe_u32 v108, v10, 7, 1
  v_lshl_add_u32 v2, v108, 6, v107
  v_and_b32 v107, 0xFFFFFF3F, v11
  v_bfe_u32 v108, v11, 6, 1
  v_lshl_add_u32 v107, v108, 7, v107
  v_bfe_u32 v108, v11, 7, 1
  v_lshl_add_u32 v17, v108, 6, v107
  v_mov_b32 v2, v10
  v_mov_b32 v17, v11
  v_add_u32 v16, 4096, v2
  v_add_u32 v17, 16384, v17
  s_lshl_b32 s46, s24, 5
  s_add_u32 s46, s46, s25
  s_lshl_b32 s46, s46, 11
  s_add_u32 s46, s46, 0x4120000
  s_xor_b32 s47, s46, 0x800
  s_mov_b32 s54, 0
  s_mov_b32 s55, 0
  s_mov_b32 s21, 0
  s_mov_b32 s76, 0
  s_mov_b32 s77, 0
  s_lshl_b32 s79, s19, 7
  s_lshl_b32 s23, s26, 2
  s_add_u32 s79, s79, s23
  s_add_u32 s79, s79, 0x4170000
  v_min_u32 v191, 92, v22
  v_add_u32 v191, 64, v191
  v_mov_b64 v[24:25], -1
  buffer_store_dwordx2 v[24:25], v6, s[4:7], s32 offen offset:0
  buffer_store_dwordx2 v[24:25], v6, s[4:7], s32 offen offset:512
  buffer_store_dwordx2 v[24:25], v6, s[4:7], s32 offen offset:1024
  buffer_store_dwordx2 v[24:25], v6, s[4:7], s32 offen offset:1536
  buffer_store_dwordx2 v[24:25], v6, s[4:7], s32 offen offset:2048
  buffer_store_dwordx2 v[24:25], v12, s[4:7], s46 offen
  v_mov_b32 v26, 0
  s_mov_b64 exec, 1
  s_add_u32 s72, s79, 0
  buffer_store_dword v26, v26, s[4:7], s72 offen sc1
  s_add_u32 s72, s79, 4096
  buffer_store_dword v26, v26, s[4:7], s72 offen sc1
  s_add_u32 s72, s79, 8192
  buffer_store_dword v26, v26, s[4:7], s72 offen sc1
  s_add_u32 s72, s79, 12288
  buffer_store_dword v26, v26, s[4:7], s72 offen sc1
  s_add_u32 s72, s79, 16384
  buffer_store_dword v26, v26, s[4:7], s72 offen sc1
  s_add_u32 s72, s79, 20480
  buffer_store_dword v26, v26, s[4:7], s72 offen sc1
  s_movk_i32 s80, 16384
  s_mov_b64 exec, -1
  s_lshl_b32 s72, s25, 2
  s_add_u32 s72, s72, s20
  s_bfe_u32 s73, s72, 0x10002
  s_xor_b32 s73, s73, 1
  v_mov_b32 v28, s73
  v_mov_b32 v29, s73
  v_mov_b32 v30, s73
  v_mov_b32 v31, s73
  s_lshr_b32 s73, s72, 1
  s_lshl_b32 s73, s73, 15
  s_and_b32 s72, s72, 1
  s_lshl_b32 s72, s72, 13
  s_add_u32 s72, s72, s73
  s_add_u32 s72, s72, s45
  s_add_u32 s73, s72, 0
  buffer_store_dwordx4 v[28:31], v0, s[4:7], s73 offen offset:0 sc1
  buffer_store_dwordx4 v[28:31], v0, s[4:7], s73 offen offset:1024 sc1
  buffer_store_dwordx4 v[28:31], v0, s[4:7], s73 offen offset:2048 sc1
  buffer_store_dwordx4 v[28:31], v0, s[4:7], s73 offen offset:3072 sc1
  s_add_u32 s73, s72, 4096
  buffer_store_dwordx4 v[28:31], v0, s[4:7], s73 offen offset:0 sc1
  buffer_store_dwordx4 v[28:31], v0, s[4:7], s73 offen offset:1024 sc1
  buffer_store_dwordx4 v[28:31], v0, s[4:7], s73 offen offset:2048 sc1
  buffer_store_dwordx4 v[28:31], v0, s[4:7], s73 offen offset:3072 sc1
  s_add_u32 s73, s72, 16384
  buffer_store_dwordx4 v[28:31], v0, s[4:7], s73 offen offset:0 sc1
  buffer_store_dwordx4 v[28:31], v0, s[4:7], s73 offen offset:1024 sc1
  s_cmp_eq_u32 s33, 0
  s_cbranch_scc1 L_team_noinit
  s_mov_b64 exec, s[52:53]
  s_add_u32 s72, s42, 0
  buffer_store_dwordx2 v[24:25], v5, s[4:7], s72 offen
  s_add_u32 s72, s42, 32768
  buffer_store_dwordx2 v[24:25], v5, s[4:7], s72 offen
  s_mov_b64 exec, -1
L_team_noinit:
  v_lshrrev_b32 v24, 7, v0
  v_and_b32 v25, 0x70, v0
  v_lshl_add_u32 v112, v24, 13, v25
  v_lshrrev_b32 v24, 8, v0
  v_and_b32 v25, 0xF0, v0
  s_movk_i32 s23, 1280
  v_mul_lo_u32 v113, v24, s23
  v_add_u32 v113, v113, v25
  v_lshrrev_b32 v26, 5, v25
  v_lshlrev_b32 v114, 2, v26
  v_lshrrev_b32 v26, 1, v24
  v_lshl_add_u32 v114, v26, 11, v114
  v_and_b32 v26, 1, v24
  v_lshl_add_u32 v114, v26, 9, v114
  s_lshl_b32 s23, s20, 5
  v_add_u32 v114, s23, v114
  v_mov_b32 v26, 0x05040100
  v_mov_b32 v27, 0x07060302
  v_and_b32 v116, 16, v0
  v_cmp_eq_u32 vcc, 0, v116
  s_nop 1
  v_cndmask_b32 v116, v27, v26, vcc
  s_add_u32 s23, s20, 0
  s_and_b32 s23, s23, 3
  s_lshl_b32 s23, s23, 13
  v_add_u32 v117, s23, v114
  s_add_u32 s23, s20, 1
  s_and_b32 s23, s23, 3
  s_lshl_b32 s23, s23, 13
  v_add_u32 v118, s23, v114
  s_add_u32 s23, s20, 2
  s_and_b32 s23, s23, 3
  s_lshl_b32 s23, s23, 13
  v_add_u32 v119, s23, v114
  s_add_u32 s23, s20, 3
  s_and_b32 s23, s23, 3
  s_lshl_b32 s23, s23, 13
  v_add_u32 v120, s23, v114
  v_lshrrev_b32 v25, 2, v25
  v_lshl_add_u32 v115, v24, 10, v25
  s_lshl_b32 s23, s20, 6
  v_add_u32 v115, s23, v115
  s_lshl_b32 s63, s19, 8
  s_lshl_b32 s23, s26, 7
  s_add_u32 s63, s63, s23
  s_mul_i32 s23, s20, 524288
  s_add_u32 s62, s63, s23
  s_mul_i32 s23, s20, 262144
  s_add_u32 s63, s63, s23
  s_mul_i32 s64, s19, 163840
  s_mul_i32 s23, s26, 81920
  s_add_u32 s64, s64, s23
  s_mul_i32 s23, s20, 20480
  s_add_u32 s64, s64, s23
  s_lshl_b32 s65, s20, 12
  s_lshl_b32 s75, s25, 2
  s_add_u32 s75, s75, s20
  s_lshl_b32 s75, s75, 13
  s_lshl_b32 s74, s75, 1
  s_lshl_b32 s23, s24, 12
  s_add_u32 s74, s74, s23
  s_add_u32 s75, s75, s23
  v_lshlrev_b32 v122, 3, v0
  v_and_b32 v122, 0xFFF, v122
  v_lshrrev_b32 v121, 9, v0
  v_lshl_add_u32 v121, v121, 13, v122
  s_load_dwordx2 s[8:9], s[0:1], 16
  s_waitcnt lgkmcnt(0)
  s_and_b32 s9, s9, 0xffff
  s_mov_b32 s10, 5242880
  s_mov_b32 s11, 0x00020000
  s_lshl_b32 m0, s65, 1
  s_add_u32 m0, m0, 0
  s_add_u32 s23, s62, 0
  buffer_load_dwordx4 v112, s[8:11], s23 offen  lds
  s_lshl_b32 m0, s65, 1
  s_add_u32 m0, m0, 1024
  s_add_u32 s23, s62, 65536
  buffer_load_dwordx4 v112, s[8:11], s23 offen  lds
  s_lshl_b32 m0, s65, 1
  s_add_u32 m0, m0, 2048
  s_add_u32 s23, s62, 131072
  buffer_load_dwordx4 v112, s[8:11], s23 offen  lds
  s_lshl_b32 m0, s65, 1
  s_add_u32 m0, m0, 3072
  s_add_u32 s23, s62, 196608
  buffer_load_dwordx4 v112, s[8:11], s23 offen  lds
  s_lshl_b32 m0, s65, 1
  s_add_u32 m0, m0, 4096
  s_add_u32 s23, s62, 262144
  buffer_load_dwordx4 v112, s[8:11], s23 offen  lds
  s_lshl_b32 m0, s65, 1
  s_add_u32 m0, m0, 5120
  s_add_u32 s23, s62, 327680
  buffer_load_dwordx4 v112, s[8:11], s23 offen  lds
  s_lshl_b32 m0, s65, 1
  s_add_u32 m0, m0, 6144
  s_add_u32 s23, s62, 393216
  buffer_load_dwordx4 v112, s[8:11], s23 offen  lds
  s_lshl_b32 m0, s65, 1
  s_add_u32 m0, m0, 7168
  s_add_u32 s23, s62, 458752
  buffer_load_dwordx4 v112, s[8:11], s23 offen  lds
  s_lshl_b32 m0, s65, 1
  s_add_u32 m0, m0, 32768
  s_add_u32 s23, s62, 2097152
  buffer_load_dwordx4 v112, s[8:11], s23 offen  lds
  s_lshl_b32 m0, s65, 1
  s_add_u32 m0, m0, 33792
  s_add_u32 s23, s62, 2162688
  buffer_load_dwordx4 v112, s[8:11], s23 offen  lds
  s_lshl_b32 m0, s65, 1
  s_add_u32 m0, m0, 34816
  s_add_u32 s23, s62, 2228224
  buffer_load_dwordx4 v112, s[8:11], s23 offen  lds
  s_lshl_b32 m0, s65, 1
  s_add_u32 m0, m0, 35840
  s_add_u32 s23, s62, 2293760
  buffer_load_dwordx4 v112, s[8:11], s23 offen  lds
  s_lshl_b32 m0, s65, 1
  s_add_u32 m0, m0, 36864
  s_add_u32 s23, s62, 2359296
  buffer_load_dwordx4 v112, s[8:11], s23 offen  lds
  s_lshl_b32 m0, s65, 1
  s_add_u32 m0, m0, 37888
  s_add_u32 s23, s62, 2424832
  buffer_load_dwordx4 v112, s[8:11], s23 offen  lds
  s_lshl_b32 m0, s65, 1
  s_add_u32 m0, m0, 38912
  s_add_u32 s23, s62, 2490368
  buffer_load_dwordx4 v112, s[8:11], s23 offen  lds
  s_lshl_b32 m0, s65, 1
  s_add_u32 m0, m0, 39936
  s_add_u32 s23, s62, 2555904
  buffer_load_dwordx4 v112, s[8:11], s23 offen  lds
  s_add_u32 m0, s65, 65536
  s_add_u32 s23, s63, 4194304
  buffer_load_dwordx4 v112, s[8:11], s23 offen  lds
  s_add_u32 m0, s65, 66560
  s_add_u32 s23, s63, 4259840
  buffer_load_dwordx4 v112, s[8:11], s23 offen  lds
  s_add_u32 m0, s65, 67584
  s_add_u32 s23, s63, 4325376
  buffer_load_dwordx4 v112, s[8:11], s23 offen  lds
  s_add_u32 m0, s65, 68608
  s_add_u32 s23, s63, 4390912
  buffer_load_dwordx4 v112, s[8:11], s23 offen  lds
  s_load_dwordx2 s[12:13], s[0:1], 24
  s_waitcnt lgkmcnt(0)
  s_and_b32 s13, s13, 0xffff
  s_mov_b32 s14, 5242880
  s_mov_b32 s15, 0x00020000
  s_lshl_b32 m0, s65, 1
  s_add_u32 m0, m0, 98304
  s_add_u32 s23, s62, 0
  buffer_load_dwordx4 v112, s[12:15], s23 offen  lds
  s_lshl_b32 m0, s65, 1
  s_add_u32 m0, m0, 99328
  s_add_u32 s23, s62, 65536
  buffer_load_dwordx4 v112, s[12:15], s23 offen  lds
  s_lshl_b32 m0, s65, 1
  s_add_u32 m0, m0, 100352
  s_add_u32 s23, s62, 131072
  buffer_load_dwordx4 v112, s[12:15], s23 offen  lds
  s_lshl_b32 m0, s65, 1
  s_add_u32 m0, m0, 101376
  s_add_u32 s23, s62, 196608
  buffer_load_dwordx4 v112, s[12:15], s23 offen  lds
  s_lshl_b32 m0, s65, 1
  s_add_u32 m0, m0, 102400
  s_add_u32 s23, s62, 262144
  buffer_load_dwordx4 v112, s[12:15], s23 offen  lds
  s_lshl_b32 m0, s65, 1
  s_add_u32 m0, m0, 103424
  s_add_u32 s23, s62, 327680
  buffer_load_dwordx4 v112, s[12:15], s23 offen  lds
  s_lshl_b32 m0, s65, 1
  s_add_u32 m0, m0, 104448
  s_add_u32 s23, s62, 393216
  buffer_load_dwordx4 v112, s[12:15], s23 offen  lds
  s_lshl_b32 m0, s65, 1
  s_add_u32 m0, m0, 105472
  s_add_u32 s23, s62, 458752
  buffer_load_dwordx4 v112, s[12:15], s23 offen  lds
  s_waitcnt vmcnt(20)
  s_waitcnt lgkmcnt(0)
  s_barrier
  s_lshl_b32 m0, s65, 1
  s_add_u32 m0, m0, 131072
  s_add_u32 s23, s62, 2097152
  buffer_load_dwordx4 v112, s[12:15], s23 offen  lds
  s_lshl_b32 m0, s65, 1
  s_add_u32 m0, m0, 132096
  s_add_u32 s23, s62, 2162688
  buffer_load_dwordx4 v112, s[12:15], s23 offen  lds
  s_lshl_b32 m0, s65, 1
  s_add_u32 m0, m0, 133120
  s_add_u32 s23, s62, 2228224
  buffer_load_dwordx4 v112, s[12:15], s23 offen  lds
  s_lshl_b32 m0, s65, 1
  s_add_u32 m0, m0, 134144
  s_add_u32 s23, s62, 2293760
  buffer_load_dwordx4 v112, s[12:15], s23 offen  lds
  s_lshl_b32 m0, s65, 1
  s_add_u32 m0, m0, 135168
  s_add_u32 s23, s62, 2359296
  buffer_load_dwordx4 v112, s[12:15], s23 offen  lds
  s_lshl_b32 m0, s65, 1
  s_add_u32 m0, m0, 136192
  s_add_u32 s23, s62, 2424832
  buffer_load_dwordx4 v112, s[12:15], s23 offen  lds
  s_lshl_b32 m0, s65, 1
  s_add_u32 m0, m0, 137216
  s_add_u32 s23, s62, 2490368
  buffer_load_dwordx4 v112, s[12:15], s23 offen  lds
  s_lshl_b32 m0, s65, 1
  s_add_u32 m0, m0, 138240
  s_add_u32 s23, s62, 2555904
  buffer_load_dwordx4 v112, s[12:15], s23 offen  lds
  s_cmp_lg_u32 s20, 0
  s_cbranch_scc1 L_ta_done
  s_mov_b64 exec, 1
  v_mov_b32 v24, 52
  v_mov_b32 v25, 1
  global_atomic_add v24, v25, s[16:17] sc1
  s_mov_b64 exec, -1
L_ta_done:
  v_add_u32 v124, 0, v117
  v_add_u32 v125, 0, v118
  v_add_u32 v126, 0, v119
  v_add_u32 v127, 0, v120
  ds_read_b32 v40, v124 offset:0
  ds_read_b32 v41, v124 offset:128
  ds_read_b32 v42, v124 offset:256
  ds_read_b32 v43, v124 offset:384
  ds_read_b32 v44, v124 offset:4096
  ds_read_b32 v45, v124 offset:4224
  ds_read_b32 v46, v124 offset:4352
  ds_read_b32 v47, v124 offset:4480
  ds_read_b32 v48, v124 offset:1024
  ds_read_b32 v49, v124 offset:1152
  ds_read_b32 v50, v124 offset:1280
  ds_read_b32 v51, v124 offset:1408
  ds_read_b32 v52, v124 offset:5120
  ds_read_b32 v53, v124 offset:5248
  ds_read_b32 v54, v124 offset:5376
  ds_read_b32 v55, v124 offset:5504
  ds_read_b32 v56, v125 offset:0
  ds_read_b32 v57, v125 offset:128
  ds_read_b32 v58, v125 offset:256
  ds_read_b32 v59, v125 offset:384
  ds_read_b32 v60, v125 offset:4096
  ds_read_b32 v61, v125 offset:4224
  ds_read_b32 v62, v125 offset:4352
  ds_read_b32 v63, v125 offset:4480
  ds_read_b32 v64, v125 offset:1024
  ds_read_b32 v65, v125 offset:1152
  ds_read_b32 v66, v125 offset:1280
  ds_read_b32 v67, v125 offset:1408
  ds_read_b32 v68, v125 offset:5120
  ds_read_b32 v69, v125 offset:5248
  ds_read_b32 v70, v125 offset:5376
  ds_read_b32 v71, v125 offset:5504
  s_waitcnt lgkmcnt(15)
  v_perm_b32 v104, v48, v40, v116
  v_perm_b32 v105, v49, v41, v116
  v_perm_b32 v106, v50, v42, v116
  v_perm_b32 v107, v51, v43, v116
  v_perm_b32 v108, v52, v44, v116
  v_perm_b32 v109, v53, v45, v116
  v_perm_b32 v110, v54, v46, v116
  v_perm_b32 v111, v55, v47, v116
  v_accvgpr_write_b32 a0, v104
  v_accvgpr_write_b32 a1, v105
  v_accvgpr_write_b32 a2, v106
  v_accvgpr_write_b32 a3, v107
  v_accvgpr_write_b32 a4, v108
  v_accvgpr_write_b32 a5, v109
  v_accvgpr_write_b32 a6, v110
  v_accvgpr_write_b32 a7, v111
  ds_read_b32 v72, v126 offset:0
  ds_read_b32 v73, v126 offset:128
  ds_read_b32 v74, v126 offset:256
  ds_read_b32 v75, v126 offset:384
  ds_read_b32 v76, v126 offset:4096
  ds_read_b32 v77, v126 offset:4224
  ds_read_b32 v78, v126 offset:4352
  ds_read_b32 v79, v126 offset:4480
  ds_read_b32 v80, v126 offset:1024
  ds_read_b32 v81, v126 offset:1152
  ds_read_b32 v82, v126 offset:1280
  ds_read_b32 v83, v126 offset:1408
  ds_read_b32 v84, v126 offset:5120
  ds_read_b32 v85, v126 offset:5248
  ds_read_b32 v86, v126 offset:5376
  ds_read_b32 v87, v126 offset:5504
  s_waitcnt lgkmcnt(15)
  v_perm_b32 v104, v64, v56, v116
  v_perm_b32 v105, v65, v57, v116
  v_perm_b32 v106, v66, v58, v116
  v_perm_b32 v107, v67, v59, v116
  v_perm_b32 v108, v68, v60, v116
  v_perm_b32 v109, v69, v61, v116
  v_perm_b32 v110, v70, v62, v116
  v_perm_b32 v111, v71, v63, v116
  v_accvgpr_write_b32 a16, v104
  v_accvgpr_write_b32 a17, v105
  v_accvgpr_write_b32 a18, v106
  v_accvgpr_write_b32 a19, v107
  v_accvgpr_write_b32 a20, v108
  v_accvgpr_write_b32 a21, v109
  v_accvgpr_write_b32 a22, v110
  v_accvgpr_write_b32 a23, v111
  ds_read_b32 v88, v127 offset:0
  ds_read_b32 v89, v127 offset:128
  ds_read_b32 v90, v127 offset:256
  ds_read_b32 v91, v127 offset:384
  ds_read_b32 v92, v127 offset:4096
  ds_read_b32 v93, v127 offset:4224
  ds_read_b32 v94, v127 offset:4352
  ds_read_b32 v95, v127 offset:4480
  ds_read_b32 v96, v127 offset:1024
  ds_read_b32 v97, v127 offset:1152
  ds_read_b32 v98, v127 offset:1280
  ds_read_b32 v99, v127 offset:1408
  ds_read_b32 v100, v127 offset:5120
  ds_read_b32 v101, v127 offset:5248
  ds_read_b32 v102, v127 offset:5376
  ds_read_b32 v103, v127 offset:5504
  s_waitcnt lgkmcnt(15)
  v_perm_b32 v104, v80, v72, v116
  v_perm_b32 v105, v81, v73, v116
  v_perm_b32 v106, v82, v74, v116
  v_perm_b32 v107, v83, v75, v116
  v_perm_b32 v108, v84, v76, v116
  v_perm_b32 v109, v85, v77, v116
  v_perm_b32 v110, v86, v78, v116
  v_perm_b32 v111, v87, v79, v116
  v_accvgpr_write_b32 a32, v104
  v_accvgpr_write_b32 a33, v105
  v_accvgpr_write_b32 a34, v106
  v_accvgpr_write_b32 a35, v107
  v_accvgpr_write_b32 a36, v108
  v_accvgpr_write_b32 a37, v109
  v_accvgpr_write_b32 a38, v110
  v_accvgpr_write_b32 a39, v111
  s_waitcnt lgkmcnt(0)
  v_perm_b32 v104, v96, v88, v116
  v_perm_b32 v105, v97, v89, v116
  v_perm_b32 v106, v98, v90, v116
  v_perm_b32 v107, v99, v91, v116
  v_perm_b32 v108, v100, v92, v116
  v_perm_b32 v109, v101, v93, v116
  v_perm_b32 v110, v102, v94, v116
  v_perm_b32 v111, v103, v95, v116
  v_accvgpr_write_b32 a48, v104
  v_accvgpr_write_b32 a49, v105
  v_accvgpr_write_b32 a50, v106
  v_accvgpr_write_b32 a51, v107
  v_accvgpr_write_b32 a52, v108
  v_accvgpr_write_b32 a53, v109
  v_accvgpr_write_b32 a54, v110
  v_accvgpr_write_b32 a55, v111
  s_waitcnt vmcnt(20)
  s_waitcnt lgkmcnt(0)
  s_barrier
  s_add_u32 m0, s65, 0
  s_add_u32 s23, s63, 4194304
  buffer_load_dwordx4 v112, s[12:15], s23 offen  lds
  s_add_u32 m0, s65, 1024
  s_add_u32 s23, s63, 4259840
  buffer_load_dwordx4 v112, s[12:15], s23 offen  lds
  s_add_u32 m0, s65, 2048
  s_add_u32 s23, s63, 4325376
  buffer_load_dwordx4 v112, s[12:15], s23 offen  lds
  s_add_u32 m0, s65, 3072
  s_add_u32 s23, s63, 4390912
  buffer_load_dwordx4 v112, s[12:15], s23 offen  lds
  v_add_u32 v124, 32768, v117
  v_add_u32 v125, 32768, v118
  v_add_u32 v126, 32768, v119
  v_add_u32 v127, 32768, v120
  ds_read_b32 v40, v124 offset:0
  ds_read_b32 v41, v124 offset:128
  ds_read_b32 v42, v124 offset:256
  ds_read_b32 v43, v124 offset:384
  ds_read_b32 v44, v124 offset:4096
  ds_read_b32 v45, v124 offset:4224
  ds_read_b32 v46, v124 offset:4352
  ds_read_b32 v47, v124 offset:4480
  ds_read_b32 v48, v124 offset:1024
  ds_read_b32 v49, v124 offset:1152
  ds_read_b32 v50, v124 offset:1280
  ds_read_b32 v51, v124 offset:1408
  ds_read_b32 v52, v124 offset:5120
  ds_read_b32 v53, v124 offset:5248
  ds_read_b32 v54, v124 offset:5376
  ds_read_b32 v55, v124 offset:5504
  ds_read_b32 v56, v125 offset:0
  ds_read_b32 v57, v125 offset:128
  ds_read_b32 v58, v125 offset:256
  ds_read_b32 v59, v125 offset:384
  ds_read_b32 v60, v125 offset:4096
  ds_read_b32 v61, v125 offset:4224
  ds_read_b32 v62, v125 offset:4352
  ds_read_b32 v63, v125 offset:4480
  ds_read_b32 v64, v125 offset:1024
  ds_read_b32 v65, v125 offset:1152
  ds_read_b32 v66, v125 offset:1280
  ds_read_b32 v67, v125 offset:1408
  ds_read_b32 v68, v125 offset:5120
  ds_read_b32 v69, v125 offset:5248
  ds_read_b32 v70, v125 offset:5376
  ds_read_b32 v71, v125 offset:5504
  s_waitcnt lgkmcnt(15)
  v_perm_b32 v104, v48, v40, v116
  v_perm_b32 v105, v49, v41, v116
  v_perm_b32 v106, v50, v42, v116
  v_perm_b32 v107, v51, v43, v116
  v_perm_b32 v108, v52, v44, v116
  v_perm_b32 v109, v53, v45, v116
  v_perm_b32 v110, v54, v46, v116
  v_perm_b32 v111, v55, v47, v116
  v_accvgpr_write_b32 a8, v104
  v_accvgpr_write_b32 a9, v105
  v_accvgpr_write_b32 a10, v106
  v_accvgpr_write_b32 a11, v107
  v_accvgpr_write_b32 a12, v108
  v_accvgpr_write_b32 a13, v109
  v_accvgpr_write_b32 a14, v110
  v_accvgpr_write_b32 a15, v111
  ds_read_b32 v72, v126 offset:0
  ds_read_b32 v73, v126 offset:128
  ds_read_b32 v74, v126 offset:256
  ds_read_b32 v75, v126 offset:384
  ds_read_b32 v76, v126 offset:4096
  ds_read_b32 v77, v126 offset:4224
  ds_read_b32 v78, v126 offset:4352
  ds_read_b32 v79, v126 offset:4480
  ds_read_b32 v80, v126 offset:1024
  ds_read_b32 v81, v126 offset:1152
  ds_read_b32 v82, v126 offset:1280
  ds_read_b32 v83, v126 offset:1408
  ds_read_b32 v84, v126 offset:5120
  ds_read_b32 v85, v126 offset:5248
  ds_read_b32 v86, v126 offset:5376
  ds_read_b32 v87, v126 offset:5504
  s_waitcnt lgkmcnt(15)
  v_perm_b32 v104, v64, v56, v116
  v_perm_b32 v105, v65, v57, v116
  v_perm_b32 v106, v66, v58, v116
  v_perm_b32 v107, v67, v59, v116
  v_perm_b32 v108, v68, v60, v116
  v_perm_b32 v109, v69, v61, v116
  v_perm_b32 v110, v70, v62, v116
  v_perm_b32 v111, v71, v63, v116
  v_accvgpr_write_b32 a24, v104
  v_accvgpr_write_b32 a25, v105
  v_accvgpr_write_b32 a26, v106
  v_accvgpr_write_b32 a27, v107
  v_accvgpr_write_b32 a28, v108
  v_accvgpr_write_b32 a29, v109
  v_accvgpr_write_b32 a30, v110
  v_accvgpr_write_b32 a31, v111
  ds_read_b32 v88, v127 offset:0
  ds_read_b32 v89, v127 offset:128
  ds_read_b32 v90, v127 offset:256
  ds_read_b32 v91, v127 offset:384
  ds_read_b32 v92, v127 offset:4096
  ds_read_b32 v93, v127 offset:4224
  ds_read_b32 v94, v127 offset:4352
  ds_read_b32 v95, v127 offset:4480
  ds_read_b32 v96, v127 offset:1024
  ds_read_b32 v97, v127 offset:1152
  ds_read_b32 v98, v127 offset:1280
  ds_read_b32 v99, v127 offset:1408
  ds_read_b32 v100, v127 offset:5120
  ds_read_b32 v101, v127 offset:5248
  ds_read_b32 v102, v127 offset:5376
  ds_read_b32 v103, v127 offset:5504
  s_waitcnt lgkmcnt(15)
  v_perm_b32 v104, v80, v72, v116
  v_perm_b32 v105, v81, v73, v116
  v_perm_b32 v106, v82, v74, v116
  v_perm_b32 v107, v83, v75, v116
  v_perm_b32 v108, v84, v76, v116
  v_perm_b32 v109, v85, v77, v116
  v_perm_b32 v110, v86, v78, v116
  v_perm_b32 v111, v87, v79, v116
  v_accvgpr_write_b32 a40, v104
  v_accvgpr_write_b32 a41, v105
  v_accvgpr_write_b32 a42, v106
  v_accvgpr_write_b32 a43, v107
  v_accvgpr_write_b32 a44, v108
  v_accvgpr_write_b32 a45, v109
  v_accvgpr_write_b32 a46, v110
  v_accvgpr_write_b32 a47, v111
  s_waitcnt lgkmcnt(0)
  v_perm_b32 v104, v96, v88, v116
  v_perm_b32 v105, v97, v89, v116
  v_perm_b32 v106, v98, v90, v116
  v_perm_b32 v107, v99, v91, v116
  v_perm_b32 v108, v100, v92, v116
  v_perm_b32 v109, v101, v93, v116
  v_perm_b32 v110, v102, v94, v116
  v_perm_b32 v111, v103, v95, v116
  v_accvgpr_write_b32 a56, v104
  v_accvgpr_write_b32 a57, v105
  v_accvgpr_write_b32 a58, v106
  v_accvgpr_write_b32 a59, v107
  v_accvgpr_write_b32 a60, v108
  v_accvgpr_write_b32 a61, v109
  v_accvgpr_write_b32 a62, v110
  v_accvgpr_write_b32 a63, v111
  s_waitcnt vmcnt(20)
  s_waitcnt lgkmcnt(0)
  s_barrier
  s_load_dwordx2 s[8:9], s[0:1], 32
  s_waitcnt lgkmcnt(0)
  s_and_b32 s9, s9, 0xffff
  s_mov_b32 s10, 5242880
  s_mov_b32 s11, 0x00020000
  s_lshl_b32 m0, s65, 1
  s_add_u32 m0, m0, 32768
  s_add_u32 s23, s62, 0
  buffer_load_dwordx4 v112, s[8:11], s23 offen  lds
  s_lshl_b32 m0, s65, 1
  s_add_u32 m0, m0, 33792
  s_add_u32 s23, s62, 65536
  buffer_load_dwordx4 v112, s[8:11], s23 offen  lds
  s_lshl_b32 m0, s65, 1
  s_add_u32 m0, m0, 34816
  s_add_u32 s23, s62, 131072
  buffer_load_dwordx4 v112, s[8:11], s23 offen  lds
  s_lshl_b32 m0, s65, 1
  s_add_u32 m0, m0, 35840
  s_add_u32 s23, s62, 196608
  buffer_load_dwordx4 v112, s[8:11], s23 offen  lds
  s_lshl_b32 m0, s65, 1
  s_add_u32 m0, m0, 36864
  s_add_u32 s23, s62, 262144
  buffer_load_dwordx4 v112, s[8:11], s23 offen  lds
  s_lshl_b32 m0, s65, 1
  s_add_u32 m0, m0, 37888
  s_add_u32 s23, s62, 327680
  buffer_load_dwordx4 v112, s[8:11], s23 offen  lds
  s_lshl_b32 m0, s65, 1
  s_add_u32 m0, m0, 38912
  s_add_u32 s23, s62, 393216
  buffer_load_dwordx4 v112, s[8:11], s23 offen  lds
  s_lshl_b32 m0, s65, 1
  s_add_u32 m0, m0, 39936
  s_add_u32 s23, s62, 458752
  buffer_load_dwordx4 v112, s[8:11], s23 offen  lds
  v_add_u32 v124, 65536, v114
  v_add_u32 v125, 73728, v114
  ds_read_b32 v40, v124 offset:0
  ds_read_b32 v41, v124 offset:128
  ds_read_b32 v42, v124 offset:256
  ds_read_b32 v43, v124 offset:384
  ds_read_b32 v44, v124 offset:4096
  ds_read_b32 v45, v124 offset:4224
  ds_read_b32 v46, v124 offset:4352
  ds_read_b32 v47, v124 offset:4480
  ds_read_b32 v48, v124 offset:1024
  ds_read_b32 v49, v124 offset:1152
  ds_read_b32 v50, v124 offset:1280
  ds_read_b32 v51, v124 offset:1408
  ds_read_b32 v52, v124 offset:5120
  ds_read_b32 v53, v124 offset:5248
  ds_read_b32 v54, v124 offset:5376
  ds_read_b32 v55, v124 offset:5504
  ds_read_b32 v56, v125 offset:0
  ds_read_b32 v57, v125 offset:128
  ds_read_b32 v58, v125 offset:256
  ds_read_b32 v59, v125 offset:384
  ds_read_b32 v60, v125 offset:4096
  ds_read_b32 v61, v125 offset:4224
  ds_read_b32 v62, v125 offset:4352
  ds_read_b32 v63, v125 offset:4480
  ds_read_b32 v64, v125 offset:1024
  ds_read_b32 v65, v125 offset:1152
  ds_read_b32 v66, v125 offset:1280
  ds_read_b32 v67, v125 offset:1408
  ds_read_b32 v68, v125 offset:5120
  ds_read_b32 v69, v125 offset:5248
  ds_read_b32 v70, v125 offset:5376
  ds_read_b32 v71, v125 offset:5504
  s_waitcnt lgkmcnt(15)
  v_perm_b32 v104, v48, v40, v116
  v_perm_b32 v105, v49, v41, v116
  v_perm_b32 v106, v50, v42, v116
  v_perm_b32 v107, v51, v43, v116
  v_perm_b32 v108, v52, v44, v116
  v_perm_b32 v109, v53, v45, v116
  v_perm_b32 v110, v54, v46, v116
  v_perm_b32 v111, v55, v47, v116
  v_accvgpr_write_b32 a64, v104
  v_accvgpr_write_b32 a65, v105
  v_accvgpr_write_b32 a66, v106
  v_accvgpr_write_b32 a67, v107
  v_accvgpr_write_b32 a68, v108
  v_accvgpr_write_b32 a69, v109
  v_accvgpr_write_b32 a70, v110
  v_accvgpr_write_b32 a71, v111
  s_waitcnt lgkmcnt(0)
  v_perm_b32 v104, v64, v56, v116
  v_perm_b32 v105, v65, v57, v116
  v_perm_b32 v106, v66, v58, v116
  v_perm_b32 v107, v67, v59, v116
  v_perm_b32 v108, v68, v60, v116
  v_perm_b32 v109, v69, v61, v116
  v_perm_b32 v110, v70, v62, v116
  v_perm_b32 v111, v71, v63, v116
  v_accvgpr_write_b32 a72, v104
  v_accvgpr_write_b32 a73, v105
  v_accvgpr_write_b32 a74, v106
  v_accvgpr_write_b32 a75, v107
  v_accvgpr_write_b32 a76, v108
  v_accvgpr_write_b32 a77, v109
  v_accvgpr_write_b32 a78, v110
  v_accvgpr_write_b32 a79, v111
  s_waitcnt vmcnt(20)
  s_waitcnt lgkmcnt(0)
  s_barrier
  s_lshl_b32 m0, s65, 1
  s_add_u32 m0, m0, 65536
  s_add_u32 s23, s62, 2097152
  buffer_load_dwordx4 v112, s[8:11], s23 offen  lds
  s_lshl_b32 m0, s65, 1
  s_add_u32 m0, m0, 66560
  s_add_u32 s23, s62, 2162688
  buffer_load_dwordx4 v112, s[8:11], s23 offen  lds
  s_lshl_b32 m0, s65, 1
  s_add_u32 m0, m0, 67584
  s_add_u32 s23, s62, 2228224
  buffer_load_dwordx4 v112, s[8:11], s23 offen  lds
  s_lshl_b32 m0, s65, 1
  s_add_u32 m0, m0, 68608
  s_add_u32 s23, s62, 2293760
  buffer_load_dwordx4 v112, s[8:11], s23 offen  lds
  s_lshl_b32 m0, s65, 1
  s_add_u32 m0, m0, 69632
  s_add_u32 s23, s62, 2359296
  buffer_load_dwordx4 v112, s[8:11], s23 offen  lds
  s_lshl_b32 m0, s65, 1
  s_add_u32 m0, m0, 70656
  s_add_u32 s23, s62, 2424832
  buffer_load_dwordx4 v112, s[8:11], s23 offen  lds
  s_lshl_b32 m0, s65, 1
  s_add_u32 m0, m0, 71680
  s_add_u32 s23, s62, 2490368
  buffer_load_dwordx4 v112, s[8:11], s23 offen  lds
  s_lshl_b32 m0, s65, 1
  s_add_u32 m0, m0, 72704
  s_add_u32 s23, s62, 2555904
  buffer_load_dwordx4 v112, s[8:11], s23 offen  lds
  v_add_u32 v124, 98304, v117
  v_add_u32 v125, 98304, v118
  v_add_u32 v126, 98304, v119
  v_add_u32 v127, 98304, v120
  ds_read_b32 v40, v124 offset:0
  ds_read_b32 v41, v124 offset:128
  ds_read_b32 v42, v124 offset:256
  ds_read_b32 v43, v124 offset:384
  ds_read_b32 v44, v124 offset:4096
  ds_read_b32 v45, v124 offset:4224
  ds_read_b32 v46, v124 offset:4352
  ds_read_b32 v47, v124 offset:4480
  ds_read_b32 v48, v124 offset:1024
  ds_read_b32 v49, v124 offset:1152
  ds_read_b32 v50, v124 offset:1280
  ds_read_b32 v51, v124 offset:1408
  ds_read_b32 v52, v124 offset:5120
  ds_read_b32 v53, v124 offset:5248
  ds_read_b32 v54, v124 offset:5376
  ds_read_b32 v55, v124 offset:5504
  ds_read_b32 v56, v125 offset:0
  ds_read_b32 v57, v125 offset:128
  ds_read_b32 v58, v125 offset:256
  ds_read_b32 v59, v125 offset:384
  ds_read_b32 v60, v125 offset:4096
  ds_read_b32 v61, v125 offset:4224
  ds_read_b32 v62, v125 offset:4352
  ds_read_b32 v63, v125 offset:4480
  ds_read_b32 v64, v125 offset:1024
  ds_read_b32 v65, v125 offset:1152
  ds_read_b32 v66, v125 offset:1280
  ds_read_b32 v67, v125 offset:1408
  ds_read_b32 v68, v125 offset:5120
  ds_read_b32 v69, v125 offset:5248
  ds_read_b32 v70, v125 offset:5376
  ds_read_b32 v71, v125 offset:5504
  s_waitcnt lgkmcnt(15)
  v_perm_b32 v104, v48, v40, v116
  v_perm_b32 v105, v49, v41, v116
  v_perm_b32 v106, v50, v42, v116
  v_perm_b32 v107, v51, v43, v116
  v_perm_b32 v108, v52, v44, v116
  v_perm_b32 v109, v53, v45, v116
  v_perm_b32 v110, v54, v46, v116
  v_perm_b32 v111, v55, v47, v116
  v_accvgpr_write_b32 a80, v104
  v_accvgpr_write_b32 a81, v105
  v_accvgpr_write_b32 a82, v106
  v_accvgpr_write_b32 a83, v107
  v_accvgpr_write_b32 a84, v108
  v_accvgpr_write_b32 a85, v109
  v_accvgpr_write_b32 a86, v110
  v_accvgpr_write_b32 a87, v111
  ds_read_b32 v72, v126 offset:0
  ds_read_b32 v73, v126 offset:128
  ds_read_b32 v74, v126 offset:256
  ds_read_b32 v75, v126 offset:384
  ds_read_b32 v76, v126 offset:4096
  ds_read_b32 v77, v126 offset:4224
  ds_read_b32 v78, v126 offset:4352
  ds_read_b32 v79, v126 offset:4480
  ds_read_b32 v80, v126 offset:1024
  ds_read_b32 v81, v126 offset:1152
  ds_read_b32 v82, v126 offset:1280
  ds_read_b32 v83, v126 offset:1408
  ds_read_b32 v84, v126 offset:5120
  ds_read_b32 v85, v126 offset:5248
  ds_read_b32 v86, v126 offset:5376
  ds_read_b32 v87, v126 offset:5504
  s_waitcnt lgkmcnt(15)
  v_perm_b32 v104, v64, v56, v116
  v_perm_b32 v105, v65, v57, v116
  v_perm_b32 v106, v66, v58, v116
  v_perm_b32 v107, v67, v59, v116
  v_perm_b32 v108, v68, v60, v116
  v_perm_b32 v109, v69, v61, v116
  v_perm_b32 v110, v70, v62, v116
  v_perm_b32 v111, v71, v63, v116
  v_accvgpr_write_b32 a96, v104
  v_accvgpr_write_b32 a97, v105
  v_accvgpr_write_b32 a98, v106
  v_accvgpr_write_b32 a99, v107
  v_accvgpr_write_b32 a100, v108
  v_accvgpr_write_b32 a101, v109
  v_accvgpr_write_b32 a102, v110
  v_accvgpr_write_b32 a103, v111
  ds_read_b32 v88, v127 offset:0
  ds_read_b32 v89, v127 offset:128
  ds_read_b32 v90, v127 offset:256
  ds_read_b32 v91, v127 offset:384
  ds_read_b32 v92, v127 offset:4096
  ds_read_b32 v93, v127 offset:4224
  ds_read_b32 v94, v127 offset:4352
  ds_read_b32 v95, v127 offset:4480
  ds_read_b32 v96, v127 offset:1024
  ds_read_b32 v97, v127 offset:1152
  ds_read_b32 v98, v127 offset:1280
  ds_read_b32 v99, v127 offset:1408
  ds_read_b32 v100, v127 offset:5120
  ds_read_b32 v101, v127 offset:5248
  ds_read_b32 v102, v127 offset:5376
  ds_read_b32 v103, v127 offset:5504
  s_waitcnt lgkmcnt(15)
  v_perm_b32 v104, v80, v72, v116
  v_perm_b32 v105, v81, v73, v116
  v_perm_b32 v106, v82, v74, v116
  v_perm_b32 v107, v83, v75, v116
  v_perm_b32 v108, v84, v76, v116
  v_perm_b32 v109, v85, v77, v116
  v_perm_b32 v110, v86, v78, v116
  v_perm_b32 v111, v87, v79, v116
  v_accvgpr_write_b32 a112, v104
  v_accvgpr_write_b32 a113, v105
  v_accvgpr_write_b32 a114, v106
  v_accvgpr_write_b32 a115, v107
  v_accvgpr_write_b32 a116, v108
  v_accvgpr_write_b32 a117, v109
  v_accvgpr_write_b32 a118, v110
  v_accvgpr_write_b32 a119, v111
  s_waitcnt lgkmcnt(0)
  v_perm_b32 v104, v96, v88, v116
  v_perm_b32 v105, v97, v89, v116
  v_perm_b32 v106, v98, v90, v116
  v_perm_b32 v107, v99, v91, v116
  v_perm_b32 v108, v100, v92, v116
  v_perm_b32 v109, v101, v93, v116
  v_perm_b32 v110, v102, v94, v116
  v_perm_b32 v111, v103, v95, v116
  v_accvgpr_write_b32 a128, v104
  v_accvgpr_write_b32 a129, v105
  v_accvgpr_write_b32 a130, v106
  v_accvgpr_write_b32 a131, v107
  v_accvgpr_write_b32 a132, v108
  v_accvgpr_write_b32 a133, v109
  v_accvgpr_write_b32 a134, v110
  v_accvgpr_write_b32 a135, v111
  s_waitcnt vmcnt(20)
  s_waitcnt lgkmcnt(0)
  s_barrier
  s_add_u32 m0, s65, 98304
  s_add_u32 s23, s63, 4194304
  buffer_load_dwordx4 v112, s[8:11], s23 offen  lds
  s_add_u32 m0, s65, 99328
  s_add_u32 s23, s63, 4259840
  buffer_load_dwordx4 v112, s[8:11], s23 offen  lds
  s_add_u32 m0, s65, 100352
  s_add_u32 s23, s63, 4325376
  buffer_load_dwordx4 v112, s[8:11], s23 offen  lds
  s_add_u32 m0, s65, 101376
  s_add_u32 s23, s63, 4390912
  buffer_load_dwordx4 v112, s[8:11], s23 offen  lds
  v_add_u32 v124, 131072, v117
  v_add_u32 v125, 131072, v118
  v_add_u32 v126, 131072, v119
  v_add_u32 v127, 131072, v120
  ds_read_b32 v40, v124 offset:0
  ds_read_b32 v41, v124 offset:128
  ds_read_b32 v42, v124 offset:256
  ds_read_b32 v43, v124 offset:384
  ds_read_b32 v44, v124 offset:4096
  ds_read_b32 v45, v124 offset:4224
  ds_read_b32 v46, v124 offset:4352
  ds_read_b32 v47, v124 offset:4480
  ds_read_b32 v48, v124 offset:1024
  ds_read_b32 v49, v124 offset:1152
  ds_read_b32 v50, v124 offset:1280
  ds_read_b32 v51, v124 offset:1408
  ds_read_b32 v52, v124 offset:5120
  ds_read_b32 v53, v124 offset:5248
  ds_read_b32 v54, v124 offset:5376
  ds_read_b32 v55, v124 offset:5504
  ds_read_b32 v56, v125 offset:0
  ds_read_b32 v57, v125 offset:128
  ds_read_b32 v58, v125 offset:256
  ds_read_b32 v59, v125 offset:384
  ds_read_b32 v60, v125 offset:4096
  ds_read_b32 v61, v125 offset:4224
  ds_read_b32 v62, v125 offset:4352
  ds_read_b32 v63, v125 offset:4480
  ds_read_b32 v64, v125 offset:1024
  ds_read_b32 v65, v125 offset:1152
  ds_read_b32 v66, v125 offset:1280
  ds_read_b32 v67, v125 offset:1408
  ds_read_b32 v68, v125 offset:5120
  ds_read_b32 v69, v125 offset:5248
  ds_read_b32 v70, v125 offset:5376
  ds_read_b32 v71, v125 offset:5504
  s_waitcnt lgkmcnt(15)
  v_perm_b32 v104, v48, v40, v116
  v_perm_b32 v105, v49, v41, v116
  v_perm_b32 v106, v50, v42, v116
  v_perm_b32 v107, v51, v43, v116
  v_perm_b32 v108, v52, v44, v116
  v_perm_b32 v109, v53, v45, v116
  v_perm_b32 v110, v54, v46, v116
  v_perm_b32 v111, v55, v47, v116
  v_accvgpr_write_b32 a88, v104
  v_accvgpr_write_b32 a89, v105
  v_accvgpr_write_b32 a90, v106
  v_accvgpr_write_b32 a91, v107
  v_accvgpr_write_b32 a92, v108
  v_accvgpr_write_b32 a93, v109
  v_accvgpr_write_b32 a94, v110
  v_accvgpr_write_b32 a95, v111
  ds_read_b32 v72, v126 offset:0
  ds_read_b32 v73, v126 offset:128
  ds_read_b32 v74, v126 offset:256
  ds_read_b32 v75, v126 offset:384
  ds_read_b32 v76, v126 offset:4096
  ds_read_b32 v77, v126 offset:4224
  ds_read_b32 v78, v126 offset:4352
  ds_read_b32 v79, v126 offset:4480
  ds_read_b32 v80, v126 offset:1024
  ds_read_b32 v81, v126 offset:1152
  ds_read_b32 v82, v126 offset:1280
  ds_read_b32 v83, v126 offset:1408
  ds_read_b32 v84, v126 offset:5120
  ds_read_b32 v85, v126 offset:5248
  ds_read_b32 v86, v126 offset:5376
  ds_read_b32 v87, v126 offset:5504
  s_waitcnt lgkmcnt(15)
  v_perm_b32 v104, v64, v56, v116
  v_perm_b32 v105, v65, v57, v116
  v_perm_b32 v106, v66, v58, v116
  v_perm_b32 v107, v67, v59, v116
  v_perm_b32 v108, v68, v60, v116
  v_perm_b32 v109, v69, v61, v116
  v_perm_b32 v110, v70, v62, v116
  v_perm_b32 v111, v71, v63, v116
  v_accvgpr_write_b32 a104, v104
  v_accvgpr_write_b32 a105, v105
  v_accvgpr_write_b32 a106, v106
  v_accvgpr_write_b32 a107, v107
  v_accvgpr_write_b32 a108, v108
  v_accvgpr_write_b32 a109, v109
  v_accvgpr_write_b32 a110, v110
  v_accvgpr_write_b32 a111, v111
  ds_read_b32 v88, v127 offset:0
  ds_read_b32 v89, v127 offset:128
  ds_read_b32 v90, v127 offset:256
  ds_read_b32 v91, v127 offset:384
  ds_read_b32 v92, v127 offset:4096
  ds_read_b32 v93, v127 offset:4224
  ds_read_b32 v94, v127 offset:4352
  ds_read_b32 v95, v127 offset:4480
  ds_read_b32 v96, v127 offset:1024
  ds_read_b32 v97, v127 offset:1152
  ds_read_b32 v98, v127 offset:1280
  ds_read_b32 v99, v127 offset:1408
  ds_read_b32 v100, v127 offset:5120
  ds_read_b32 v101, v127 offset:5248
  ds_read_b32 v102, v127 offset:5376
  ds_read_b32 v103, v127 offset:5504
  s_waitcnt lgkmcnt(15)
  v_perm_b32 v104, v80, v72, v116
  v_perm_b32 v105, v81, v73, v116
  v_perm_b32 v106, v82, v74, v116
  v_perm_b32 v107, v83, v75, v116
  v_perm_b32 v108, v84, v76, v116
  v_perm_b32 v109, v85, v77, v116
  v_perm_b32 v110, v86, v78, v116
  v_perm_b32 v111, v87, v79, v116
  v_accvgpr_write_b32 a120, v104
  v_accvgpr_write_b32 a121, v105
  v_accvgpr_write_b32 a122, v106
  v_accvgpr_write_b32 a123, v107
  v_accvgpr_write_b32 a124, v108
  v_accvgpr_write_b32 a125, v109
  v_accvgpr_write_b32 a126, v110
  v_accvgpr_write_b32 a127, v111
  s_waitcnt lgkmcnt(0)
  v_perm_b32 v104, v96, v88, v116
  v_perm_b32 v105, v97, v89, v116
  v_perm_b32 v106, v98, v90, v116
  v_perm_b32 v107, v99, v91, v116
  v_perm_b32 v108, v100, v92, v116
  v_perm_b32 v109, v101, v93, v116
  v_perm_b32 v110, v102, v94, v116
  v_perm_b32 v111, v103, v95, v116
  v_accvgpr_write_b32 a136, v104
  v_accvgpr_write_b32 a137, v105
  v_accvgpr_write_b32 a138, v106
  v_accvgpr_write_b32 a139, v107
  v_accvgpr_write_b32 a140, v108
  v_accvgpr_write_b32 a141, v109
  v_accvgpr_write_b32 a142, v110
  v_accvgpr_write_b32 a143, v111
  s_waitcnt vmcnt(20)
  s_waitcnt lgkmcnt(0)
  s_barrier
  s_load_dwordx2 s[12:13], s[0:1], 40
  s_waitcnt lgkmcnt(0)
  s_and_b32 s13, s13, 0xffff
  s_mov_b32 s14, 5242880
  s_mov_b32 s15, 0x00020000
  s_add_u32 m0, s65, 131072
  s_add_u32 s23, s64, 0
  buffer_load_dwordx4 v113, s[12:15], s23 offen  lds
  s_add_u32 m0, s65, 132096
  s_add_u32 s23, s64, 5120
  buffer_load_dwordx4 v113, s[12:15], s23 offen  lds
  s_add_u32 m0, s65, 133120
  s_add_u32 s23, s64, 10240
  buffer_load_dwordx4 v113, s[12:15], s23 offen  lds
  s_add_u32 m0, s65, 134144
  s_add_u32 s23, s64, 15360
  buffer_load_dwordx4 v113, s[12:15], s23 offen  lds
  v_add_u32 v124, 0, v114
  v_add_u32 v125, 8192, v114
  ds_read_b32 v40, v124 offset:0
  ds_read_b32 v41, v124 offset:128
  ds_read_b32 v42, v124 offset:256
  ds_read_b32 v43, v124 offset:384
  ds_read_b32 v44, v124 offset:4096
  ds_read_b32 v45, v124 offset:4224
  ds_read_b32 v46, v124 offset:4352
  ds_read_b32 v47, v124 offset:4480
  ds_read_b32 v48, v124 offset:1024
  ds_read_b32 v49, v124 offset:1152
  ds_read_b32 v50, v124 offset:1280
  ds_read_b32 v51, v124 offset:1408
  ds_read_b32 v52, v124 offset:5120
  ds_read_b32 v53, v124 offset:5248
  ds_read_b32 v54, v124 offset:5376
  ds_read_b32 v55, v124 offset:5504
  ds_read_b32 v56, v125 offset:0
  ds_read_b32 v57, v125 offset:128
  ds_read_b32 v58, v125 offset:256
  ds_read_b32 v59, v125 offset:384
  ds_read_b32 v60, v125 offset:4096
  ds_read_b32 v61, v125 offset:4224
  ds_read_b32 v62, v125 offset:4352
  ds_read_b32 v63, v125 offset:4480
  ds_read_b32 v64, v125 offset:1024
  ds_read_b32 v65, v125 offset:1152
  ds_read_b32 v66, v125 offset:1280
  ds_read_b32 v67, v125 offset:1408
  ds_read_b32 v68, v125 offset:5120
  ds_read_b32 v69, v125 offset:5248
  ds_read_b32 v70, v125 offset:5376
  ds_read_b32 v71, v125 offset:5504
  s_waitcnt lgkmcnt(15)
  v_perm_b32 v104, v48, v40, v116
  v_perm_b32 v105, v49, v41, v116
  v_perm_b32 v106, v50, v42, v116
  v_perm_b32 v107, v51, v43, v116
  v_perm_b32 v108, v52, v44, v116
  v_perm_b32 v109, v53, v45, v116
  v_perm_b32 v110, v54, v46, v116
  v_perm_b32 v111, v55, v47, v116
  v_accvgpr_write_b32 a144, v104
  v_accvgpr_write_b32 a145, v105
  v_accvgpr_write_b32 a146, v106
  v_accvgpr_write_b32 a147, v107
  v_accvgpr_write_b32 a148, v108
  v_accvgpr_write_b32 a149, v109
  v_accvgpr_write_b32 a150, v110
  v_accvgpr_write_b32 a151, v111
  s_waitcnt lgkmcnt(0)
  v_perm_b32 v104, v64, v56, v116
  v_perm_b32 v105, v65, v57, v116
  v_perm_b32 v106, v66, v58, v116
  v_perm_b32 v107, v67, v59, v116
  v_perm_b32 v108, v68, v60, v116
  v_perm_b32 v109, v69, v61, v116
  v_perm_b32 v110, v70, v62, v116
  v_perm_b32 v111, v71, v63, v116
  v_accvgpr_write_b32 a152, v104
  v_accvgpr_write_b32 a153, v105
  v_accvgpr_write_b32 a154, v106
  v_accvgpr_write_b32 a155, v107
  v_accvgpr_write_b32 a156, v108
  v_accvgpr_write_b32 a157, v109
  v_accvgpr_write_b32 a158, v110
  v_accvgpr_write_b32 a159, v111
  s_waitcnt vmcnt(16)
  s_waitcnt lgkmcnt(0)
  s_barrier
  s_add_u32 m0, s65, 0
  s_add_u32 s23, s64, 256
  buffer_load_dwordx4 v113, s[12:15], s23 offen  lds
  s_add_u32 m0, s65, 1024
  s_add_u32 s23, s64, 5376
  buffer_load_dwordx4 v113, s[12:15], s23 offen  lds
  s_add_u32 m0, s65, 2048
  s_add_u32 s23, s64, 10496
  buffer_load_dwordx4 v113, s[12:15], s23 offen  lds
  s_add_u32 m0, s65, 3072
  s_add_u32 s23, s64, 15616
  buffer_load_dwordx4 v113, s[12:15], s23 offen  lds
  v_add_u32 v124, 32768, v117
  v_add_u32 v125, 32768, v118
  v_add_u32 v126, 32768, v119
  v_add_u32 v127, 32768, v120
  ds_read_b32 v40, v124 offset:0
  ds_read_b32 v41, v124 offset:128
  ds_read_b32 v42, v124 offset:256
  ds_read_b32 v43, v124 offset:384
  ds_read_b32 v44, v124 offset:4096
  ds_read_b32 v45, v124 offset:4224
  ds_read_b32 v46, v124 offset:4352
  ds_read_b32 v47, v124 offset:4480
  ds_read_b32 v48, v124 offset:1024
  ds_read_b32 v49, v124 offset:1152
  ds_read_b32 v50, v124 offset:1280
  ds_read_b32 v51, v124 offset:1408
  ds_read_b32 v52, v124 offset:5120
  ds_read_b32 v53, v124 offset:5248
  ds_read_b32 v54, v124 offset:5376
  ds_read_b32 v55, v124 offset:5504
  ds_read_b32 v56, v125 offset:0
  ds_read_b32 v57, v125 offset:128
  ds_read_b32 v58, v125 offset:256
  ds_read_b32 v59, v125 offset:384
  ds_read_b32 v60, v125 offset:4096
  ds_read_b32 v61, v125 offset:4224
  ds_read_b32 v62, v125 offset:4352
  ds_read_b32 v63, v125 offset:4480
  ds_read_b32 v64, v125 offset:1024
  ds_read_b32 v65, v125 offset:1152
  ds_read_b32 v66, v125 offset:1280
  ds_read_b32 v67, v125 offset:1408
  ds_read_b32 v68, v125 offset:5120
  ds_read_b32 v69, v125 offset:5248
  ds_read_b32 v70, v125 offset:5376
  ds_read_b32 v71, v125 offset:5504
  s_waitcnt lgkmcnt(15)
  v_perm_b32 v104, v48, v40, v116
  v_perm_b32 v105, v49, v41, v116
  v_perm_b32 v106, v50, v42, v116
  v_perm_b32 v107, v51, v43, v116
  v_perm_b32 v108, v52, v44, v116
  v_perm_b32 v109, v53, v45, v116
  v_perm_b32 v110, v54, v46, v116
  v_perm_b32 v111, v55, v47, v116
  v_accvgpr_write_b32 a160, v104
  v_accvgpr_write_b32 a161, v105
  v_accvgpr_write_b32 a162, v106
  v_accvgpr_write_b32 a163, v107
  v_accvgpr_write_b32 a164, v108
  v_accvgpr_write_b32 a165, v109
  v_accvgpr_write_b32 a166, v110
  v_accvgpr_write_b32 a167, v111
  ds_read_b32 v72, v126 offset:0
  ds_read_b32 v73, v126 offset:128
  ds_read_b32 v74, v126 offset:256
  ds_read_b32 v75, v126 offset:384
  ds_read_b32 v76, v126 offset:4096
  ds_read_b32 v77, v126 offset:4224
  ds_read_b32 v78, v126 offset:4352
  ds_read_b32 v79, v126 offset:4480
  ds_read_b32 v80, v126 offset:1024
  ds_read_b32 v81, v126 offset:1152
  ds_read_b32 v82, v126 offset:1280
  ds_read_b32 v83, v126 offset:1408
  ds_read_b32 v84, v126 offset:5120
  ds_read_b32 v85, v126 offset:5248
  ds_read_b32 v86, v126 offset:5376
  ds_read_b32 v87, v126 offset:5504
  s_waitcnt lgkmcnt(15)
  v_perm_b32 v104, v64, v56, v116
  v_perm_b32 v105, v65, v57, v116
  v_perm_b32 v106, v66, v58, v116
  v_perm_b32 v107, v67, v59, v116
  v_perm_b32 v108, v68, v60, v116
  v_perm_b32 v109, v69, v61, v116
  v_perm_b32 v110, v70, v62, v116
  v_perm_b32 v111, v71, v63, v116
  v_accvgpr_write_b32 a176, v104
  v_accvgpr_write_b32 a177, v105
  v_accvgpr_write_b32 a178, v106
  v_accvgpr_write_b32 a179, v107
  v_accvgpr_write_b32 a180, v108
  v_accvgpr_write_b32 a181, v109
  v_accvgpr_write_b32 a182, v110
  v_accvgpr_write_b32 a183, v111
  ds_read_b32 v88, v127 offset:0
  ds_read_b32 v89, v127 offset:128
  ds_read_b32 v90, v127 offset:256
  ds_read_b32 v91, v127 offset:384
  ds_read_b32 v92, v127 offset:4096
  ds_read_b32 v93, v127 offset:4224
  ds_read_b32 v94, v127 offset:4352
  ds_read_b32 v95, v127 offset:4480
  ds_read_b32 v96, v127 offset:1024
  ds_read_b32 v97, v127 offset:1152
  ds_read_b32 v98, v127 offset:1280
  ds_read_b32 v99, v127 offset:1408
  ds_read_b32 v100, v127 offset:5120
  ds_read_b32 v101, v127 offset:5248
  ds_read_b32 v102, v127 offset:5376
  ds_read_b32 v103, v127 offset:5504
  s_waitcnt lgkmcnt(15)
  v_perm_b32 v104, v80, v72, v116
  v_perm_b32 v105, v81, v73, v116
  v_perm_b32 v106, v82, v74, v116
  v_perm_b32 v107, v83, v75, v116
  v_perm_b32 v108, v84, v76, v116
  v_perm_b32 v109, v85, v77, v116
  v_perm_b32 v110, v86, v78, v116
  v_perm_b32 v111, v87, v79, v116
  v_accvgpr_write_b32 a192, v104
  v_accvgpr_write_b32 a193, v105
  v_accvgpr_write_b32 a194, v106
  v_accvgpr_write_b32 a195, v107
  v_accvgpr_write_b32 a196, v108
  v_accvgpr_write_b32 a197, v109
  v_accvgpr_write_b32 a198, v110
  v_accvgpr_write_b32 a199, v111
  s_waitcnt lgkmcnt(0)
  v_perm_b32 v104, v96, v88, v116
  v_perm_b32 v105, v97, v89, v116
  v_perm_b32 v106, v98, v90, v116
  v_perm_b32 v107, v99, v91, v116
  v_perm_b32 v108, v100, v92, v116
  v_perm_b32 v109, v101, v93, v116
  v_perm_b32 v110, v102, v94, v116
  v_perm_b32 v111, v103, v95, v116
  v_accvgpr_write_b32 a208, v104
  v_accvgpr_write_b32 a209, v105
  v_accvgpr_write_b32 a210, v106
  v_accvgpr_write_b32 a211, v107
  v_accvgpr_write_b32 a212, v108
  v_accvgpr_write_b32 a213, v109
  v_accvgpr_write_b32 a214, v110
  v_accvgpr_write_b32 a215, v111
  s_waitcnt vmcnt(12)
  s_waitcnt lgkmcnt(0)
  s_barrier
  s_add_u32 m0, s65, 32768
  s_add_u32 s23, s64, 512
  buffer_load_dwordx4 v113, s[12:15], s23 offen  lds
  s_add_u32 m0, s65, 33792
  s_add_u32 s23, s64, 5632
  buffer_load_dwordx4 v113, s[12:15], s23 offen  lds
  s_add_u32 m0, s65, 34816
  s_add_u32 s23, s64, 10752
  buffer_load_dwordx4 v113, s[12:15], s23 offen  lds
  s_add_u32 m0, s65, 35840
  s_add_u32 s23, s64, 15872
  buffer_load_dwordx4 v113, s[12:15], s23 offen  lds
  v_add_u32 v124, 65536, v117
  v_add_u32 v125, 65536, v118
  v_add_u32 v126, 65536, v119
  v_add_u32 v127, 65536, v120
  ds_read_b32 v40, v124 offset:0
  ds_read_b32 v41, v124 offset:128
  ds_read_b32 v42, v124 offset:256
  ds_read_b32 v43, v124 offset:384
  ds_read_b32 v44, v124 offset:4096
  ds_read_b32 v45, v124 offset:4224
  ds_read_b32 v46, v124 offset:4352
  ds_read_b32 v47, v124 offset:4480
  ds_read_b32 v48, v124 offset:1024
  ds_read_b32 v49, v124 offset:1152
  ds_read_b32 v50, v124 offset:1280
  ds_read_b32 v51, v124 offset:1408
  ds_read_b32 v52, v124 offset:5120
  ds_read_b32 v53, v124 offset:5248
  ds_read_b32 v54, v124 offset:5376
  ds_read_b32 v55, v124 offset:5504
  ds_read_b32 v56, v125 offset:0
  ds_read_b32 v57, v125 offset:128
  ds_read_b32 v58, v125 offset:256
  ds_read_b32 v59, v125 offset:384
  ds_read_b32 v60, v125 offset:4096
  ds_read_b32 v61, v125 offset:4224
  ds_read_b32 v62, v125 offset:4352
  ds_read_b32 v63, v125 offset:4480
  ds_read_b32 v64, v125 offset:1024
  ds_read_b32 v65, v125 offset:1152
  ds_read_b32 v66, v125 offset:1280
  ds_read_b32 v67, v125 offset:1408
  ds_read_b32 v68, v125 offset:5120
  ds_read_b32 v69, v125 offset:5248
  ds_read_b32 v70, v125 offset:5376
  ds_read_b32 v71, v125 offset:5504
  s_waitcnt lgkmcnt(15)
  v_perm_b32 v104, v48, v40, v116
  v_perm_b32 v105, v49, v41, v116
  v_perm_b32 v106, v50, v42, v116
  v_perm_b32 v107, v51, v43, v116
  v_perm_b32 v108, v52, v44, v116
  v_perm_b32 v109, v53, v45, v116
  v_perm_b32 v110, v54, v46, v116
  v_perm_b32 v111, v55, v47, v116
  v_accvgpr_write_b32 a168, v104
  v_accvgpr_write_b32 a169, v105
  v_accvgpr_write_b32 a170, v106
  v_accvgpr_write_b32 a171, v107
  v_accvgpr_write_b32 a172, v108
  v_accvgpr_write_b32 a173, v109
  v_accvgpr_write_b32 a174, v110
  v_accvgpr_write_b32 a175, v111
  ds_read_b32 v72, v126 offset:0
  ds_read_b32 v73, v126 offset:128
  ds_read_b32 v74, v126 offset:256
  ds_read_b32 v75, v126 offset:384
  ds_read_b32 v76, v126 offset:4096
  ds_read_b32 v77, v126 offset:4224
  ds_read_b32 v78, v126 offset:4352
  ds_read_b32 v79, v126 offset:4480
  ds_read_b32 v80, v126 offset:1024
  ds_read_b32 v81, v126 offset:1152
  ds_read_b32 v82, v126 offset:1280
  ds_read_b32 v83, v126 offset:1408
  ds_read_b32 v84, v126 offset:5120
  ds_read_b32 v85, v126 offset:5248
  ds_read_b32 v86, v126 offset:5376
  ds_read_b32 v87, v126 offset:5504
  s_waitcnt lgkmcnt(15)
  v_perm_b32 v104, v64, v56, v116
  v_perm_b32 v105, v65, v57, v116
  v_perm_b32 v106, v66, v58, v116
  v_perm_b32 v107, v67, v59, v116
  v_perm_b32 v108, v68, v60, v116
  v_perm_b32 v109, v69, v61, v116
  v_perm_b32 v110, v70, v62, v116
  v_perm_b32 v111, v71, v63, v116
  v_accvgpr_write_b32 a184, v104
  v_accvgpr_write_b32 a185, v105
  v_accvgpr_write_b32 a186, v106
  v_accvgpr_write_b32 a187, v107
  v_accvgpr_write_b32 a188, v108
  v_accvgpr_write_b32 a189, v109
  v_accvgpr_write_b32 a190, v110
  v_accvgpr_write_b32 a191, v111
  ds_read_b32 v88, v127 offset:0
  ds_read_b32 v89, v127 offset:128
  ds_read_b32 v90, v127 offset:256
  ds_read_b32 v91, v127 offset:384
  ds_read_b32 v92, v127 offset:4096
  ds_read_b32 v93, v127 offset:4224
  ds_read_b32 v94, v127 offset:4352
  ds_read_b32 v95, v127 offset:4480
  ds_read_b32 v96, v127 offset:1024
  ds_read_b32 v97, v127 offset:1152
  ds_read_b32 v98, v127 offset:1280
  ds_read_b32 v99, v127 offset:1408
  ds_read_b32 v100, v127 offset:5120
  ds_read_b32 v101, v127 offset:5248
  ds_read_b32 v102, v127 offset:5376
  ds_read_b32 v103, v127 offset:5504
  s_waitcnt lgkmcnt(15)
  v_perm_b32 v104, v80, v72, v116
  v_perm_b32 v105, v81, v73, v116
  v_perm_b32 v106, v82, v74, v116
  v_perm_b32 v107, v83, v75, v116
  v_perm_b32 v108, v84, v76, v116
  v_perm_b32 v109, v85, v77, v116
  v_perm_b32 v110, v86, v78, v116
  v_perm_b32 v111, v87, v79, v116
  v_accvgpr_write_b32 a200, v104
  v_accvgpr_write_b32 a201, v105
  v_accvgpr_write_b32 a202, v106
  v_accvgpr_write_b32 a203, v107
  v_accvgpr_write_b32 a204, v108
  v_accvgpr_write_b32 a205, v109
  v_accvgpr_write_b32 a206, v110
  v_accvgpr_write_b32 a207, v111
  s_waitcnt lgkmcnt(0)
  v_perm_b32 v104, v96, v88, v116
  v_perm_b32 v105, v97, v89, v116
  v_perm_b32 v106, v98, v90, v116
  v_perm_b32 v107, v99, v91, v116
  v_perm_b32 v108, v100, v92, v116
  v_perm_b32 v109, v101, v93, v116
  v_perm_b32 v110, v102, v94, v116
  v_perm_b32 v111, v103, v95, v116
  v_accvgpr_write_b32 a216, v104
  v_accvgpr_write_b32 a217, v105
  v_accvgpr_write_b32 a218, v106
  v_accvgpr_write_b32 a219, v107
  v_accvgpr_write_b32 a220, v108
  v_accvgpr_write_b32 a221, v109
  v_accvgpr_write_b32 a222, v110
  v_accvgpr_write_b32 a223, v111
  s_waitcnt vmcnt(12)
  s_waitcnt lgkmcnt(0)
  s_barrier
  s_add_u32 m0, s65, 65536
  s_add_u32 s23, s64, 768
  buffer_load_dwordx4 v113, s[12:15], s23 offen  lds
  s_add_u32 m0, s65, 66560
  s_add_u32 s23, s64, 5888
  buffer_load_dwordx4 v113, s[12:15], s23 offen  lds
  s_add_u32 m0, s65, 67584
  s_add_u32 s23, s64, 11008
  buffer_load_dwordx4 v113, s[12:15], s23 offen  lds
  s_add_u32 m0, s65, 68608
  s_add_u32 s23, s64, 16128
  buffer_load_dwordx4 v113, s[12:15], s23 offen  lds
  v_add_u32 v124, 98304, v114
  v_add_u32 v125, 106496, v114
  ds_read_b32 v40, v124 offset:0
  ds_read_b32 v41, v124 offset:128
  ds_read_b32 v42, v124 offset:256
  ds_read_b32 v43, v124 offset:384
  ds_read_b32 v44, v124 offset:4096
  ds_read_b32 v45, v124 offset:4224
  ds_read_b32 v46, v124 offset:4352
  ds_read_b32 v47, v124 offset:4480
  ds_read_b32 v48, v124 offset:1024
  ds_read_b32 v49, v124 offset:1152
  ds_read_b32 v50, v124 offset:1280
  ds_read_b32 v51, v124 offset:1408
  ds_read_b32 v52, v124 offset:5120
  ds_read_b32 v53, v124 offset:5248
  ds_read_b32 v54, v124 offset:5376
  ds_read_b32 v55, v124 offset:5504
  ds_read_b32 v56, v125 offset:0
  ds_read_b32 v57, v125 offset:128
  ds_read_b32 v58, v125 offset:256
  ds_read_b32 v59, v125 offset:384
  ds_read_b32 v60, v125 offset:4096
  ds_read_b32 v61, v125 offset:4224
  ds_read_b32 v62, v125 offset:4352
  ds_read_b32 v63, v125 offset:4480
  ds_read_b32 v64, v125 offset:1024
  ds_read_b32 v65, v125 offset:1152
  ds_read_b32 v66, v125 offset:1280
  ds_read_b32 v67, v125 offset:1408
  ds_read_b32 v68, v125 offset:5120
  ds_read_b32 v69, v125 offset:5248
  ds_read_b32 v70, v125 offset:5376
  ds_read_b32 v71, v125 offset:5504
  s_waitcnt lgkmcnt(15)
  v_perm_b32 v104, v48, v40, v116
  v_perm_b32 v105, v49, v41, v116
  v_perm_b32 v106, v50, v42, v116
  v_perm_b32 v107, v51, v43, v116
  v_perm_b32 v108, v52, v44, v116
  v_perm_b32 v109, v53, v45, v116
  v_perm_b32 v110, v54, v46, v116
  v_perm_b32 v111, v55, v47, v116
  v_accvgpr_write_b32 a224, v104
  v_accvgpr_write_b32 a225, v105
  v_accvgpr_write_b32 a226, v106
  v_accvgpr_write_b32 a227, v107
  v_accvgpr_write_b32 a228, v108
  v_accvgpr_write_b32 a229, v109
  v_accvgpr_write_b32 a230, v110
  v_accvgpr_write_b32 a231, v111
  s_waitcnt lgkmcnt(0)
  v_perm_b32 v104, v64, v56, v116
  v_perm_b32 v105, v65, v57, v116
  v_perm_b32 v106, v66, v58, v116
  v_perm_b32 v107, v67, v59, v116
  v_perm_b32 v108, v68, v60, v116
  v_perm_b32 v109, v69, v61, v116
  v_perm_b32 v110, v70, v62, v116
  v_perm_b32 v111, v71, v63, v116
  v_accvgpr_write_b32 a232, v104
  v_accvgpr_write_b32 a233, v105
  v_accvgpr_write_b32 a234, v106
  v_accvgpr_write_b32 a235, v107
  v_accvgpr_write_b32 a236, v108
  v_accvgpr_write_b32 a237, v109
  v_accvgpr_write_b32 a238, v110
  v_accvgpr_write_b32 a239, v111
  s_waitcnt vmcnt(12)
  s_waitcnt lgkmcnt(0)
  s_barrier
  s_add_u32 m0, s65, 98304
  s_add_u32 s23, s64, 1024
  buffer_load_dwordx4 v113, s[12:15], s23 offen  lds
  s_add_u32 m0, s65, 99328
  s_add_u32 s23, s64, 6144
  buffer_load_dwordx4 v113, s[12:15], s23 offen  lds
  s_add_u32 m0, s65, 100352
  s_add_u32 s23, s64, 11264
  buffer_load_dwordx4 v113, s[12:15], s23 offen  lds
  s_add_u32 m0, s65, 101376
  s_add_u32 s23, s64, 16384
  buffer_load_dwordx4 v113, s[12:15], s23 offen  lds
  v_add_u32 v124, 131072, v115
  ds_read_b32 a240, v124 offset:0
  ds_read_b32 a241, v124 offset:256
  ds_read_b32 a242, v124 offset:512
  ds_read_b32 a243, v124 offset:768
  ds_read_b32 a244, v124 offset:4096
  ds_read_b32 a245, v124 offset:4352
  ds_read_b32 a246, v124 offset:4608
  ds_read_b32 a247, v124 offset:4864
  ds_read_b32 a248, v124 offset:8192
  ds_read_b32 a249, v124 offset:8448
  ds_read_b32 a250, v124 offset:8704
  ds_read_b32 a251, v124 offset:8960
  ds_read_b32 a252, v124 offset:12288
  ds_read_b32 a253, v124 offset:12544
  ds_read_b32 a254, v124 offset:12800
  ds_read_b32 a255, v124 offset:13056
  s_waitcnt vmcnt(12)
  s_waitcnt lgkmcnt(0)
  s_barrier
  v_add_u32 v124, 0, v115
  ds_read_b32 v192, v124 offset:0
  ds_read_b32 v193, v124 offset:256
  ds_read_b32 v194, v124 offset:512
  ds_read_b32 v195, v124 offset:768
  ds_read_b32 v196, v124 offset:4096
  ds_read_b32 v197, v124 offset:4352
  ds_read_b32 v198, v124 offset:4608
  ds_read_b32 v199, v124 offset:4864
  ds_read_b32 v200, v124 offset:8192
  ds_read_b32 v201, v124 offset:8448
  ds_read_b32 v202, v124 offset:8704
  ds_read_b32 v203, v124 offset:8960
  ds_read_b32 v204, v124 offset:12288
  ds_read_b32 v205, v124 offset:12544
  ds_read_b32 v206, v124 offset:12800
  ds_read_b32 v207, v124 offset:13056
  s_waitcnt vmcnt(8)
  s_waitcnt lgkmcnt(0)
  s_barrier
  v_add_u32 v124, 32768, v115
  ds_read_b32 v208, v124 offset:0
  ds_read_b32 v209, v124 offset:256
  ds_read_b32 v210, v124 offset:512
  ds_read_b32 v211, v124 offset:768
  ds_read_b32 v212, v124 offset:4096
  ds_read_b32 v213, v124 offset:4352
  ds_read_b32 v214, v124 offset:4608
  ds_read_b32 v215, v124 offset:4864
  ds_read_b32 v216, v124 offset:8192
  ds_read_b32 v217, v124 offset:8448
  ds_read_b32 v218, v124 offset:8704
  ds_read_b32 v219, v124 offset:8960
  ds_read_b32 v220, v124 offset:12288
  ds_read_b32 v221, v124 offset:12544
  ds_read_b32 v222, v124 offset:12800
  ds_read_b32 v223, v124 offset:13056
  s_waitcnt vmcnt(4)
  s_waitcnt lgkmcnt(0)
  s_barrier
  v_add_u32 v124, 65536, v115
  ds_read_b32 v224, v124 offset:0
  ds_read_b32 v225, v124 offset:256
  ds_read_b32 v226, v124 offset:512
  ds_read_b32 v227, v124 offset:768
  ds_read_b32 v228, v124 offset:4096
  ds_read_b32 v229, v124 offset:4352
  ds_read_b32 v230, v124 offset:4608
  ds_read_b32 v231, v124 offset:4864
  ds_read_b32 v232, v124 offset:8192
  ds_read_b32 v233, v124 offset:8448
  ds_read_b32 v234, v124 offset:8704
  ds_read_b32 v235, v124 offset:8960
  ds_read_b32 v236, v124 offset:12288
  ds_read_b32 v237, v124 offset:12544
  ds_read_b32 v238, v124 offset:12800
  ds_read_b32 v239, v124 offset:13056
  s_waitcnt vmcnt(0)
  s_waitcnt lgkmcnt(0)
  s_barrier
  v_add_u32 v124, 98304, v115
  ds_read_b32 v240, v124 offset:0
  ds_read_b32 v241, v124 offset:256
  ds_read_b32 v242, v124 offset:512
  ds_read_b32 v243, v124 offset:768
  ds_read_b32 v244, v124 offset:4096
  ds_read_b32 v245, v124 offset:4352
  ds_read_b32 v246, v124 offset:4608
  ds_read_b32 v247, v124 offset:4864
  ds_read_b32 v248, v124 offset:8192
  ds_read_b32 v249, v124 offset:8448
  ds_read_b32 v250, v124 offset:8704
  ds_read_b32 v251, v124 offset:8960
  ds_read_b32 v252, v124 offset:12288
  ds_read_b32 v253, v124 offset:12544
  ds_read_b32 v254, v124 offset:12800
  ds_read_b32 v255, v124 offset:13056
  s_waitcnt vmcnt(0) lgkmcnt(0)
  s_barrier
  v_mov_b32 v24, 48
  s_mov_b32 s22, 0
  s_mov_b64 exec, 1
L_tw_poll:
  global_load_dwordx4 v[28:31], v24, s[16:17] sc1
  s_add_u32 s22, s22, 1
  s_cmp_gt_u32 s22, 200000
  s_cbranch_scc1 L_fail
  s_waitcnt vmcnt(0)
  v_readfirstlane_b32 s23, v29
  v_readfirstlane_b32 s62, v30
  v_readfirstlane_b32 s63, v31
  s_cmp_lt_u32 s23, 64
  s_cbranch_scc1 L_tw_poll
  s_and_b32 s23, s62, s63
  s_bitcmp1_b32 s23, 0
  s_cbranch_scc1 L_tw_have
  s_sleep 8
  s_cmp_lt_u32 s22, 60
  s_cbranch_scc1 L_tw_poll
  v_mov_b32 v26, 1
  v_mov_b32 v27, 0
  global_atomic_cmpswap v28, v24, v[26:27], s[16:17] offset:8 sc0 sc1
  global_atomic_cmpswap v29, v24, v[26:27], s[16:17] offset:12 sc0 sc1
  s_waitcnt vmcnt(0)
  v_readfirstlane_b32 s62, v28
  v_readfirstlane_b32 s63, v29
L_tw_have:
  s_mov_b64 exec, -1
  s_and_b32 s62, s62, 0x2000
  s_and_b32 s63, s63, 0x2000
  s_cmp_eq_u32 s24, 0
  s_cselect_b32 s23, s62, s63
  s_cselect_b32 s62, s63, s62
  s_add_u32 s45, s45, s23
  s_add_u32 s43, s43, s62
  s_lshl_b32 s23, s20, 8
  v_add_u32 v50, s23, v22
  s_lshl_b32 s67, s20, 11
  s_mov_b32 s60, 24576
  s_mov_b32 s61, 24576
  s_min_u32 s62, s76, 63
  s_sub_u32 s23, s62, 18
  s_lshr_b32 s23, s23, 2
  s_add_u32 s78, s23, 12
  s_add_u32 s23, s62, 6
  s_lshr_b32 s23, s23, 1
  s_cmp_lt_u32 s62, 18
  s_cselect_b32 s78, s23, s78
  s_cmp_lt_u32 s62, 6
  s_cselect_b32 s78, s62, s78
  s_add_u32 s76, s76, 1
  s_bitcmp1_b32 s77, s78
  s_cbranch_scc1 L_kvr1_ok
  s_mov_b32 s22, 0
L_kvr1:
  global_load_dword v190, v191, s[16:17] sc1
  s_add_u32 s22, s22, 1
  s_cmp_gt_u32 s22, 200000
  s_cbranch_scc1 L_fail
  s_waitcnt vmcnt(0)
  v_cmp_le_u32 vcc, 32, v190
  s_nop 3
  s_mov_b32 s77, vcc_lo
  s_bitcmp1_b32 s77, s78
  s_cbranch_scc1 L_kvr1_ok
  s_sleep 4
  s_branch L_kvr1
L_kvr1_ok:
  s_min_u32 s62, s76, 63
  s_sub_u32 s23, s62, 18
  s_lshr_b32 s23, s23, 2
  s_add_u32 s78, s23, 12
  s_add_u32 s23, s62, 6
  s_lshr_b32 s23, s23, 1
  s_cmp_lt_u32 s62, 18
  s_cselect_b32 s78, s23, s78
  s_cmp_lt_u32 s62, 6
  s_cselect_b32 s78, s62, s78
  s_add_u32 s76, s76, 1
  s_bitcmp1_b32 s77, s78
  s_cbranch_scc1 L_kvr2_ok
  s_mov_b32 s22, 0
L_kvr2:
  global_load_dword v190, v191, s[16:17] sc1
  s_add_u32 s22, s22, 1
  s_cmp_gt_u32 s22, 200000
  s_cbranch_scc1 L_fail
  s_waitcnt vmcnt(0)
  v_cmp_le_u32 vcc, 32, v190
  s_nop 3
  s_mov_b32 s77, vcc_lo
  s_bitcmp1_b32 s77, s78
  s_cbranch_scc1 L_kvr2_ok
  s_sleep 4
  s_branch L_kvr2
L_kvr2_ok:
  s_cmp_eq_u32 s20, 3
  s_cbranch_scc1 L_pro3
  s_lshl_b32 s23, s67, 1
  s_add_u32 m0, s23, s60
  s_add_u32 s60, s60, 12288
  buffer_load_dwordx4 v0, s[4:7], s28 offen offset:0 sc1 lds
  buffer_load_dwordx4 v0, s[4:7], s28 offen offset:1024 sc1 lds
  buffer_load_dwordx4 v0, s[4:7], s28 offen offset:2048 sc1 lds
  buffer_load_dwordx4 v0, s[4:7], s28 offen offset:3072 sc1 lds
  s_cmp_eq_u32 s60, 73728
  s_cselect_b32 s60, 24576, s60
  s_add_u32 s28, s28, 262144
  s_lshl_b32 s23, s67, 1
  s_add_u32 m0, s23, s60
  s_add_u32 s60, s60, 12288
  buffer_load_dwordx4 v0, s[4:7], s28 offen offset:0 sc1 lds
  buffer_load_dwordx4 v0, s[4:7], s28 offen offset:1024 sc1 lds
  buffer_load_dwordx4 v0, s[4:7], s28 offen offset:2048 sc1 lds
  buffer_load_dwordx4 v0, s[4:7], s28 offen offset:3072 sc1 lds
  s_cmp_eq_u32 s60, 73728
  s_cselect_b32 s60, 24576, s60
  s_add_u32 s28, s28, 262144
L_pro3:
  s_load_dwordx2 s[8:9], s[0:1], 8
  s_waitcnt lgkmcnt(0)
  s_and_b32 s9, s9, 0xffff
  s_mov_b32 s10, 10240
  s_mov_b32 s11, 0x00020000
  s_movk_i32 s23, 1280
  v_bfe_u32 v24, v10, 4, 3
  v_mul_lo_u32 v24, v24, s23
  v_lshrrev_b32 v25, 7, v10
  v_lshl_add_u32 v24, v25, 4, v24
  buffer_load_dwordx4 v[40:43], v24, s[8:11], 0 offen
  buffer_load_dwordx4 v[44:47], v24, s[8:11], 0 offen offset:512
  v_bfe_u32 v26, v11, 4, 3
  v_mul_lo_u32 v26, v26, s23
  v_lshrrev_b32 v25, 7, v11
  v_lshl_add_u32 v26, v25, 4, v26
  v_and_b32 v25, 8, v11
  v_add_u32 v26, v26, v25
  buffer_load_dwordx2 v[48:49], v26, s[8:11], 0 offen offset:1024
  v_mov_b64 v[28:29], 0
  v_mov_b64 v[30:31], 0
  v_mov_b64 v[32:33], 0
  v_mov_b64 v[34:35], 0
  v_mov_b64 v[36:37], 0
  v_mov_b64 v[38:39], 0
  v_mov_b64 v[104:105], 0
  v_mov_b64 v[106:107], 0
  v_mov_b64 v[108:109], 0
  v_mov_b64 v[110:111], 0
  v_mov_b64 v[112:113], 0
  s_waitcnt vmcnt(0) lgkmcnt(0)
  v_lshlrev_b32 v84, 16, v40
  v_and_b32 v85, 0xFFFF0000, v40
  v_lshlrev_b32 v86, 16, v41
  v_and_b32 v87, 0xFFFF0000, v41
  v_lshlrev_b32 v88, 16, v42
  v_and_b32 v89, 0xFFFF0000, v42
  v_lshlrev_b32 v90, 16, v43
  v_and_b32 v91, 0xFFFF0000, v43
  v_lshlrev_b32 v92, 16, v44
  v_and_b32 v93, 0xFFFF0000, v44
  v_lshlrev_b32 v94, 16, v45
  v_and_b32 v95, 0xFFFF0000, v45
  v_lshlrev_b32 v96, 16, v46
  v_and_b32 v97, 0xFFFF0000, v46
  v_lshlrev_b32 v98, 16, v47
  v_and_b32 v99, 0xFFFF0000, v47
  v_lshlrev_b32 v100, 16, v48
  v_and_b32 v101, 0xFFFF0000, v48
  v_lshlrev_b32 v102, 16, v49
  v_and_b32 v103, 0xFFFF0000, v49
  s_min_u32 s62, s76, 63
  s_sub_u32 s23, s62, 18
  s_lshr_b32 s23, s23, 2
  s_add_u32 s78, s23, 12
  s_add_u32 s23, s62, 6
  s_lshr_b32 s23, s23, 1
  s_cmp_lt_u32 s62, 18
  s_cselect_b32 s78, s23, s78
  s_cmp_lt_u32 s62, 6
  s_cselect_b32 s78, s62, s78
  s_add_u32 s76, s76, 1
  s_bitcmp1_b32 s77, s78
  s_cbranch_scc1 L_kvr3_ok
  s_mov_b32 s22, 0
L_kvr3:
  global_load_dword v190, v191, s[16:17] sc1
  s_add_u32 s22, s22, 1
  s_cmp_gt_u32 s22, 200000
  s_cbranch_scc1 L_fail
  s_waitcnt vmcnt(0)
  v_cmp_le_u32 vcc, 32, v190
  s_nop 3
  s_mov_b32 s77, vcc_lo
  s_bitcmp1_b32 s77, s78
  s_cbranch_scc1 L_kvr3_ok
  s_sleep 4
  s_branch L_kvr3
L_kvr3_ok:
L_loop:
  v_dot2_f32_bf16 v84, v104, v3, v84
  v_dot2_f32_bf16 v85, v104, v18, v85
  v_dot2_f32_bf16 v86, v105, v3, v86
  v_dot2_f32_bf16 v87, v105, v18, v87
  v_dot2_f32_bf16 v88, v106, v3, v88
  v_dot2_f32_bf16 v89, v106, v18, v89
  v_dot2_f32_bf16 v90, v107, v3, v90
  v_dot2_f32_bf16 v91, v107, v18, v91
  v_dot2_f32_bf16 v92, v108, v3, v92
  v_dot2_f32_bf16 v93, v108, v18, v93
  v_dot2_f32_bf16 v94, v109, v3, v94
  v_dot2_f32_bf16 v95, v109, v18, v95
  v_cvt_pk_bf16_f32 v40, v84, v85
  v_cvt_pk_bf16_f32 v41, v86, v87
  v_cvt_pk_bf16_f32 v42, v88, v89
  v_cvt_pk_bf16_f32 v43, v90, v91
  ds_write_b128 v10, v[40:43] offset:0
  v_dot2_f32_bf16 v96, v110, v3, v96
  v_dot2_f32_bf16 v97, v110, v18, v97
  v_dot2_f32_bf16 v98, v111, v3, v98
  v_dot2_f32_bf16 v99, v111, v18, v99
  v_dot2_f32_bf16 v100, v112, v3, v100
  v_dot2_f32_bf16 v101, v112, v18, v101
  v_dot2_f32_bf16 v102, v113, v3, v102
  v_dot2_f32_bf16 v103, v113, v18, v103
  v_smfmac_f32_16x16x64_bf16 v[28:31], v[40:43], a[0:7], v7
  v_cvt_pk_bf16_f32 v44, v92, v93
  v_cvt_pk_bf16_f32 v45, v94, v95
  v_cvt_pk_bf16_f32 v46, v96, v97
  v_cvt_pk_bf16_f32 v47, v98, v99
  ds_write_b128 v10, v[44:47] offset:4096
  v_smfmac_f32_16x16x64_bf16 v[32:35], v[40:43], a[80:87], v7
  v_cvt_pk_bf16_f32 v48, v100, v101
  v_cvt_pk_bf16_f32 v49, v102, v103
  ds_write_b64 v11, v[48:49] offset:8192
  v_smfmac_f32_16x16x64_bf16 v[28:31], v[44:47], a[8:15], v7
  v_smfmac_f32_16x16x64_bf16 v[32:35], v[44:47], a[88:95], v7
  s_lshl_b32 s23, s26, 12
  s_add_u32 s62, s23, s61
  v_add_u32 v19, s62, v0
  s_waitcnt lgkmcnt(0)
  s_barrier
  ds_read_b128 v[52:55], v180 offset:0
  ds_read_b128 v[56:59], v180 offset:4096
  ds_read_b128 v[60:63], v181 offset:0
  ds_read_b128 v[64:67], v181 offset:4096
  ds_read_b128 v[68:71], v182 offset:0
  ds_read_b128 v[72:75], v182 offset:4096
  ds_read_b128 v[76:79], v0 offset:8192
  ds_read_b128 v[80:83], v0 offset:9216
  v_smfmac_f32_16x16x64_bf16 v[36:39], v[40:43], a[160:167], v7
  s_xor_b32 s23, s23, 0x1000
  s_add_u32 s62, s23, s61
  v_add_u32 v20, s62, v0
  v_smfmac_f32_16x16x64_bf16 v[36:39], v[44:47], a[168:175], v7
  s_lshr_b32 s23, s67, 1
  s_add_u32 s62, s23, s61
  v_add_u32 v21, s62, v0
  s_waitcnt lgkmcnt(7)
  v_smfmac_f32_16x16x64_bf16 v[28:31], v[52:55], a[16:23], v7
  ds_read_b128 v[84:87], v19 offset:0
  v_smfmac_f32_16x16x64_bf16 v[32:35], v[52:55], a[96:103], v7
  s_waitcnt lgkmcnt(7)
  v_smfmac_f32_16x16x64_bf16 v[28:31], v[56:59], a[24:31], v7
  ds_read_b128 v[88:91], v19 offset:1024
  v_smfmac_f32_16x16x64_bf16 v[32:35], v[56:59], a[104:111], v7
  s_waitcnt lgkmcnt(7)
  v_smfmac_f32_16x16x64_bf16 v[28:31], v[60:63], a[32:39], v7
  ds_read_b128 v[92:95], v19 offset:2048
  v_smfmac_f32_16x16x64_bf16 v[32:35], v[60:63], a[112:119], v7
  s_waitcnt lgkmcnt(7)
  v_smfmac_f32_16x16x64_bf16 v[28:31], v[64:67], a[40:47], v7
  ds_read_b128 v[96:99], v19 offset:3072
  v_smfmac_f32_16x16x64_bf16 v[32:35], v[64:67], a[120:127], v7
  s_waitcnt lgkmcnt(7)
  v_smfmac_f32_16x16x64_bf16 v[28:31], v[68:71], a[48:55], v7
  ds_read_b128 v[100:103], v20 offset:0
  v_smfmac_f32_16x16x64_bf16 v[32:35], v[68:71], a[128:135], v7
  s_waitcnt lgkmcnt(7)
  v_smfmac_f32_16x16x64_bf16 v[28:31], v[72:75], a[56:63], v7
  s_waitcnt vmcnt(0)
  ds_read_b128 v[104:107], v20 offset:1024
  v_smfmac_f32_16x16x64_bf16 v[32:35], v[72:75], a[136:143], v7
  s_waitcnt lgkmcnt(7)
  v_smfmac_f32_16x16x64_bf16 v[28:31], v[76:79], a[64:71], v7
  ds_read_b128 v[108:111], v20 offset:2048
  v_smfmac_f32_16x16x64_bf16 v[32:35], v[76:79], a[144:151], v7
  s_waitcnt lgkmcnt(7)
  v_smfmac_f32_16x16x64_bf16 v[28:31], v[80:83], a[72:79], v7
  ds_read_b128 v[112:115], v20 offset:3072
  v_smfmac_f32_16x16x64_bf16 v[32:35], v[80:83], a[152:159], v7
  v_smfmac_f32_16x16x64_bf16 v[36:39], v[52:55], a[176:183], v7
  v_smfmac_f32_16x16x64_bf16 v[36:39], v[56:59], a[184:191], v7
  s_nop 5
  v_permlane32_swap_b32 v28, v32
  v_permlane32_swap_b32 v29, v33
  v_permlane32_swap_b32 v30, v34
  v_permlane32_swap_b32 v31, v35
  v_pk_add_f32 v[28:29], v[28:29], v[32:33]
  v_pk_add_f32 v[30:31], v[30:31], v[34:35]
  v_cvt_pk_bf16_f32 v164, v28, v29
  v_cvt_pk_bf16_f32 v165, v30, v31
  ds_read_b128 v[148:151], v21 offset:8192
  s_nop 0
  v_mfma_f32_16x16x16_bf16 v[32:35], v[164:165], v[8:9], 0
  v_smfmac_f32_16x16x64_bf16 v[36:39], v[60:63], a[192:199], v7
  v_smfmac_f32_16x16x64_bf16 v[36:39], v[64:67], a[200:207], v7
  s_nop 5
  v_cvt_pk_bf16_f32 v165, v34, v35
  v_cvt_pk_bf16_f32 v166, v32, v33
  v_and_or_b32 v167, v165, -2, s54
  buffer_store_dwordx2 v[166:167], v12, s[4:7], s46 offen
  v_mov_b32 v164, v166
  ds_write_b64 v12, v[164:165] offset:20480
  v_smfmac_f32_16x16x64_bf16 v[36:39], v[68:71], a[208:215], v7
  v_smfmac_f32_16x16x64_bf16 v[36:39], v[72:75], a[216:223], v7
  s_waitcnt lgkmcnt(0)
  s_barrier
  ds_read_b128 v[116:119], v13 offset:20480
  ds_read_b128 v[120:123], v13 offset:21504
  ds_read_b128 v[124:127], v14 offset:20480
  ds_read_b128 v[128:131], v14 offset:21504
  v_smfmac_f32_16x16x64_bf16 v[36:39], v[76:79], a[224:231], v7
  v_smfmac_f32_16x16x64_bf16 v[36:39], v[80:83], a[232:239], v7
  s_waitcnt lgkmcnt(2)
  s_waitcnt lgkmcnt(0)
  v_mfma_f32_16x16x32_bf16 v[152:155], v[84:87], v[116:119], 0
  v_mfma_f32_16x16x32_bf16 v[156:159], v[88:91], v[116:119], 0
  v_mfma_f32_16x16x32_bf16 v[160:163], v[124:127], v[116:119], 0
  buffer_load_dwordx4 v[132:135], v13, s[4:7], s47 offen sc1
  buffer_load_dwordx4 v[140:143], v14, s[4:7], s47 offen sc1
  buffer_load_dwordx4 v[136:139], v13, s[4:7], s47 offen offset:1024 sc1
  buffer_load_dwordx4 v[144:147], v14, s[4:7], s47 offen offset:1024 sc1
  v_mfma_f32_16x16x32_bf16 v[152:155], v[92:95], v[120:123], v[152:155]
  v_mfma_f32_16x16x32_bf16 v[156:159], v[96:99], v[120:123], v[156:159]
  v_mfma_f32_16x16x32_bf16 v[160:163], v[128:131], v[120:123], v[160:163]
  v_permlane32_swap_b32 v36, v38
  v_permlane32_swap_b32 v37, v39
  v_pk_add_f32 v[36:37], v[36:37], v[38:39]
  v_cvt_pk_bf16_f32 v178, v36, v37
  ds_write_b32 v50, v178 offset:23552
  s_cmp_eq_u32 s21, 63
  s_cbranch_scc1 L_last
  v_mov_b64 v[52:53], 0
  v_mov_b64 v[54:55], 0
  v_mov_b64 v[56:57], 0
  v_mov_b64 v[58:59], 0
  v_mov_b64 v[60:61], 0
  v_mov_b64 v[62:63], 0
  v_mov_b64 v[64:65], 0
  v_mov_b64 v[66:67], 0
  v_mov_b64 v[68:69], 0
  v_mov_b64 v[70:71], 0
  v_mov_b64 v[36:37], 0
  v_mov_b64 v[38:39], 0
  v_mov_b32 v116, 0x3F803F80
  v_mov_b32 v117, 0x3F803F80
  v_mov_b32 v118, 0x3F803F80
  v_mov_b32 v119, 0x3F803F80
  v_mov_b64 v[28:29], 0
  v_mov_b64 v[30:31], 0
  v_mov_b64 v[32:33], 0
  v_mov_b64 v[34:35], 0
  s_add_u32 s61, s61, 12288
  s_cmp_eq_u32 s61, 73728
  s_cselect_b32 s61, 24576, s61
  s_mov_b32 s22, 1
  s_waitcnt vmcnt(3)
  v_xor_b32 v23, s54, v133
  v_bitop3_b32 v23, v23, v135, s54 bitop3:0xF6
  s_waitcnt vmcnt(2)
  v_bitop3_b32 v23, v23, v141, s54 bitop3:0xF6
  v_bitop3_b32 v23, v23, v143, s54 bitop3:0xF6
  s_waitcnt vmcnt(1)
  v_bitop3_b32 v23, v23, v137, s54 bitop3:0xF6
  v_bitop3_b32 v23, v23, v139, s54 bitop3:0xF6
  s_waitcnt vmcnt(0)
  v_bitop3_b32 v23, v23, v145, s54 bitop3:0xF6
  v_bitop3_b32 v23, v23, v147, s54 bitop3:0xF6
  v_and_b32 v23, 1, v23
  v_cmp_ne_u32 vcc, 0, v23
  s_cbranch_vccz L_tok
  s_mov_b32 s22, 0
L_tpoll:
  buffer_load_dwordx4 v[132:135], v13, s[4:7], s47 offen sc1
  buffer_load_dwordx4 v[140:143], v14, s[4:7], s47 offen sc1
  buffer_load_dwordx4 v[136:139], v13, s[4:7], s47 offen offset:1024 sc1
  buffer_load_dwordx4 v[144:147], v14, s[4:7], s47 offen offset:1024 sc1
  s_add_u32 s22, s22, 1
  s_cmp_gt_u32 s22, 200000
  s_cbranch_scc1 L_fail
  s_waitcnt vmcnt(0)
  v_xor_b32 v23, s54, v133
  v_bitop3_b32 v23, v23, v135, s54 bitop3:0xF6
  v_bitop3_b32 v23, v23, v141, s54 bitop3:0xF6
  v_bitop3_b32 v23, v23, v143, s54 bitop3:0xF6
  v_bitop3_b32 v23, v23, v137, s54 bitop3:0xF6
  v_bitop3_b32 v23, v23, v139, s54 bitop3:0xF6
  v_bitop3_b32 v23, v23, v145, s54 bitop3:0xF6
  v_bitop3_b32 v23, v23, v147, s54 bitop3:0xF6
  v_and_b32 v23, 1, v23
  v_cmp_ne_u32 vcc, 0, v23
  s_cbranch_vccnz L_tpoll
L_tok:
  v_mfma_f32_16x16x32_bf16 v[152:155], v[100:103], v[132:135], v[152:155]
  v_mfma_f32_16x16x32_bf16 v[156:159], v[104:107], v[132:135], v[156:159]
  v_mfma_f32_16x16x32_bf16 v[160:163], v[140:143], v[132:135], v[160:163]
  v_mfma_f32_16x16x32_bf16 v[152:155], v[108:111], v[136:139], v[152:155]
  v_mfma_f32_16x16x32_bf16 v[156:159], v[112:115], v[136:139], v[156:159]
  v_mfma_f32_16x16x32_bf16 v[160:163], v[144:147], v[136:139], v[160:163]
  s_cmp_eq_u32 s20, 3
  s_cbranch_scc1 L_so3
  s_lshl_b32 s23, s67, 1
  s_add_u32 m0, s23, s60
  s_add_u32 s60, s60, 12288
  buffer_load_dwordx4 v0, s[4:7], s28 offen offset:0 sc1 lds
  buffer_load_dwordx4 v0, s[4:7], s28 offen offset:1024 sc1 lds
  buffer_load_dwordx4 v0, s[4:7], s28 offen offset:2048 sc1 lds
  buffer_load_dwordx4 v0, s[4:7], s28 offen offset:3072 sc1 lds
  s_cmp_eq_u32 s60, 73728
  s_cselect_b32 s60, 24576, s60
  s_add_u32 s28, s28, 262144
  s_branch L_so_done
L_so3:
  s_cmp_eq_u32 s21, 0
  s_cselect_b32 s62, 0x4190000, s30
  s_cselect_b32 s78, 0x4190000, s31
  s_cselect_b32 s23, 0, 65536
  buffer_store_dwordx4 v[168:171], v0, s[4:7], s62 offen sc1
  buffer_store_dwordx4 v[172:175], v0, s[4:7], s78 offen sc1
  s_add_u32 s30, s30, s23
  s_add_u32 s31, s31, s23
  s_max_u32 s62, s21, 1
  s_sub_u32 s62, s62, 1
  v_mov_b32 v190, s62
  s_mov_b64 exec, 1
  s_add_u32 s23, s79, s80
  buffer_store_dword v190, v22, s[4:7], s23 offen sc1
  s_mov_b64 exec, -1
  s_add_u32 s80, s80, 4096
  s_cmp_eq_u32 s80, 24576
  s_cselect_b32 s80, 0, s80
  buffer_load_dword v26, v22, s[4:7], s47 offen sc1
L_so_done:
  v_mov_b32_dpp v152, v156 row_ror:8 row_mask:0xf bank_mask:0xc
  v_mov_b32_dpp v153, v157 row_ror:8 row_mask:0xf bank_mask:0xc
  v_mov_b32_dpp v154, v158 row_ror:8 row_mask:0xf bank_mask:0xc
  v_mov_b32_dpp v155, v159 row_ror:8 row_mask:0xf bank_mask:0xc
  v_max3_f32 v24, v152, v153, v154
  v_mov_b32_dpp v160, v161 row_ror:8 row_mask:0xf bank_mask:0xc
  v_max3_f32 v24, v24, v155, v160
  s_nop 1
  v_max_f32_dpp v24, v24, v24 row_ror:8 row_mask:0xf bank_mask:0xf
  v_mov_b32 v27, v24
  s_nop 1
  v_permlane16_swap_b32 v24, v27
  v_max_f32 v24, v24, v27
  v_mov_b32 v27, v24
  s_nop 1
  v_permlane32_swap_b32 v24, v27
  v_max_f32 v24, v24, v27
  v_mul_f32 v24, s58, v24
  v_fma_f32 v152, v152, s58, -v24
  v_fma_f32 v153, v153, s58, -v24
  v_fma_f32 v154, v154, s58, -v24
  v_fma_f32 v155, v155, s58, -v24
  v_fma_f32 v160, v160, s58, -v24
  v_exp_f32 v152, v152
  v_exp_f32 v153, v153
  v_exp_f32 v154, v154
  v_exp_f32 v155, v155
  v_exp_f32 v160, v160
  v_cvt_pk_bf16_f32 v172, v152, v153
  v_cvt_pk_bf16_f32 v173, v154, v155
  v_mov_b32_dpp v26, v160 row_ror:8 row_mask:0xf bank_mask:0xf
  v_mov_b32_dpp v174, v172 row_ror:8 row_mask:0xf bank_mask:0xf
  v_mov_b32_dpp v175, v173 row_ror:8 row_mask:0xf bank_mask:0xf
  v_cvt_pk_bf16_f32 v176, v160, v26
  s_nop 0
  v_mfma_f32_16x16x32_bf16 v[152:155], v[116:119], v[172:175], 0
  v_mfma_f32_16x16x16_bf16 v[160:163], v[116:117], v[176:177], 0
  v_mfma_f32_16x16x32_bf16 v[168:171], v[148:151], v[172:175], 0
  v_mfma_f32_16x16x16_bf16 v[156:159], v[178:179], v[176:177], 0
  s_nop 5
  v_add_f32 v24, v152, v160
  v_rcp_f32 v24, v24
  v_pk_add_f32 v[168:169], v[168:169], v[156:157]
  v_pk_add_f32 v[170:171], v[170:171], v[158:159]
  s_mov_b64 exec, s[48:49]
  v_pk_mul_f32 v[168:169], v[168:169], v[24:25] op_sel_hi:[1,0]
  v_pk_mul_f32 v[170:171], v[170:171], v[24:25] op_sel_hi:[1,0]
  v_cvt_pk_bf16_f32 v168, v168, v169
  v_cvt_pk_bf16_f32 v169, v170, v171
  ds_write_b64 v15, v[168:169] offset:22528
  s_mov_b64 exec, -1
  s_waitcnt lgkmcnt(0)
  s_barrier
  ds_read_b128 v[72:75], v1 offset:22528
  ds_read_b128 v[76:79], v1 offset:23040
  s_waitcnt lgkmcnt(1)
  v_smfmac_f32_16x16x64_bf16 v[52:55], v[72:75], a[240:247], v7
  s_waitcnt lgkmcnt(0)
  v_smfmac_f32_16x16x64_bf16 v[52:55], v[76:79], a[248:255], v7
  v_smfmac_f32_16x16x64_bf16 v[56:59], v[72:75], v[192:199], v7
  v_smfmac_f32_16x16x64_bf16 v[56:59], v[76:79], v[200:207], v7
  s_nop 5
  v_cvt_pk_bf16_f32 v52, v52, v53
  v_cvt_pk_bf16_f32 v53, v54, v55
  v_and_or_b32 v53, v53, -2, s54
  buffer_store_dwordx2 v[52:53], v6, s[4:7], s32 offen offset:0
  v_smfmac_f32_16x16x64_bf16 v[60:63], v[72:75], v[208:215], v7
  v_smfmac_f32_16x16x64_bf16 v[60:63], v[76:79], v[216:223], v7
  v_cvt_pk_bf16_f32 v56, v56, v57
  v_cvt_pk_bf16_f32 v57, v58, v59
  v_and_or_b32 v57, v57, -2, s54
  buffer_store_dwordx2 v[56:57], v6, s[4:7], s32 offen offset:512
  v_smfmac_f32_16x16x64_bf16 v[64:67], v[72:75], v[224:231], v7
  v_smfmac_f32_16x16x64_bf16 v[64:67], v[76:79], v[232:239], v7
  s_nop 1
  v_cvt_pk_bf16_f32 v60, v60, v61
  v_cvt_pk_bf16_f32 v61, v62, v63
  v_and_or_b32 v61, v61, -2, s54
  buffer_store_dwordx2 v[60:61], v6, s[4:7], s32 offen offset:1024
  v_smfmac_f32_16x16x64_bf16 v[68:71], v[72:75], v[240:247], v7
  v_smfmac_f32_16x16x64_bf16 v[68:71], v[76:79], v[248:255], v7
  v_cvt_pk_bf16_f32 v64, v64, v65
  v_cvt_pk_bf16_f32 v65, v66, v67
  v_and_or_b32 v65, v65, -2, s54
  buffer_store_dwordx2 v[64:65], v6, s[4:7], s32 offen offset:1536
  s_nop 3
  v_cvt_pk_bf16_f32 v68, v68, v69
  v_cvt_pk_bf16_f32 v69, v70, v71
  v_and_or_b32 v69, v69, -2, s54
  buffer_store_dwordx2 v[68:69], v6, s[4:7], s32 offen offset:2048
  s_cmp_eq_u32 s33, 0
  s_cbranch_scc1 L_red_skip
  s_cmp_eq_u32 s20, 2
  s_cbranch_scc1 L_rs_done
  s_cmp_eq_u32 s20, 1
  s_cbranch_scc1 L_rs_done
  s_sleep 1
L_rs_done:
  s_sleep 4
  s_mov_b32 s22, 0
L_red:
  buffer_load_dwordx2 v[116:117], v4, s[4:7], s34 offen sc1
  buffer_load_dwordx2 v[118:119], v4, s[4:7], s35 offen sc1
  buffer_load_dwordx2 v[120:121], v4, s[4:7], s36 offen sc1
  buffer_load_dwordx2 v[122:123], v4, s[4:7], s37 offen sc1
  buffer_load_dwordx2 v[124:125], v4, s[4:7], s38 offen sc1
  buffer_load_dwordx2 v[126:127], v4, s[4:7], s39 offen sc1
  buffer_load_dwordx2 v[128:129], v4, s[4:7], s40 offen sc1
  buffer_load_dwordx2 v[130:131], v4, s[4:7], s41 offen sc1
  s_add_u32 s22, s22, 1
  s_cmp_gt_u32 s22, 200000
  s_cbranch_scc1 L_fail
  s_waitcnt vmcnt(6)
  v_xor_b32 v23, s54, v117
  v_bitop3_b32 v23, v23, v119, s54 bitop3:0xF6
  v_mfma_f32_16x16x32_bf16 v[152:155], v[116:119], v[184:187], 0
  s_waitcnt vmcnt(4)
  v_bitop3_b32 v23, v23, v121, s54 bitop3:0xF6
  v_bitop3_b32 v23, v23, v123, s54 bitop3:0xF6
  v_mfma_f32_16x16x32_bf16 v[152:155], v[120:123], v[184:187], v[152:155]
  s_waitcnt vmcnt(2)
  v_bitop3_b32 v23, v23, v125, s54 bitop3:0xF6
  v_bitop3_b32 v23, v23, v127, s54 bitop3:0xF6
  v_mfma_f32_16x16x32_bf16 v[152:155], v[124:127], v[184:187], v[152:155]
  s_waitcnt vmcnt(0)
  v_bitop3_b32 v23, v23, v129, s54 bitop3:0xF6
  v_bitop3_b32 v23, v23, v131, s54 bitop3:0xF6
  v_mfma_f32_16x16x32_bf16 v[152:155], v[128:131], v[184:187], v[152:155]
  v_and_b32 v23, 1, v23
  v_cmp_ne_u32 vcc, 0, v23
  s_cbranch_vccnz L_red
  s_nop 4
  v_cvt_pk_bf16_f32 v152, v152, v153
  v_cvt_pk_bf16_f32 v153, v154, v155
  v_and_or_b32 v153, v153, -2, s55
  s_mov_b64 exec, s[52:53]
  buffer_store_dwordx2 v[152:153], v5, s[4:7], s43 offen sc1
  buffer_store_dwordx2 v[152:153], v5, s[4:7], s42 offen
  s_mov_b64 exec, -1
L_red_skip:
  s_cmp_lg_u32 s20, 3
  s_cbranch_scc1 L_nex
  ds_read_b128 v[168:171], v189 offset:20608
  ds_read_b128 v[172:175], v0 offset:23552
  s_waitcnt lgkmcnt(0)
L_nex:
  s_barrier
  s_xor_b32 s23, s55, 1
  v_mov_b32 v41, s23
  v_mov_b32 v43, s23
  v_mov_b32 v45, s23
  v_mov_b32 v47, s23
  v_mov_b32 v49, s23
  v_mov_b32 v105, s23
  v_mov_b32 v107, s23
  v_mov_b32 v109, s23
  v_mov_b32 v111, s23
  v_mov_b32 v113, s23
  s_min_u32 s62, s76, 63
  s_sub_u32 s23, s62, 18
  s_lshr_b32 s23, s23, 2
  s_add_u32 s78, s23, 12
  s_add_u32 s23, s62, 6
  s_lshr_b32 s23, s23, 1
  s_cmp_lt_u32 s62, 18
  s_cselect_b32 s78, s23, s78
  s_cmp_lt_u32 s62, 6
  s_cselect_b32 s78, s62, s78
  s_add_u32 s76, s76, 1
  s_bitcmp1_b32 s77, s78
  s_cbranch_scc1 L_kvr4_ok
  s_mov_b32 s22, 0
L_kvr4:
  global_load_dword v190, v191, s[16:17] sc1
  s_add_u32 s22, s22, 1
  s_cmp_gt_u32 s22, 200000
  s_cbranch_scc1 L_fail
  s_waitcnt vmcnt(0)
  v_cmp_le_u32 vcc, 32, v190
  s_nop 3
  s_mov_b32 s77, vcc_lo
  s_bitcmp1_b32 s77, s78
  s_cbranch_scc1 L_kvr4_ok
  s_sleep 4
  s_branch L_kvr4
L_kvr4_ok:
  s_sleep 3
  buffer_load_dwordx4 v[40:43], v2, s[4:7], s44 offen sc1
  buffer_load_dwordx4 v[44:47], v16, s[4:7], s44 offen sc1
  buffer_load_dwordx2 v[48:49], v17, s[4:7], s44 offen sc1
  s_sleep 3
  buffer_load_dwordx4 v[104:107], v2, s[4:7], s45 offen sc1
  buffer_load_dwordx4 v[108:111], v16, s[4:7], s45 offen sc1
  buffer_load_dwordx2 v[112:113], v17, s[4:7], s45 offen sc1
  s_waitcnt vmcnt(3)
  v_xor_b32 v23, s55, v41
  v_bitop3_b32 v23, v23, v43, s55 bitop3:0xF6
  v_bitop3_b32 v23, v23, v45, s55 bitop3:0xF6
  v_bitop3_b32 v23, v23, v47, s55 bitop3:0xF6
  v_bitop3_b32 v23, v23, v49, s55 bitop3:0xF6
  v_and_b32 v23, 1, v23
  v_cmp_ne_u32 vcc, 0, v23
  s_mov_b32 s22, 0
  s_cbranch_vccz L_ga_ok
  s_mov_b32 s22, 0
L_ga:
  buffer_load_dwordx4 v[40:43], v2, s[4:7], s44 offen sc1
  buffer_load_dwordx4 v[44:47], v16, s[4:7], s44 offen sc1
  buffer_load_dwordx2 v[48:49], v17, s[4:7], s44 offen sc1
  s_add_u32 s22, s22, 1
  s_cmp_gt_u32 s22, 200000
  s_cbranch_scc1 L_fail
  s_waitcnt vmcnt(0)
  v_xor_b32 v23, s55, v41
  v_bitop3_b32 v23, v23, v43, s55 bitop3:0xF6
  v_bitop3_b32 v23, v23, v45, s55 bitop3:0xF6
  v_bitop3_b32 v23, v23, v47, s55 bitop3:0xF6
  v_bitop3_b32 v23, v23, v49, s55 bitop3:0xF6
  v_and_b32 v23, 1, v23
  v_cmp_ne_u32 vcc, 0, v23
  s_cbranch_vccnz L_ga
L_ga_ok:
  v_lshlrev_b32 v84, 16, v40
  v_and_b32 v85, 0xFFFF0000, v40
  v_lshlrev_b32 v86, 16, v41
  v_and_b32 v87, 0xFFFF0000, v41
  v_lshlrev_b32 v88, 16, v42
  v_and_b32 v89, 0xFFFF0000, v42
  v_lshlrev_b32 v90, 16, v43
  v_and_b32 v91, 0xFFFF0000, v43
  v_lshlrev_b32 v92, 16, v44
  v_and_b32 v93, 0xFFFF0000, v44
  v_lshlrev_b32 v94, 16, v45
  v_and_b32 v95, 0xFFFF0000, v45
  v_lshlrev_b32 v96, 16, v46
  v_and_b32 v97, 0xFFFF0000, v46
  v_lshlrev_b32 v98, 16, v47
  v_and_b32 v99, 0xFFFF0000, v47
  v_lshlrev_b32 v100, 16, v48
  v_and_b32 v101, 0xFFFF0000, v48
  v_lshlrev_b32 v102, 16, v49
  v_and_b32 v103, 0xFFFF0000, v49
  s_waitcnt vmcnt(0)
  v_xor_b32 v23, s55, v105
  v_bitop3_b32 v23, v23, v107, s55 bitop3:0xF6
  v_bitop3_b32 v23, v23, v109, s55 bitop3:0xF6
  v_bitop3_b32 v23, v23, v111, s55 bitop3:0xF6
  v_bitop3_b32 v23, v23, v113, s55 bitop3:0xF6
  v_and_b32 v23, 1, v23
  v_cmp_ne_u32 vcc, 0, v23
  s_mov_b32 s22, 0
  s_cbranch_vccz L_gb_ok
  s_mov_b32 s22, 0
L_gb:
  buffer_load_dwordx4 v[104:107], v2, s[4:7], s45 offen sc1
  buffer_load_dwordx4 v[108:111], v16, s[4:7], s45 offen sc1
  buffer_load_dwordx2 v[112:113], v17, s[4:7], s45 offen sc1
  s_add_u32 s22, s22, 1
  s_cmp_gt_u32 s22, 200000
  s_cbranch_scc1 L_fail
  s_waitcnt vmcnt(0)
  v_xor_b32 v23, s55, v105
  v_bitop3_b32 v23, v23, v107, s55 bitop3:0xF6
  v_bitop3_b32 v23, v23, v109, s55 bitop3:0xF6
  v_bitop3_b32 v23, v23, v111, s55 bitop3:0xF6
  v_bitop3_b32 v23, v23, v113, s55 bitop3:0xF6
  v_and_b32 v23, 1, v23
  v_cmp_ne_u32 vcc, 0, v23
  s_cbranch_vccnz L_gb
L_gb_ok:
  s_add_u32 s21, s21, 1
  s_and_b32 s54, s21, 1
  s_bfe_u32 s55, s21, 0x10001
  s_add_u32 s42, s42, s59
  s_add_u32 s44, s44, s59
  s_add_u32 s43, s43, 32768
  s_add_u32 s45, s45, 32768
  s_sub_u32 s59, 0, s59
  s_branch L_loop
L_last:
  s_waitcnt lgkmcnt(0)
  s_barrier
  s_cmp_lg_u32 s20, 3
  s_cbranch_scc1 L_team_exit
  buffer_store_dwordx4 v[168:171], v0, s[4:7], s30 offen sc1
  buffer_store_dwordx4 v[172:175], v0, s[4:7], s31 offen sc1
  s_add_u32 s30, s30, 65536
  s_add_u32 s31, s31, 65536
  s_nop 4
  ds_read_b128 v[168:171], v189 offset:20608
  ds_read_b128 v[172:175], v0 offset:23552
  s_waitcnt lgkmcnt(0)
  buffer_store_dwordx4 v[168:171], v0, s[4:7], s30 offen sc1
  buffer_store_dwordx4 v[172:175], v0, s[4:7], s31 offen sc1
  s_add_u32 s30, s30, 65536
  s_add_u32 s31, s31, 65536
  s_waitcnt vmcnt(0)
  v_mov_b32 v190, 64
  s_mov_b64 exec, 1
  s_add_u32 s23, s79, s80
  buffer_store_dword v190, v22, s[4:7], s23 offen sc1
  s_mov_b64 exec, -1
  s_add_u32 s80, s80, 4096
  s_cmp_eq_u32 s80, 24576
  s_cselect_b32 s80, 0, s80
  v_mov_b32 v190, 64
  s_mov_b64 exec, 1
  s_add_u32 s23, s79, s80
  buffer_store_dword v190, v22, s[4:7], s23 offen sc1
  s_mov_b64 exec, -1
  s_add_u32 s80, s80, 4096
  s_cmp_eq_u32 s80, 24576
  s_cselect_b32 s80, 0, s80
  v_mov_b32 v190, 64
  s_mov_b64 exec, 1
  s_add_u32 s23, s79, s80
  buffer_store_dword v190, v22, s[4:7], s23 offen sc1
  s_mov_b64 exec, -1
  s_add_u32 s80, s80, 4096
  s_cmp_eq_u32 s80, 24576
  s_cselect_b32 s80, 0, s80
  s_branch L_team_exit
L_team_exit:
  s_waitcnt vmcnt(0) lgkmcnt(0)
  s_branch L_end
L_helper:
  s_and_b32 s71, s25, 0xFF
  s_bitcmp1_b32 s25, 8
  s_cbranch_scc0 L_end
  s_lshl_b32 s23, s64, 1
  s_cmp_ge_u32 s18, s23
  s_cselect_b32 s23, 2, 0
  s_sub_u32 s70, s18, s23
  s_cmp_lt_u32 s70, 2
  s_cselect_b32 s72, 6, 5
  s_movk_i32 s74, 205
  s_cselect_b32 s74, 171, s74
  s_cselect_b32 s23, 0, 2
  s_mul_i32 s73, s70, s72
  s_add_u32 s73, s73, s23
  s_cmp_lg_u32 s20, 0
  s_cbranch_scc1 L_h0
  s_cmp_ge_u32 s71, 32
  s_cbranch_scc1 L_h0
  s_lshl_b32 s23, s70, 7
  s_lshl_b32 s75, s71, 2
  s_add_u32 s23, s23, s75
  s_add_u32 s23, s23, 0x4180000
  v_mov_b32 v1, 0
  v_mov_b32 v3, 1
  s_mov_b64 exec, 1
  buffer_store_dword v1, v1, s[4:7], s23 offen
  s_lshl_b32 s23, s70, 2
  s_add_u32 s23, s23, 192
  v_mov_b32 v2, s23
  s_waitcnt vmcnt(0)
  global_atomic_add v2, v3, s[16:17] sc1
  s_mov_b64 exec, -1
  s_cmp_lg_u32 s71, 0
  s_cbranch_scc1 L_h0
  s_sub_u32 s23, s64, 1
  s_lshr_b32 s23, s23, 1
  s_lshr_b32 s75, s18, 2
  s_cmp_lg_u32 s23, s75
  s_cbranch_scc1 L_h0
  s_mov_b64 exec, 1
  s_sub_u32 s65, 0, s4
  s_and_b32 s65, s65, 0x1FFFFF
  s_lshl_b32 s23, s24, 22
  s_add_u32 s65, s65, s23
  v_mov_b32 v4, 0x4405000
  buffer_store_dword v4, v4, s[4:7], s65 offen sc1
  v_mov_b32 v4, 0x4407000
  buffer_store_dword v4, v4, s[4:7], s65 offen sc1
  v_mov_b32 v4, 0x440d100
  buffer_store_dword v4, v4, s[4:7], s65 offen sc1
  v_mov_b32 v4, 0x440f100
  buffer_store_dword v4, v4, s[4:7], s65 offen sc1
  v_mov_b32 v4, 0x4415200
  buffer_store_dword v4, v4, s[4:7], s65 offen sc1
  v_mov_b32 v4, 0x4417200
  buffer_store_dword v4, v4, s[4:7], s65 offen sc1
  v_mov_b32 v4, 0x441d300
  buffer_store_dword v4, v4, s[4:7], s65 offen sc1
  v_mov_b32 v4, 0x441f300
  buffer_store_dword v4, v4, s[4:7], s65 offen sc1
  v_mov_b32 v4, 0x4405400
  buffer_store_dword v4, v4, s[4:7], s65 offen sc1
  v_mov_b32 v4, 0x4407400
  buffer_store_dword v4, v4, s[4:7], s65 offen sc1
  v_mov_b32 v4, 0x440d500
  buffer_store_dword v4, v4, s[4:7], s65 offen sc1
  v_mov_b32 v4, 0x440f500
  buffer_store_dword v4, v4, s[4:7], s65 offen sc1
  v_mov_b32 v4, 0x4415600
  buffer_store_dword v4, v4, s[4:7], s65 offen sc1
  v_mov_b32 v4, 0x4417600
  buffer_store_dword v4, v4, s[4:7], s65 offen sc1
  v_mov_b32 v4, 0x441d700
  buffer_store_dword v4, v4, s[4:7], s65 offen sc1
  v_mov_b32 v4, 0x441f700
  buffer_store_dword v4, v4, s[4:7], s65 offen sc1
  s_waitcnt vmcnt(0)
  s_mov_b32 s62, -1
  s_mov_b32 s63, -1
  v_mov_b32 v4, 0x4405000
  s_memtime s[84:85]
  s_waitcnt lgkmcnt(0)
  buffer_load_dword v5, v4, s[4:7], s65 offen sc1
  s_waitcnt vmcnt(0)
  s_memtime s[86:87]
  s_waitcnt lgkmcnt(0)
  s_sub_u32 s23, s86, s84
  s_min_u32 s62, s62, s23
  v_mov_b32 v4, 0x4407000
  s_memtime s[84:85]
  s_waitcnt lgkmcnt(0)
  buffer_load_dword v5, v4, s[4:7], s65 offen sc1
  s_waitcnt vmcnt(0)
  s_memtime s[86:87]
  s_waitcnt lgkmcnt(0)
  s_sub_u32 s23, s86, s84
  s_min_u32 s63, s63, s23
  v_mov_b32 v4, 0x440d100
  s_memtime s[84:85]
  s_waitcnt lgkmcnt(0)
  buffer_load_dword v5, v4, s[4:7], s65 offen sc1
  s_waitcnt vmcnt(0)
  s_memtime s[86:87]
  s_waitcnt lgkmcnt(0)
  s_sub_u32 s23, s86, s84
  s_min_u32 s62, s62, s23
  v_mov_b32 v4, 0x440f100
  s_memtime s[84:85]
  s_waitcnt lgkmcnt(0)
  buffer_load_dword v5, v4, s[4:7], s65 offen sc1
  s_waitcnt vmcnt(0)
  s_memtime s[86:87]
  s_waitcnt lgkmcnt(0)
  s_sub_u32 s23, s86, s84
  s_min_u32 s63, s63, s23
  v_mov_b32 v4, 0x4415200
  s_memtime s[84:85]
  s_waitcnt lgkmcnt(0)
  buffer_load_dword v5, v4, s[4:7], s65 offen sc1
  s_waitcnt vmcnt(0)
  s_memtime s[86:87]
  s_waitcnt lgkmcnt(0)
  s_sub_u32 s23, s86, s84
  s_min_u32 s62, s62, s23
  v_mov_b32 v4, 0x4417200
  s_memtime s[84:85]
  s_waitcnt lgkmcnt(0)
  buffer_load_dword v5, v4, s[4:7], s65 offen sc1
  s_waitcnt vmcnt(0)
  s_memtime s[86:87]
  s_waitcnt lgkmcnt(0)
  s_sub_u32 s23, s86, s84
  s_min_u32 s63, s63, s23
  v_mov_b32 v4, 0x441d300
  s_memtime s[84:85]
  s_waitcnt lgkmcnt(0)
  buffer_load_dword v5, v4, s[4:7], s65 offen sc1
  s_waitcnt vmcnt(0)
  s_memtime s[86:87]
  s_waitcnt lgkmcnt(0)
  s_sub_u32 s23, s86, s84
  s_min_u32 s62, s62, s23
  v_mov_b32 v4, 0x441f300
  s_memtime s[84:85]
  s_waitcnt lgkmcnt(0)
  buffer_load_dword v5, v4, s[4:7], s65 offen sc1
  s_waitcnt vmcnt(0)
  s_memtime s[86:87]
  s_waitcnt lgkmcnt(0)
  s_sub_u32 s23, s86, s84
  s_min_u32 s63, s63, s23
  v_mov_b32 v4, 0x4405400
  s_memtime s[84:85]
  s_waitcnt lgkmcnt(0)
  buffer_load_dword v5, v4, s[4:7], s65 offen sc1
  s_waitcnt vmcnt(0)
  s_memtime s[86:87]
  s_waitcnt lgkmcnt(0)
  s_sub_u32 s23, s86, s84
  s_min_u32 s62, s62, s23
  v_mov_b32 v4, 0x4407400
  s_memtime s[84:85]
  s_waitcnt lgkmcnt(0)
  buffer_load_dword v5, v4, s[4:7], s65 offen sc1
  s_waitcnt vmcnt(0)
  s_memtime s[86:87]
  s_waitcnt lgkmcnt(0)
  s_sub_u32 s23, s86, s84
  s_min_u32 s63, s63, s23
  v_mov_b32 v4, 0x440d500
  s_memtime s[84:85]
  s_waitcnt lgkmcnt(0)
  buffer_load_dword v5, v4, s[4:7], s65 offen sc1
  s_waitcnt vmcnt(0)
  s_memtime s[86:87]
  s_waitcnt lgkmcnt(0)
  s_sub_u32 s23, s86, s84
  s_min_u32 s62, s62, s23
  v_mov_b32 v4, 0x440f500
  s_memtime s[84:85]
  s_waitcnt lgkmcnt(0)
  buffer_load_dword v5, v4, s[4:7], s65 offen sc1
  s_waitcnt vmcnt(0)
  s_memtime s[86:87]
  s_waitcnt lgkmcnt(0)
  s_sub_u32 s23, s86, s84
  s_min_u32 s63, s63, s23
  v_mov_b32 v4, 0x4415600
  s_memtime s[84:85]
  s_waitcnt lgkmcnt(0)
  buffer_load_dword v5, v4, s[4:7], s65 offen sc1
  s_waitcnt vmcnt(0)
  s_memtime s[86:87]
  s_waitcnt lgkmcnt(0)
  s_sub_u32 s23, s86, s84
  s_min_u32 s62, s62, s23
  v_mov_b32 v4, 0x4417600
  s_memtime s[84:85]
  s_waitcnt lgkmcnt(0)
  buffer_load_dword v5, v4, s[4:7], s65 offen sc1
  s_waitcnt vmcnt(0)
  s_memtime s[86:87]
  s_waitcnt lgkmcnt(0)
  s_sub_u32 s23, s86, s84
  s_min_u32 s63, s63, s23
  v_mov_b32 v4, 0x441d700
  s_memtime s[84:85]
  s_waitcnt lgkmcnt(0)
  buffer_load_dword v5, v4, s[4:7], s65 offen sc1
  s_waitcnt vmcnt(0)
  s_memtime s[86:87]
  s_waitcnt lgkmcnt(0)
  s_sub_u32 s23, s86, s84
  s_min_u32 s62, s62, s23
  v_mov_b32 v4, 0x441f700
  s_memtime s[84:85]
  s_waitcnt lgkmcnt(0)
  buffer_load_dword v5, v4, s[4:7], s65 offen sc1
  s_waitcnt vmcnt(0)
  s_memtime s[86:87]
  s_waitcnt lgkmcnt(0)
  s_sub_u32 s23, s86, s84
  s_min_u32 s63, s63, s23
  s_cmp_lt_u32 s63, s62
  s_cselect_b32 s23, 0x2001, 1
  v_mov_b32 v6, s23
  s_lshl_b32 s23, s24, 2
  s_add_u32 s23, s23, 56
  v_mov_b32 v4, s23
  v_mov_b32 v7, 0
  global_atomic_cmpswap v4, v[6:7], s[16:17] sc1
  s_waitcnt vmcnt(0)
  s_mov_b64 exec, -1
L_h0:
  s_barrier
  s_load_dwordx2 s[8:9], s[0:1], 0
  s_waitcnt lgkmcnt(0)
  s_and_b32 s9, s9, 0xffff
  s_mov_b32 s10, 2621440
  s_mov_b32 s11, 0x00020000
  s_load_dwordx2 s[12:13], s[0:1], 16
  s_waitcnt lgkmcnt(0)
  s_and_b32 s13, s13, 0xffff
  s_mov_b32 s14, 5242880
  s_mov_b32 s15, 0x00020000
  s_load_dwordx2 s[28:29], s[0:1], 24
  s_waitcnt lgkmcnt(0)
  s_and_b32 s29, s29, 0xffff
  s_mov_b32 s30, 5242880
  s_mov_b32 s31, 0x00020000
  s_load_dwordx2 s[32:33], s[0:1], 32
  s_waitcnt lgkmcnt(0)
  s_and_b32 s33, s33, 0xffff
  s_mov_b32 s34, 5242880
  s_mov_b32 s35, 0x00020000
  v_and_b32 v132, 63, v0
  v_lshlrev_b32 v0, 4, v132
  v_lshrrev_b32 v128, 2, v132
  s_movk_i32 s23, 1280
  v_mul_lo_u32 v128, v128, s23
  v_and_b32 v129, 3, v132
  v_lshrrev_b32 v130, 5, v132
  v_add_u32 v133, 0, v130
  v_sub_u32 v133, 0, v133
  v_and_b32 v133, 3, v133
  v_xor_b32 v133, v133, v129
  v_lshl_add_u32 v1, v133, 4, v128
  v_add_u32 v133, 2, v130
  v_sub_u32 v133, 0, v133
  v_and_b32 v133, 3, v133
  v_xor_b32 v133, v133, v129
  v_lshl_add_u32 v2, v133, 4, v128
  s_bitcmp1_b32 s20, 0
  s_cselect_b64 vcc, -1, 0
  v_cndmask_b32 v13, v1, v2, vcc
  v_lshrrev_b32 v128, 4, v132
  v_and_b32 v129, 15, v132
  v_lshlrev_b32 v130, 2, v128
  v_xor_b32 v130, v130, v129
  v_lshlrev_b32 v3, 13, v128
  v_lshl_add_u32 v3, v130, 4, v3
  v_lshrrev_b32 v130, 2, v129
  v_and_b32 v131, 3, v129
  v_lshlrev_b32 v4, 9, v130
  v_lshl_add_u32 v4, v131, 6, v4
  v_sub_u32 v133, 0, v130
  v_and_b32 v133, 3, v133
  v_xor_b32 v133, v133, v128
  v_lshl_add_u32 v4, v133, 4, v4
  v_lshlrev_b32 v133, 3, v128
  v_add_u32 v133, v133, v130
  v_lshlrev_b32 v133, 8, v133
  v_xor_b32 v134, s20, v130
  v_lshl_add_u32 v133, v134, 6, v133
  v_lshl_add_u32 v5, v131, 4, v133
  v_lshl_add_u32 v6, v131, 3, v133
  v_add_u32 v7, 65536, v4
  v_add_u32 v8, 65536, v5
  v_add_u32 v9, 65536, v6
  v_add_u32 v10, 131072, v4
  v_add_u32 v11, 131072, v5
  v_add_u32 v12, 131072, v6
  s_add_u32 s75, s71, 31
  s_and_b32 s75, s75, 31
  s_cmp_ge_u32 s71, 32
  s_cbranch_scc1 L_end
L_task:
  s_mul_i32 s76, s75, s74
  s_lshr_b32 s76, s76, 10
  s_cmp_ge_u32 s76, 24
  s_cbranch_scc1 L_engine
  s_mul_i32 s23, s76, s72
  s_sub_u32 s37, s75, s23
  s_add_u32 s37, s37, s73
  s_cmp_lt_u32 s76, 6
  s_cbranch_scc1 L_t1
  s_lshl_b32 s36, s76, 1
  s_sub_u32 s36, s36, 6
  s_cmp_lt_u32 s76, 12
  s_cbranch_scc1 L_t2
  s_lshl_b32 s36, s76, 2
  s_sub_u32 s36, s36, 30
  s_cmp_eq_u32 s76, 23
  s_cbranch_scc1 L_t2
  s_mul_i32 s38, s36, 40960
  s_mul_i32 s23, s20, 40960
  s_lshl_b32 s43, s20, 11
  s_add_u32 s38, s38, s23
  s_lshl_b32 s39, s37, 8
  s_lshl_b32 s23, s20, 16
  s_add_u32 s39, s39, s23
  s_lshl_b32 s40, s20, 11
  s_add_u32 m0, s43, 0
  s_add_u32 s42, s38, 0
  buffer_load_dwordx4 v1, s[8:11], s42 offen lds
  s_add_u32 m0, s43, 1024
  s_add_u32 s42, s38, 20480
  buffer_load_dwordx4 v2, s[8:11], s42 offen lds
  s_add_u32 m0, s40, 16384
  s_add_u32 s42, s39, 0
  buffer_load_dwordx4 v3, s[28:31], s42 offen lds
  s_add_u32 m0, s40, 17408
  s_add_u32 s42, s39, 32768
  buffer_load_dwordx4 v3, s[28:31], s42 offen lds
  s_add_u32 m0, s40, 24576
  s_add_u32 s42, s39, 0
  buffer_load_dwordx4 v3, s[32:35], s42 offen lds
  s_add_u32 m0, s40, 25600
  s_add_u32 s42, s39, 32768
  buffer_load_dwordx4 v3, s[32:35], s42 offen lds
  s_add_u32 m0, s40, 8192
  s_add_u32 s42, s39, 0
  buffer_load_dwordx4 v3, s[12:15], s42 offen lds
  s_add_u32 m0, s40, 9216
  s_add_u32 s42, s39, 32768
  buffer_load_dwordx4 v3, s[12:15], s42 offen lds
  s_add_u32 m0, s43, 32768
  s_add_u32 s42, s38, 64
  buffer_load_dwordx4 v1, s[8:11], s42 offen lds
  s_add_u32 m0, s43, 33792
  s_add_u32 s42, s38, 20544
  buffer_load_dwordx4 v2, s[8:11], s42 offen lds
  s_add_u32 m0, s40, 49152
  s_add_u32 s42, s39, 262144
  buffer_load_dwordx4 v3, s[28:31], s42 offen lds
  s_add_u32 m0, s40, 50176
  s_add_u32 s42, s39, 294912
  buffer_load_dwordx4 v3, s[28:31], s42 offen lds
  s_add_u32 m0, s40, 57344
  s_add_u32 s42, s39, 262144
  buffer_load_dwordx4 v3, s[32:35], s42 offen lds
  s_add_u32 m0, s40, 58368
  s_add_u32 s42, s39, 294912
  buffer_load_dwordx4 v3, s[32:35], s42 offen lds
  s_add_u32 m0, s40, 40960
  s_add_u32 s42, s39, 262144
  buffer_load_dwordx4 v3, s[12:15], s42 offen lds
  s_add_u32 m0, s40, 41984
  s_add_u32 s42, s39, 294912
  buffer_load_dwordx4 v3, s[12:15], s42 offen lds
  s_add_u32 m0, s43, 65536
  s_add_u32 s42, s38, 128
  buffer_load_dwordx4 v1, s[8:11], s42 offen lds
  s_add_u32 m0, s43, 66560
  s_add_u32 s42, s38, 20608
  buffer_load_dwordx4 v2, s[8:11], s42 offen lds
  s_add_u32 m0, s40, 81920
  s_add_u32 s42, s39, 524288
  buffer_load_dwordx4 v3, s[28:31], s42 offen lds
  s_add_u32 m0, s40, 82944
  s_add_u32 s42, s39, 557056
  buffer_load_dwordx4 v3, s[28:31], s42 offen lds
  s_add_u32 m0, s40, 90112
  s_add_u32 s42, s39, 524288
  buffer_load_dwordx4 v3, s[32:35], s42 offen lds
  s_add_u32 m0, s40, 91136
  s_add_u32 s42, s39, 557056
  buffer_load_dwordx4 v3, s[32:35], s42 offen lds
  s_add_u32 m0, s40, 73728
  s_add_u32 s42, s39, 524288
  buffer_load_dwordx4 v3, s[12:15], s42 offen lds
  s_add_u32 m0, s40, 74752
  s_add_u32 s42, s39, 557056
  buffer_load_dwordx4 v3, s[12:15], s42 offen lds
  s_add_u32 m0, s43, 98304
  s_add_u32 s42, s38, 192
  buffer_load_dwordx4 v1, s[8:11], s42 offen lds
  s_add_u32 m0, s43, 99328
  s_add_u32 s42, s38, 20672
  buffer_load_dwordx4 v2, s[8:11], s42 offen lds
  s_add_u32 m0, s40, 114688
  s_add_u32 s42, s39, 786432
  buffer_load_dwordx4 v3, s[28:31], s42 offen lds
  s_add_u32 m0, s40, 115712
  s_add_u32 s42, s39, 819200
  buffer_load_dwordx4 v3, s[28:31], s42 offen lds
  s_add_u32 m0, s40, 122880
  s_add_u32 s42, s39, 786432
  buffer_load_dwordx4 v3, s[32:35], s42 offen lds
  s_add_u32 m0, s40, 123904
  s_add_u32 s42, s39, 819200
  buffer_load_dwordx4 v3, s[32:35], s42 offen lds
  s_add_u32 m0, s40, 106496
  s_add_u32 s42, s39, 786432
  buffer_load_dwordx4 v3, s[12:15], s42 offen lds
  s_add_u32 m0, s40, 107520
  s_add_u32 s42, s39, 819200
  buffer_load_dwordx4 v3, s[12:15], s42 offen lds
  s_add_u32 m0, s43, 131072
  s_add_u32 s42, s38, 256
  buffer_load_dwordx4 v1, s[8:11], s42 offen lds
  s_add_u32 m0, s43, 132096
  s_add_u32 s42, s38, 20736
  buffer_load_dwordx4 v2, s[8:11], s42 offen lds
  s_add_u32 m0, s40, 147456
  s_add_u32 s42, s39, 1048576
  buffer_load_dwordx4 v3, s[28:31], s42 offen lds
  s_add_u32 m0, s40, 148480
  s_add_u32 s42, s39, 1081344
  buffer_load_dwordx4 v3, s[28:31], s42 offen lds
  s_add_u32 m0, s40, 155648
  s_add_u32 s42, s39, 1048576
  buffer_load_dwordx4 v3, s[32:35], s42 offen lds
  s_add_u32 m0, s40, 156672
  s_add_u32 s42, s39, 1081344
  buffer_load_dwordx4 v3, s[32:35], s42 offen lds
  s_add_u32 m0, s40, 139264
  s_add_u32 s42, s39, 1048576
  buffer_load_dwordx4 v3, s[12:15], s42 offen lds
  s_add_u32 m0, s40, 140288
  s_add_u32 s42, s39, 1081344
  buffer_load_dwordx4 v3, s[12:15], s42 offen lds
  v_accvgpr_write_b32 a0, 0
  v_accvgpr_write_b32 a1, 0
  v_accvgpr_write_b32 a2, 0
  v_accvgpr_write_b32 a3, 0
  v_accvgpr_write_b32 a4, 0
  v_accvgpr_write_b32 a5, 0
  v_accvgpr_write_b32 a6, 0
  v_accvgpr_write_b32 a7, 0
  v_accvgpr_write_b32 a8, 0
  v_accvgpr_write_b32 a9, 0
  v_accvgpr_write_b32 a10, 0
  v_accvgpr_write_b32 a11, 0
  v_accvgpr_write_b32 a12, 0
  v_accvgpr_write_b32 a13, 0
  v_accvgpr_write_b32 a14, 0
  v_accvgpr_write_b32 a15, 0
  v_accvgpr_write_b32 a16, 0
  v_accvgpr_write_b32 a17, 0
  v_accvgpr_write_b32 a18, 0
  v_accvgpr_write_b32 a19, 0
  v_accvgpr_write_b32 a20, 0
  v_accvgpr_write_b32 a21, 0
  v_accvgpr_write_b32 a22, 0
  v_accvgpr_write_b32 a23, 0
  v_accvgpr_write_b32 a24, 0
  v_accvgpr_write_b32 a25, 0
  v_accvgpr_write_b32 a26, 0
  v_accvgpr_write_b32 a27, 0
  v_accvgpr_write_b32 a28, 0
  v_accvgpr_write_b32 a29, 0
  v_accvgpr_write_b32 a30, 0
  v_accvgpr_write_b32 a31, 0
  v_accvgpr_write_b32 a32, 0
  v_accvgpr_write_b32 a33, 0
  v_accvgpr_write_b32 a34, 0
  v_accvgpr_write_b32 a35, 0
  v_accvgpr_write_b32 a36, 0
  v_accvgpr_write_b32 a37, 0
  v_accvgpr_write_b32 a38, 0
  v_accvgpr_write_b32 a39, 0
  v_accvgpr_write_b32 a40, 0
  v_accvgpr_write_b32 a41, 0
  v_accvgpr_write_b32 a42, 0
  v_accvgpr_write_b32 a43, 0
  v_accvgpr_write_b32 a44, 0
  v_accvgpr_write_b32 a45, 0
  v_accvgpr_write_b32 a46, 0
  v_accvgpr_write_b32 a47, 0
  v_accvgpr_write_b32 a48, 0
  v_accvgpr_write_b32 a49, 0
  v_accvgpr_write_b32 a50, 0
  v_accvgpr_write_b32 a51, 0
  v_accvgpr_write_b32 a52, 0
  v_accvgpr_write_b32 a53, 0
  v_accvgpr_write_b32 a54, 0
  v_accvgpr_write_b32 a55, 0
  v_accvgpr_write_b32 a56, 0
  v_accvgpr_write_b32 a57, 0
  v_accvgpr_write_b32 a58, 0
  v_accvgpr_write_b32 a59, 0
  v_accvgpr_write_b32 a60, 0
  v_accvgpr_write_b32 a61, 0
  v_accvgpr_write_b32 a62, 0
  v_accvgpr_write_b32 a63, 0
  v_accvgpr_write_b32 a64, 0
  v_accvgpr_write_b32 a65, 0
  v_accvgpr_write_b32 a66, 0
  v_accvgpr_write_b32 a67, 0
  v_accvgpr_write_b32 a68, 0
  v_accvgpr_write_b32 a69, 0
  v_accvgpr_write_b32 a70, 0
  v_accvgpr_write_b32 a71, 0
  v_accvgpr_write_b32 a72, 0
  v_accvgpr_write_b32 a73, 0
  v_accvgpr_write_b32 a74, 0
  v_accvgpr_write_b32 a75, 0
  v_accvgpr_write_b32 a76, 0
  v_accvgpr_write_b32 a77, 0
  v_accvgpr_write_b32 a78, 0
  v_accvgpr_write_b32 a79, 0
  v_accvgpr_write_b32 a80, 0
  v_accvgpr_write_b32 a81, 0
  v_accvgpr_write_b32 a82, 0
  v_accvgpr_write_b32 a83, 0
  v_accvgpr_write_b32 a84, 0
  v_accvgpr_write_b32 a85, 0
  v_accvgpr_write_b32 a86, 0
  v_accvgpr_write_b32 a87, 0
  v_accvgpr_write_b32 a88, 0
  v_accvgpr_write_b32 a89, 0
  v_accvgpr_write_b32 a90, 0
  v_accvgpr_write_b32 a91, 0
  v_accvgpr_write_b32 a92, 0
  v_accvgpr_write_b32 a93, 0
  v_accvgpr_write_b32 a94, 0
  v_accvgpr_write_b32 a95, 0
  v_accvgpr_write_b32 a96, 0
  v_accvgpr_write_b32 a97, 0
  v_accvgpr_write_b32 a98, 0
  v_accvgpr_write_b32 a99, 0
  v_accvgpr_write_b32 a100, 0
  v_accvgpr_write_b32 a101, 0
  v_accvgpr_write_b32 a102, 0
  v_accvgpr_write_b32 a103, 0
  v_accvgpr_write_b32 a104, 0
  v_accvgpr_write_b32 a105, 0
  v_accvgpr_write_b32 a106, 0
  v_accvgpr_write_b32 a107, 0
  v_accvgpr_write_b32 a108, 0
  v_accvgpr_write_b32 a109, 0
  v_accvgpr_write_b32 a110, 0
  v_accvgpr_write_b32 a111, 0
  v_accvgpr_write_b32 a112, 0
  v_accvgpr_write_b32 a113, 0
  v_accvgpr_write_b32 a114, 0
  v_accvgpr_write_b32 a115, 0
  v_accvgpr_write_b32 a116, 0
  v_accvgpr_write_b32 a117, 0
  v_accvgpr_write_b32 a118, 0
  v_accvgpr_write_b32 a119, 0
  v_accvgpr_write_b32 a120, 0
  v_accvgpr_write_b32 a121, 0
  v_accvgpr_write_b32 a122, 0
  v_accvgpr_write_b32 a123, 0
  v_accvgpr_write_b32 a124, 0
  v_accvgpr_write_b32 a125, 0
  v_accvgpr_write_b32 a126, 0
  v_accvgpr_write_b32 a127, 0
  v_accvgpr_write_b32 a128, 0
  v_accvgpr_write_b32 a129, 0
  v_accvgpr_write_b32 a130, 0
  v_accvgpr_write_b32 a131, 0
  v_accvgpr_write_b32 a132, 0
  v_accvgpr_write_b32 a133, 0
  v_accvgpr_write_b32 a134, 0
  v_accvgpr_write_b32 a135, 0
  v_accvgpr_write_b32 a136, 0
  v_accvgpr_write_b32 a137, 0
  v_accvgpr_write_b32 a138, 0
  v_accvgpr_write_b32 a139, 0
  v_accvgpr_write_b32 a140, 0
  v_accvgpr_write_b32 a141, 0
  v_accvgpr_write_b32 a142, 0
  v_accvgpr_write_b32 a143, 0
  v_accvgpr_write_b32 a144, 0
  v_accvgpr_write_b32 a145, 0
  v_accvgpr_write_b32 a146, 0
  v_accvgpr_write_b32 a147, 0
  v_accvgpr_write_b32 a148, 0
  v_accvgpr_write_b32 a149, 0
  v_accvgpr_write_b32 a150, 0
  v_accvgpr_write_b32 a151, 0
  v_accvgpr_write_b32 a152, 0
  v_accvgpr_write_b32 a153, 0
  v_accvgpr_write_b32 a154, 0
  v_accvgpr_write_b32 a155, 0
  v_accvgpr_write_b32 a156, 0
  v_accvgpr_write_b32 a157, 0
  v_accvgpr_write_b32 a158, 0
  v_accvgpr_write_b32 a159, 0
  v_accvgpr_write_b32 a160, 0
  v_accvgpr_write_b32 a161, 0
  v_accvgpr_write_b32 a162, 0
  v_accvgpr_write_b32 a163, 0
  v_accvgpr_write_b32 a164, 0
  v_accvgpr_write_b32 a165, 0
  v_accvgpr_write_b32 a166, 0
  v_accvgpr_write_b32 a167, 0
  v_accvgpr_write_b32 a168, 0
  v_accvgpr_write_b32 a169, 0
  v_accvgpr_write_b32 a170, 0
  v_accvgpr_write_b32 a171, 0
  v_accvgpr_write_b32 a172, 0
  v_accvgpr_write_b32 a173, 0
  v_accvgpr_write_b32 a174, 0
  v_accvgpr_write_b32 a175, 0
  v_accvgpr_write_b32 a176, 0
  v_accvgpr_write_b32 a177, 0
  v_accvgpr_write_b32 a178, 0
  v_accvgpr_write_b32 a179, 0
  v_accvgpr_write_b32 a180, 0
  v_accvgpr_write_b32 a181, 0
  v_accvgpr_write_b32 a182, 0
  v_accvgpr_write_b32 a183, 0
  v_accvgpr_write_b32 a184, 0
  v_accvgpr_write_b32 a185, 0
  v_accvgpr_write_b32 a186, 0
  v_accvgpr_write_b32 a187, 0
  v_accvgpr_write_b32 a188, 0
  v_accvgpr_write_b32 a189, 0
  v_accvgpr_write_b32 a190, 0
  v_accvgpr_write_b32 a191, 0
  s_waitcnt vmcnt(32)
  s_barrier
  ds_read_b64_tr_b16 v[80:81], v5 offset:8192
  ds_read_b64_tr_b16 v[82:83], v5 offset:9216
  ds_read_b64_tr_b16 v[84:85], v5 offset:8200
  ds_read_b64_tr_b16 v[86:87], v5 offset:9224
  ds_read_b128 v[16:19], v4 offset:0
  ds_read_b128 v[20:23], v4 offset:256
  ds_read_b128 v[24:27], v4 offset:2048
  ds_read_b128 v[28:31], v4 offset:2304
  ds_read_b128 v[32:35], v4 offset:4096
  ds_read_b128 v[36:39], v4 offset:4352
  ds_read_b128 v[40:43], v4 offset:6144
  ds_read_b128 v[44:47], v4 offset:6400
  ds_read_b64_tr_b16 v[88:89], v5 offset:16384
  ds_read_b64_tr_b16 v[90:91], v5 offset:17408
  ds_read_b64_tr_b16 v[92:93], v5 offset:16392
  ds_read_b64_tr_b16 v[94:95], v5 offset:17416
  ds_read_b64_tr_b16 v[96:97], v6 offset:24576
  ds_read_b64_tr_b16 v[98:99], v6 offset:25600
  ds_read_b64_tr_b16 v[100:101], v6 offset:24608
  ds_read_b64_tr_b16 v[102:103], v6 offset:25632
  s_waitcnt lgkmcnt(0)
  s_waitcnt vmcnt(24)
  s_barrier
  v_mfma_f32_16x16x32_bf16 a[0:3], v[80:83], v[16:19], a[0:3]
  s_add_u32 m0, s43, 0
  s_add_u32 s42, s38, 320
  buffer_load_dwordx4 v1, s[8:11], s42 offen lds
  v_mfma_f32_16x16x32_bf16 a[4:7], v[80:83], v[20:23], a[4:7]
  ds_read_b64_tr_b16 v[104:105], v5 offset:40960
  v_mfma_f32_16x16x32_bf16 a[8:11], v[80:83], v[24:27], a[8:11]
  v_mfma_f32_16x16x32_bf16 a[12:15], v[80:83], v[28:31], a[12:15]
  ds_read_b64_tr_b16 v[106:107], v5 offset:41984
  v_mfma_f32_16x16x32_bf16 a[16:19], v[80:83], v[32:35], a[16:19]
  v_mfma_f32_16x16x32_bf16 a[20:23], v[80:83], v[36:39], a[20:23]
  ds_read_b64_tr_b16 v[108:109], v5 offset:40968
  s_add_u32 m0, s43, 1024
  s_add_u32 s42, s38, 20800
  buffer_load_dwordx4 v2, s[8:11], s42 offen lds
  v_mfma_f32_16x16x32_bf16 a[24:27], v[80:83], v[40:43], a[24:27]
  v_mfma_f32_16x16x32_bf16 a[28:31], v[80:83], v[44:47], a[28:31]
  ds_read_b64_tr_b16 v[110:111], v5 offset:41992
  v_mfma_f32_16x16x32_bf16 a[32:35], v[84:87], v[16:19], a[32:35]
  v_mfma_f32_16x16x32_bf16 a[36:39], v[84:87], v[20:23], a[36:39]
  ds_read_b128 v[48:51], v4 offset:32768
  v_mfma_f32_16x16x32_bf16 a[40:43], v[84:87], v[24:27], a[40:43]
  s_add_u32 m0, s40, 16384
  s_add_u32 s42, s39, 1310720
  buffer_load_dwordx4 v3, s[28:31], s42 offen lds
  v_mfma_f32_16x16x32_bf16 a[44:47], v[84:87], v[28:31], a[44:47]
  ds_read_b128 v[52:55], v4 offset:33024
  v_mfma_f32_16x16x32_bf16 a[48:51], v[84:87], v[32:35], a[48:51]
  v_mfma_f32_16x16x32_bf16 a[52:55], v[84:87], v[36:39], a[52:55]
  ds_read_b128 v[56:59], v4 offset:34816
  v_mfma_f32_16x16x32_bf16 a[56:59], v[84:87], v[40:43], a[56:59]
  v_mfma_f32_16x16x32_bf16 a[60:63], v[84:87], v[44:47], a[60:63]
  ds_read_b128 v[60:63], v4 offset:35072
  s_add_u32 m0, s40, 17408
  s_add_u32 s42, s39, 1343488
  buffer_load_dwordx4 v3, s[28:31], s42 offen lds
  v_mfma_f32_16x16x32_bf16 a[64:67], v[88:91], v[16:19], a[64:67]
  v_mfma_f32_16x16x32_bf16 a[68:71], v[88:91], v[20:23], a[68:71]
  ds_read_b128 v[64:67], v4 offset:36864
  v_mfma_f32_16x16x32_bf16 a[72:75], v[88:91], v[24:27], a[72:75]
  v_mfma_f32_16x16x32_bf16 a[76:79], v[88:91], v[28:31], a[76:79]
  ds_read_b128 v[68:71], v4 offset:37120
  v_mfma_f32_16x16x32_bf16 a[80:83], v[88:91], v[32:35], a[80:83]
  s_add_u32 m0, s40, 24576
  s_add_u32 s42, s39, 1310720
  buffer_load_dwordx4 v3, s[32:35], s42 offen lds
  v_mfma_f32_16x16x32_bf16 a[84:87], v[88:91], v[36:39], a[84:87]
  ds_read_b128 v[72:75], v4 offset:38912
  v_mfma_f32_16x16x32_bf16 a[88:91], v[88:91], v[40:43], a[88:91]
  v_mfma_f32_16x16x32_bf16 a[92:95], v[88:91], v[44:47], a[92:95]
  ds_read_b128 v[76:79], v4 offset:39168
  v_mfma_f32_16x16x32_bf16 a[96:99], v[92:95], v[16:19], a[96:99]
  v_mfma_f32_16x16x32_bf16 a[100:103], v[92:95], v[20:23], a[100:103]
  ds_read_b64_tr_b16 v[112:113], v5 offset:49152
  s_add_u32 m0, s40, 25600
  s_add_u32 s42, s39, 1343488
  buffer_load_dwordx4 v3, s[32:35], s42 offen lds
  v_mfma_f32_16x16x32_bf16 a[104:107], v[92:95], v[24:27], a[104:107]
  v_mfma_f32_16x16x32_bf16 a[108:111], v[92:95], v[28:31], a[108:111]
  ds_read_b64_tr_b16 v[114:115], v5 offset:50176
  v_mfma_f32_16x16x32_bf16 a[112:115], v[92:95], v[32:35], a[112:115]
  v_mfma_f32_16x16x32_bf16 a[116:119], v[92:95], v[36:39], a[116:119]
  ds_read_b64_tr_b16 v[116:117], v5 offset:49160
  v_mfma_f32_16x16x32_bf16 a[120:123], v[92:95], v[40:43], a[120:123]
  s_add_u32 m0, s40, 8192
  s_add_u32 s42, s39, 1310720
  buffer_load_dwordx4 v3, s[12:15], s42 offen lds
  v_mfma_f32_16x16x32_bf16 a[124:127], v[92:95], v[44:47], a[124:127]
  ds_read_b64_tr_b16 v[118:119], v5 offset:50184
  v_mfma_f32_16x16x32_bf16 a[128:131], v[16:19], v[96:99], a[128:131]
  v_mfma_f32_16x16x32_bf16 a[132:135], v[20:23], v[96:99], a[132:135]
  ds_read_b64_tr_b16 v[120:121], v6 offset:57344
  v_mfma_f32_16x16x32_bf16 a[136:139], v[24:27], v[96:99], a[136:139]
  v_mfma_f32_16x16x32_bf16 a[140:143], v[28:31], v[96:99], a[140:143]
  ds_read_b64_tr_b16 v[122:123], v6 offset:58368
  s_add_u32 m0, s40, 9216
  s_add_u32 s42, s39, 1343488
  buffer_load_dwordx4 v3, s[12:15], s42 offen lds
  v_mfma_f32_16x16x32_bf16 a[144:147], v[32:35], v[96:99], a[144:147]
  v_mfma_f32_16x16x32_bf16 a[148:151], v[36:39], v[96:99], a[148:151]
  ds_read_b64_tr_b16 v[124:125], v6 offset:57376
  v_mfma_f32_16x16x32_bf16 a[152:155], v[40:43], v[96:99], a[152:155]
  v_mfma_f32_16x16x32_bf16 a[156:159], v[44:47], v[96:99], a[156:159]
  ds_read_b64_tr_b16 v[126:127], v6 offset:58400
  v_mfma_f32_16x16x32_bf16 a[160:163], v[16:19], v[100:103], a[160:163]
  v_mfma_f32_16x16x32_bf16 a[164:167], v[20:23], v[100:103], a[164:167]
  v_mfma_f32_16x16x32_bf16 a[168:171], v[24:27], v[100:103], a[168:171]
  v_mfma_f32_16x16x32_bf16 a[172:175], v[28:31], v[100:103], a[172:175]
  v_mfma_f32_16x16x32_bf16 a[176:179], v[32:35], v[100:103], a[176:179]
  v_mfma_f32_16x16x32_bf16 a[180:183], v[36:39], v[100:103], a[180:183]
  v_mfma_f32_16x16x32_bf16 a[184:187], v[40:43], v[100:103], a[184:187]
  v_mfma_f32_16x16x32_bf16 a[188:191], v[44:47], v[100:103], a[188:191]
  s_waitcnt lgkmcnt(0)
  s_waitcnt vmcnt(24)
  s_barrier
  v_mfma_f32_16x16x32_bf16 a[0:3], v[104:107], v[48:51], a[0:3]
  s_add_u32 m0, s43, 32768
  s_add_u32 s42, s38, 384
  buffer_load_dwordx4 v1, s[8:11], s42 offen lds
  v_mfma_f32_16x16x32_bf16 a[4:7], v[104:107], v[52:55], a[4:7]
  ds_read_b64_tr_b16 v[80:81], v8 offset:8192
  v_mfma_f32_16x16x32_bf16 a[8:11], v[104:107], v[56:59], a[8:11]
  v_mfma_f32_16x16x32_bf16 a[12:15], v[104:107], v[60:63], a[12:15]
  ds_read_b64_tr_b16 v[82:83], v8 offset:9216
  v_mfma_f32_16x16x32_bf16 a[16:19], v[104:107], v[64:67], a[16:19]
  v_mfma_f32_16x16x32_bf16 a[20:23], v[104:107], v[68:71], a[20:23]
  ds_read_b64_tr_b16 v[84:85], v8 offset:8200
  s_add_u32 m0, s43, 33792
  s_add_u32 s42, s38, 20864
  buffer_load_dwordx4 v2, s[8:11], s42 offen lds
  v_mfma_f32_16x16x32_bf16 a[24:27], v[104:107], v[72:75], a[24:27]
  v_mfma_f32_16x16x32_bf16 a[28:31], v[104:107], v[76:79], a[28:31]
  ds_read_b64_tr_b16 v[86:87], v8 offset:9224
  v_mfma_f32_16x16x32_bf16 a[32:35], v[108:111], v[48:51], a[32:35]
  v_mfma_f32_16x16x32_bf16 a[36:39], v[108:111], v[52:55], a[36:39]
  ds_read_b128 v[16:19], v7 offset:0
  v_mfma_f32_16x16x32_bf16 a[40:43], v[108:111], v[56:59], a[40:43]
  s_add_u32 m0, s40, 49152
  s_add_u32 s42, s39, 1572864
  buffer_load_dwordx4 v3, s[28:31], s42 offen lds
  v_mfma_f32_16x16x32_bf16 a[44:47], v[108:111], v[60:63], a[44:47]
  ds_read_b128 v[20:23], v7 offset:256
  v_mfma_f32_16x16x32_bf16 a[48:51], v[108:111], v[64:67], a[48:51]
  v_mfma_f32_16x16x32_bf16 a[52:55], v[108:111], v[68:71], a[52:55]
  ds_read_b128 v[24:27], v7 offset:2048
  v_mfma_f32_16x16x32_bf16 a[56:59], v[108:111], v[72:75], a[56:59]
  v_mfma_f32_16x16x32_bf16 a[60:63], v[108:111], v[76:79], a[60:63]
  ds_read_b128 v[28:31], v7 offset:2304
  s_add_u32 m0, s40, 50176
  s_add_u32 s42, s39, 1605632
  buffer_load_dwordx4 v3, s[28:31], s42 offen lds
  v_mfma_f32_16x16x32_bf16 a[64:67], v[112:115], v[48:51], a[64:67]
  v_mfma_f32_16x16x32_bf16 a[68:71], v[112:115], v[52:55], a[68:71]
  ds_read_b128 v[32:35], v7 offset:4096
  v_mfma_f32_16x16x32_bf16 a[72:75], v[112:115], v[56:59], a[72:75]
  v_mfma_f32_16x16x32_bf16 a[76:79], v[112:115], v[60:63], a[76:79]
  ds_read_b128 v[36:39], v7 offset:4352
  v_mfma_f32_16x16x32_bf16 a[80:83], v[112:115], v[64:67], a[80:83]
  s_add_u32 m0, s40, 57344
  s_add_u32 s42, s39, 1572864
  buffer_load_dwordx4 v3, s[32:35], s42 offen lds
  v_mfma_f32_16x16x32_bf16 a[84:87], v[112:115], v[68:71], a[84:87]
  ds_read_b128 v[40:43], v7 offset:6144
  v_mfma_f32_16x16x32_bf16 a[88:91], v[112:115], v[72:75], a[88:91]
  v_mfma_f32_16x16x32_bf16 a[92:95], v[112:115], v[76:79], a[92:95]
  ds_read_b128 v[44:47], v7 offset:6400
  v_mfma_f32_16x16x32_bf16 a[96:99], v[116:119], v[48:51], a[96:99]
  v_mfma_f32_16x16x32_bf16 a[100:103], v[116:119], v[52:55], a[100:103]
  ds_read_b64_tr_b16 v[88:89], v8 offset:16384
  s_add_u32 m0, s40, 58368
  s_add_u32 s42, s39, 1605632
  buffer_load_dwordx4 v3, s[32:35], s42 offen lds
  v_mfma_f32_16x16x32_bf16 a[104:107], v[116:119], v[56:59], a[104:107]
  v_mfma_f32_16x16x32_bf16 a[108:111], v[116:119], v[60:63], a[108:111]
  ds_read_b64_tr_b16 v[90:91], v8 offset:17408
  v_mfma_f32_16x16x32_bf16 a[112:115], v[116:119], v[64:67], a[112:115]
  v_mfma_f32_16x16x32_bf16 a[116:119], v[116:119], v[68:71], a[116:119]
  ds_read_b64_tr_b16 v[92:93], v8 offset:16392
  v_mfma_f32_16x16x32_bf16 a[120:123], v[116:119], v[72:75], a[120:123]
  s_add_u32 m0, s40, 40960
  s_add_u32 s42, s39, 1572864
  buffer_load_dwordx4 v3, s[12:15], s42 offen lds
  v_mfma_f32_16x16x32_bf16 a[124:127], v[116:119], v[76:79], a[124:127]
  ds_read_b64_tr_b16 v[94:95], v8 offset:17416
  v_mfma_f32_16x16x32_bf16 a[128:131], v[48:51], v[120:123], a[128:131]
  v_mfma_f32_16x16x32_bf16 a[132:135], v[52:55], v[120:123], a[132:135]
  ds_read_b64_tr_b16 v[96:97], v9 offset:24576
  v_mfma_f32_16x16x32_bf16 a[136:139], v[56:59], v[120:123], a[136:139]
  v_mfma_f32_16x16x32_bf16 a[140:143], v[60:63], v[120:123], a[140:143]
  ds_read_b64_tr_b16 v[98:99], v9 offset:25600
  s_add_u32 m0, s40, 41984
  s_add_u32 s42, s39, 1605632
  buffer_load_dwordx4 v3, s[12:15], s42 offen lds
  v_mfma_f32_16x16x32_bf16 a[144:147], v[64:67], v[120:123], a[144:147]
  v_mfma_f32_16x16x32_bf16 a[148:151], v[68:71], v[120:123], a[148:151]
  ds_read_b64_tr_b16 v[100:101], v9 offset:24608
  v_mfma_f32_16x16x32_bf16 a[152:155], v[72:75], v[120:123], a[152:155]
  v_mfma_f32_16x16x32_bf16 a[156:159], v[76:79], v[120:123], a[156:159]
  ds_read_b64_tr_b16 v[102:103], v9 offset:25632
  v_mfma_f32_16x16x32_bf16 a[160:163], v[48:51], v[124:127], a[160:163]
  v_mfma_f32_16x16x32_bf16 a[164:167], v[52:55], v[124:127], a[164:167]
  v_mfma_f32_16x16x32_bf16 a[168:171], v[56:59], v[124:127], a[168:171]
  v_mfma_f32_16x16x32_bf16 a[172:175], v[60:63], v[124:127], a[172:175]
  v_mfma_f32_16x16x32_bf16 a[176:179], v[64:67], v[124:127], a[176:179]
  v_mfma_f32_16x16x32_bf16 a[180:183], v[68:71], v[124:127], a[180:183]
  v_mfma_f32_16x16x32_bf16 a[184:187], v[72:75], v[124:127], a[184:187]
  v_mfma_f32_16x16x32_bf16 a[188:191], v[76:79], v[124:127], a[188:191]
  s_waitcnt lgkmcnt(0)
  s_waitcnt vmcnt(24)
  s_barrier
  v_mfma_f32_16x16x32_bf16 a[0:3], v[80:83], v[16:19], a[0:3]
  s_add_u32 m0, s43, 65536
  s_add_u32 s42, s38, 448
  buffer_load_dwordx4 v1, s[8:11], s42 offen lds
  v_mfma_f32_16x16x32_bf16 a[4:7], v[80:83], v[20:23], a[4:7]
  ds_read_b64_tr_b16 v[104:105], v8 offset:40960
  v_mfma_f32_16x16x32_bf16 a[8:11], v[80:83], v[24:27], a[8:11]
  v_mfma_f32_16x16x32_bf16 a[12:15], v[80:83], v[28:31], a[12:15]
  ds_read_b64_tr_b16 v[106:107], v8 offset:41984
  v_mfma_f32_16x16x32_bf16 a[16:19], v[80:83], v[32:35], a[16:19]
  v_mfma_f32_16x16x32_bf16 a[20:23], v[80:83], v[36:39], a[20:23]
  ds_read_b64_tr_b16 v[108:109], v8 offset:40968
  s_add_u32 m0, s43, 66560
  s_add_u32 s42, s38, 20928
  buffer_load_dwordx4 v2, s[8:11], s42 offen lds
  v_mfma_f32_16x16x32_bf16 a[24:27], v[80:83], v[40:43], a[24:27]
  v_mfma_f32_16x16x32_bf16 a[28:31], v[80:83], v[44:47], a[28:31]
  ds_read_b64_tr_b16 v[110:111], v8 offset:41992
  v_mfma_f32_16x16x32_bf16 a[32:35], v[84:87], v[16:19], a[32:35]
  v_mfma_f32_16x16x32_bf16 a[36:39], v[84:87], v[20:23], a[36:39]
  ds_read_b128 v[48:51], v7 offset:32768
  v_mfma_f32_16x16x32_bf16 a[40:43], v[84:87], v[24:27], a[40:43]
  s_add_u32 m0, s40, 81920
  s_add_u32 s42, s39, 1835008
  buffer_load_dwordx4 v3, s[28:31], s42 offen lds
  v_mfma_f32_16x16x32_bf16 a[44:47], v[84:87], v[28:31], a[44:47]
  ds_read_b128 v[52:55], v7 offset:33024
  v_mfma_f32_16x16x32_bf16 a[48:51], v[84:87], v[32:35], a[48:51]
  v_mfma_f32_16x16x32_bf16 a[52:55], v[84:87], v[36:39], a[52:55]
  ds_read_b128 v[56:59], v7 offset:34816
  v_mfma_f32_16x16x32_bf16 a[56:59], v[84:87], v[40:43], a[56:59]
  v_mfma_f32_16x16x32_bf16 a[60:63], v[84:87], v[44:47], a[60:63]
  ds_read_b128 v[60:63], v7 offset:35072
  s_add_u32 m0, s40, 82944
  s_add_u32 s42, s39, 1867776
  buffer_load_dwordx4 v3, s[28:31], s42 offen lds
  v_mfma_f32_16x16x32_bf16 a[64:67], v[88:91], v[16:19], a[64:67]
  v_mfma_f32_16x16x32_bf16 a[68:71], v[88:91], v[20:23], a[68:71]
  ds_read_b128 v[64:67], v7 offset:36864
  v_mfma_f32_16x16x32_bf16 a[72:75], v[88:91], v[24:27], a[72:75]
  v_mfma_f32_16x16x32_bf16 a[76:79], v[88:91], v[28:31], a[76:79]
  ds_read_b128 v[68:71], v7 offset:37120
  v_mfma_f32_16x16x32_bf16 a[80:83], v[88:91], v[32:35], a[80:83]
  s_add_u32 m0, s40, 90112
  s_add_u32 s42, s39, 1835008
  buffer_load_dwordx4 v3, s[32:35], s42 offen lds
  v_mfma_f32_16x16x32_bf16 a[84:87], v[88:91], v[36:39], a[84:87]
  ds_read_b128 v[72:75], v7 offset:38912
  v_mfma_f32_16x16x32_bf16 a[88:91], v[88:91], v[40:43], a[88:91]
  v_mfma_f32_16x16x32_bf16 a[92:95], v[88:91], v[44:47], a[92:95]
  ds_read_b128 v[76:79], v7 offset:39168
  v_mfma_f32_16x16x32_bf16 a[96:99], v[92:95], v[16:19], a[96:99]
  v_mfma_f32_16x16x32_bf16 a[100:103], v[92:95], v[20:23], a[100:103]
  ds_read_b64_tr_b16 v[112:113], v8 offset:49152
  s_add_u32 m0, s40, 91136
  s_add_u32 s42, s39, 1867776
  buffer_load_dwordx4 v3, s[32:35], s42 offen lds
  v_mfma_f32_16x16x32_bf16 a[104:107], v[92:95], v[24:27], a[104:107]
  v_mfma_f32_16x16x32_bf16 a[108:111], v[92:95], v[28:31], a[108:111]
  ds_read_b64_tr_b16 v[114:115], v8 offset:50176
  v_mfma_f32_16x16x32_bf16 a[112:115], v[92:95], v[32:35], a[112:115]
  v_mfma_f32_16x16x32_bf16 a[116:119], v[92:95], v[36:39], a[116:119]
  ds_read_b64_tr_b16 v[116:117], v8 offset:49160
  v_mfma_f32_16x16x32_bf16 a[120:123], v[92:95], v[40:43], a[120:123]
  s_add_u32 m0, s40, 73728
  s_add_u32 s42, s39, 1835008
  buffer_load_dwordx4 v3, s[12:15], s42 offen lds
  v_mfma_f32_16x16x32_bf16 a[124:127], v[92:95], v[44:47], a[124:127]
  ds_read_b64_tr_b16 v[118:119], v8 offset:50184
  v_mfma_f32_16x16x32_bf16 a[128:131], v[16:19], v[96:99], a[128:131]
  v_mfma_f32_16x16x32_bf16 a[132:135], v[20:23], v[96:99], a[132:135]
  ds_read_b64_tr_b16 v[120:121], v9 offset:57344
  v_mfma_f32_16x16x32_bf16 a[136:139], v[24:27], v[96:99], a[136:139]
  v_mfma_f32_16x16x32_bf16 a[140:143], v[28:31], v[96:99], a[140:143]
  ds_read_b64_tr_b16 v[122:123], v9 offset:58368
  s_add_u32 m0, s40, 74752
  s_add_u32 s42, s39, 1867776
  buffer_load_dwordx4 v3, s[12:15], s42 offen lds
  v_mfma_f32_16x16x32_bf16 a[144:147], v[32:35], v[96:99], a[144:147]
  v_mfma_f32_16x16x32_bf16 a[148:151], v[36:39], v[96:99], a[148:151]
  ds_read_b64_tr_b16 v[124:125], v9 offset:57376
  v_mfma_f32_16x16x32_bf16 a[152:155], v[40:43], v[96:99], a[152:155]
  v_mfma_f32_16x16x32_bf16 a[156:159], v[44:47], v[96:99], a[156:159]
  ds_read_b64_tr_b16 v[126:127], v9 offset:58400
  v_mfma_f32_16x16x32_bf16 a[160:163], v[16:19], v[100:103], a[160:163]
  v_mfma_f32_16x16x32_bf16 a[164:167], v[20:23], v[100:103], a[164:167]
  v_mfma_f32_16x16x32_bf16 a[168:171], v[24:27], v[100:103], a[168:171]
  v_mfma_f32_16x16x32_bf16 a[172:175], v[28:31], v[100:103], a[172:175]
  v_mfma_f32_16x16x32_bf16 a[176:179], v[32:35], v[100:103], a[176:179]
  v_mfma_f32_16x16x32_bf16 a[180:183], v[36:39], v[100:103], a[180:183]
  v_mfma_f32_16x16x32_bf16 a[184:187], v[40:43], v[100:103], a[184:187]
  v_mfma_f32_16x16x32_bf16 a[188:191], v[44:47], v[100:103], a[188:191]
  s_waitcnt lgkmcnt(0)
  s_waitcnt vmcnt(24)
  s_barrier
  v_mfma_f32_16x16x32_bf16 a[0:3], v[104:107], v[48:51], a[0:3]
  s_add_u32 m0, s43, 98304
  s_add_u32 s42, s38, 512
  buffer_load_dwordx4 v1, s[8:11], s42 offen lds
  v_mfma_f32_16x16x32_bf16 a[4:7], v[104:107], v[52:55], a[4:7]
  ds_read_b64_tr_b16 v[80:81], v11 offset:8192
  v_mfma_f32_16x16x32_bf16 a[8:11], v[104:107], v[56:59], a[8:11]
  v_mfma_f32_16x16x32_bf16 a[12:15], v[104:107], v[60:63], a[12:15]
  ds_read_b64_tr_b16 v[82:83], v11 offset:9216
  v_mfma_f32_16x16x32_bf16 a[16:19], v[104:107], v[64:67], a[16:19]
  v_mfma_f32_16x16x32_bf16 a[20:23], v[104:107], v[68:71], a[20:23]
  ds_read_b64_tr_b16 v[84:85], v11 offset:8200
  s_add_u32 m0, s43, 99328
  s_add_u32 s42, s38, 20992
  buffer_load_dwordx4 v2, s[8:11], s42 offen lds
  v_mfma_f32_16x16x32_bf16 a[24:27], v[104:107], v[72:75], a[24:27]
  v_mfma_f32_16x16x32_bf16 a[28:31], v[104:107], v[76:79], a[28:31]
  ds_read_b64_tr_b16 v[86:87], v11 offset:9224
  v_mfma_f32_16x16x32_bf16 a[32:35], v[108:111], v[48:51], a[32:35]
  v_mfma_f32_16x16x32_bf16 a[36:39], v[108:111], v[52:55], a[36:39]
  ds_read_b128 v[16:19], v10 offset:0
  v_mfma_f32_16x16x32_bf16 a[40:43], v[108:111], v[56:59], a[40:43]
  s_add_u32 m0, s40, 114688
  s_add_u32 s42, s39, 2097152
  buffer_load_dwordx4 v3, s[28:31], s42 offen lds
  v_mfma_f32_16x16x32_bf16 a[44:47], v[108:111], v[60:63], a[44:47]
  ds_read_b128 v[20:23], v10 offset:256
  v_mfma_f32_16x16x32_bf16 a[48:51], v[108:111], v[64:67], a[48:51]
  v_mfma_f32_16x16x32_bf16 a[52:55], v[108:111], v[68:71], a[52:55]
  ds_read_b128 v[24:27], v10 offset:2048
  v_mfma_f32_16x16x32_bf16 a[56:59], v[108:111], v[72:75], a[56:59]
  v_mfma_f32_16x16x32_bf16 a[60:63], v[108:111], v[76:79], a[60:63]
  ds_read_b128 v[28:31], v10 offset:2304
  s_add_u32 m0, s40, 115712
  s_add_u32 s42, s39, 2129920
  buffer_load_dwordx4 v3, s[28:31], s42 offen lds
  v_mfma_f32_16x16x32_bf16 a[64:67], v[112:115], v[48:51], a[64:67]
  v_mfma_f32_16x16x32_bf16 a[68:71], v[112:115], v[52:55], a[68:71]
  ds_read_b128 v[32:35], v10 offset:4096
  v_mfma_f32_16x16x32_bf16 a[72:75], v[112:115], v[56:59], a[72:75]
  v_mfma_f32_16x16x32_bf16 a[76:79], v[112:115], v[60:63], a[76:79]
  ds_read_b128 v[36:39], v10 offset:4352
  v_mfma_f32_16x16x32_bf16 a[80:83], v[112:115], v[64:67], a[80:83]
  s_add_u32 m0, s40, 122880
  s_add_u32 s42, s39, 2097152
  buffer_load_dwordx4 v3, s[32:35], s42 offen lds
  v_mfma_f32_16x16x32_bf16 a[84:87], v[112:115], v[68:71], a[84:87]
  ds_read_b128 v[40:43], v10 offset:6144
  v_mfma_f32_16x16x32_bf16 a[88:91], v[112:115], v[72:75], a[88:91]
  v_mfma_f32_16x16x32_bf16 a[92:95], v[112:115], v[76:79], a[92:95]
  ds_read_b128 v[44:47], v10 offset:6400
  v_mfma_f32_16x16x32_bf16 a[96:99], v[116:119], v[48:51], a[96:99]
  v_mfma_f32_16x16x32_bf16 a[100:103], v[116:119], v[52:55], a[100:103]
  ds_read_b64_tr_b16 v[88:89], v11 offset:16384
  s_add_u32 m0, s40, 123904
  s_add_u32 s42, s39, 2129920
  buffer_load_dwordx4 v3, s[32:35], s42 offen lds
  v_mfma_f32_16x16x32_bf16 a[104:107], v[116:119], v[56:59], a[104:107]
  v_mfma_f32_16x16x32_bf16 a[108:111], v[116:119], v[60:63], a[108:111]
  ds_read_b64_tr_b16 v[90:91], v11 offset:17408
  v_mfma_f32_16x16x32_bf16 a[112:115], v[116:119], v[64:67], a[112:115]
  v_mfma_f32_16x16x32_bf16 a[116:119], v[116:119], v[68:71], a[116:119]
  ds_read_b64_tr_b16 v[92:93], v11 offset:16392
  v_mfma_f32_16x16x32_bf16 a[120:123], v[116:119], v[72:75], a[120:123]
  s_add_u32 m0, s40, 106496
  s_add_u32 s42, s39, 2097152
  buffer_load_dwordx4 v3, s[12:15], s42 offen lds
  v_mfma_f32_16x16x32_bf16 a[124:127], v[116:119], v[76:79], a[124:127]
  ds_read_b64_tr_b16 v[94:95], v11 offset:17416
  v_mfma_f32_16x16x32_bf16 a[128:131], v[48:51], v[120:123], a[128:131]
  v_mfma_f32_16x16x32_bf16 a[132:135], v[52:55], v[120:123], a[132:135]
  ds_read_b64_tr_b16 v[96:97], v12 offset:24576
  v_mfma_f32_16x16x32_bf16 a[136:139], v[56:59], v[120:123], a[136:139]
  v_mfma_f32_16x16x32_bf16 a[140:143], v[60:63], v[120:123], a[140:143]
  ds_read_b64_tr_b16 v[98:99], v12 offset:25600
  s_add_u32 m0, s40, 107520
  s_add_u32 s42, s39, 2129920
  buffer_load_dwordx4 v3, s[12:15], s42 offen lds
  v_mfma_f32_16x16x32_bf16 a[144:147], v[64:67], v[120:123], a[144:147]
  v_mfma_f32_16x16x32_bf16 a[148:151], v[68:71], v[120:123], a[148:151]
  ds_read_b64_tr_b16 v[100:101], v12 offset:24608
  v_mfma_f32_16x16x32_bf16 a[152:155], v[72:75], v[120:123], a[152:155]
  v_mfma_f32_16x16x32_bf16 a[156:159], v[76:79], v[120:123], a[156:159]
  ds_read_b64_tr_b16 v[102:103], v12 offset:25632
  v_mfma_f32_16x16x32_bf16 a[160:163], v[48:51], v[124:127], a[160:163]
  v_mfma_f32_16x16x32_bf16 a[164:167], v[52:55], v[124:127], a[164:167]
  v_mfma_f32_16x16x32_bf16 a[168:171], v[56:59], v[124:127], a[168:171]
  v_mfma_f32_16x16x32_bf16 a[172:175], v[60:63], v[124:127], a[172:175]
  v_mfma_f32_16x16x32_bf16 a[176:179], v[64:67], v[124:127], a[176:179]
  v_mfma_f32_16x16x32_bf16 a[180:183], v[68:71], v[124:127], a[180:183]
  v_mfma_f32_16x16x32_bf16 a[184:187], v[72:75], v[124:127], a[184:187]
  v_mfma_f32_16x16x32_bf16 a[188:191], v[76:79], v[124:127], a[188:191]
  s_waitcnt lgkmcnt(0)
  s_waitcnt vmcnt(24)
  s_barrier
  v_mfma_f32_16x16x32_bf16 a[0:3], v[80:83], v[16:19], a[0:3]
  s_add_u32 m0, s43, 131072
  s_add_u32 s42, s38, 576
  buffer_load_dwordx4 v1, s[8:11], s42 offen lds
  v_mfma_f32_16x16x32_bf16 a[4:7], v[80:83], v[20:23], a[4:7]
  ds_read_b64_tr_b16 v[104:105], v5 offset:8192
  v_mfma_f32_16x16x32_bf16 a[8:11], v[80:83], v[24:27], a[8:11]
  v_mfma_f32_16x16x32_bf16 a[12:15], v[80:83], v[28:31], a[12:15]
  ds_read_b64_tr_b16 v[106:107], v5 offset:9216
  v_mfma_f32_16x16x32_bf16 a[16:19], v[80:83], v[32:35], a[16:19]
  v_mfma_f32_16x16x32_bf16 a[20:23], v[80:83], v[36:39], a[20:23]
  ds_read_b64_tr_b16 v[108:109], v5 offset:8200
  s_add_u32 m0, s43, 132096
  s_add_u32 s42, s38, 21056
  buffer_load_dwordx4 v2, s[8:11], s42 offen lds
  v_mfma_f32_16x16x32_bf16 a[24:27], v[80:83], v[40:43], a[24:27]
  v_mfma_f32_16x16x32_bf16 a[28:31], v[80:83], v[44:47], a[28:31]
  ds_read_b64_tr_b16 v[110:111], v5 offset:9224
  v_mfma_f32_16x16x32_bf16 a[32:35], v[84:87], v[16:19], a[32:35]
  v_mfma_f32_16x16x32_bf16 a[36:39], v[84:87], v[20:23], a[36:39]
  ds_read_b128 v[48:51], v4 offset:0
  v_mfma_f32_16x16x32_bf16 a[40:43], v[84:87], v[24:27], a[40:43]
  s_add_u32 m0, s40, 147456
  s_add_u32 s42, s39, 2359296
  buffer_load_dwordx4 v3, s[28:31], s42 offen lds
  v_mfma_f32_16x16x32_bf16 a[44:47], v[84:87], v[28:31], a[44:47]
  ds_read_b128 v[52:55], v4 offset:256
  v_mfma_f32_16x16x32_bf16 a[48:51], v[84:87], v[32:35], a[48:51]
  v_mfma_f32_16x16x32_bf16 a[52:55], v[84:87], v[36:39], a[52:55]
  ds_read_b128 v[56:59], v4 offset:2048
  v_mfma_f32_16x16x32_bf16 a[56:59], v[84:87], v[40:43], a[56:59]
  v_mfma_f32_16x16x32_bf16 a[60:63], v[84:87], v[44:47], a[60:63]
  ds_read_b128 v[60:63], v4 offset:2304
  s_add_u32 m0, s40, 148480
  s_add_u32 s42, s39, 2392064
  buffer_load_dwordx4 v3, s[28:31], s42 offen lds
  v_mfma_f32_16x16x32_bf16 a[64:67], v[88:91], v[16:19], a[64:67]
  v_mfma_f32_16x16x32_bf16 a[68:71], v[88:91], v[20:23], a[68:71]
  ds_read_b128 v[64:67], v4 offset:4096
  v_mfma_f32_16x16x32_bf16 a[72:75], v[88:91], v[24:27], a[72:75]
  v_mfma_f32_16x16x32_bf16 a[76:79], v[88:91], v[28:31], a[76:79]
  ds_read_b128 v[68:71], v4 offset:4352
  v_mfma_f32_16x16x32_bf16 a[80:83], v[88:91], v[32:35], a[80:83]
  s_add_u32 m0, s40, 155648
  s_add_u32 s42, s39, 2359296
  buffer_load_dwordx4 v3, s[32:35], s42 offen lds
  v_mfma_f32_16x16x32_bf16 a[84:87], v[88:91], v[36:39], a[84:87]
  ds_read_b128 v[72:75], v4 offset:6144
  v_mfma_f32_16x16x32_bf16 a[88:91], v[88:91], v[40:43], a[88:91]
  v_mfma_f32_16x16x32_bf16 a[92:95], v[88:91], v[44:47], a[92:95]
  ds_read_b128 v[76:79], v4 offset:6400
  v_mfma_f32_16x16x32_bf16 a[96:99], v[92:95], v[16:19], a[96:99]
  v_mfma_f32_16x16x32_bf16 a[100:103], v[92:95], v[20:23], a[100:103]
  ds_read_b64_tr_b16 v[112:113], v5 offset:16384
  s_add_u32 m0, s40, 156672
  s_add_u32 s42, s39, 2392064
  buffer_load_dwordx4 v3, s[32:35], s42 offen lds
  v_mfma_f32_16x16x32_bf16 a[104:107], v[92:95], v[24:27], a[104:107]
  v_mfma_f32_16x16x32_bf16 a[108:111], v[92:95], v[28:31], a[108:111]
  ds_read_b64_tr_b16 v[114:115], v5 offset:17408
  v_mfma_f32_16x16x32_bf16 a[112:115], v[92:95], v[32:35], a[112:115]
  v_mfma_f32_16x16x32_bf16 a[116:119], v[92:95], v[36:39], a[116:119]
  ds_read_b64_tr_b16 v[116:117], v5 offset:16392
  v_mfma_f32_16x16x32_bf16 a[120:123], v[92:95], v[40:43], a[120:123]
  s_add_u32 m0, s40, 139264
  s_add_u32 s42, s39, 2359296
  buffer_load_dwordx4 v3, s[12:15], s42 offen lds
  v_mfma_f32_16x16x32_bf16 a[124:127], v[92:95], v[44:47], a[124:127]
  ds_read_b64_tr_b16 v[118:119], v5 offset:17416
  v_mfma_f32_16x16x32_bf16 a[128:131], v[16:19], v[96:99], a[128:131]
  v_mfma_f32_16x16x32_bf16 a[132:135], v[20:23], v[96:99], a[132:135]
  ds_read_b64_tr_b16 v[120:121], v6 offset:24576
  v_mfma_f32_16x16x32_bf16 a[136:139], v[24:27], v[96:99], a[136:139]
  v_mfma_f32_16x16x32_bf16 a[140:143], v[28:31], v[96:99], a[140:143]
  ds_read_b64_tr_b16 v[122:123], v6 offset:25600
  s_add_u32 m0, s40, 140288
  s_add_u32 s42, s39, 2392064
  buffer_load_dwordx4 v3, s[12:15], s42 offen lds
  v_mfma_f32_16x16x32_bf16 a[144:147], v[32:35], v[96:99], a[144:147]
  v_mfma_f32_16x16x32_bf16 a[148:151], v[36:39], v[96:99], a[148:151]
  ds_read_b64_tr_b16 v[124:125], v6 offset:24608
  v_mfma_f32_16x16x32_bf16 a[152:155], v[40:43], v[96:99], a[152:155]
  v_mfma_f32_16x16x32_bf16 a[156:159], v[44:47], v[96:99], a[156:159]
  ds_read_b64_tr_b16 v[126:127], v6 offset:25632
  v_mfma_f32_16x16x32_bf16 a[160:163], v[16:19], v[100:103], a[160:163]
  v_mfma_f32_16x16x32_bf16 a[164:167], v[20:23], v[100:103], a[164:167]
  v_mfma_f32_16x16x32_bf16 a[168:171], v[24:27], v[100:103], a[168:171]
  v_mfma_f32_16x16x32_bf16 a[172:175], v[28:31], v[100:103], a[172:175]
  v_mfma_f32_16x16x32_bf16 a[176:179], v[32:35], v[100:103], a[176:179]
  v_mfma_f32_16x16x32_bf16 a[180:183], v[36:39], v[100:103], a[180:183]
  v_mfma_f32_16x16x32_bf16 a[184:187], v[40:43], v[100:103], a[184:187]
  v_mfma_f32_16x16x32_bf16 a[188:191], v[44:47], v[100:103], a[188:191]
  s_waitcnt lgkmcnt(0)
  s_waitcnt vmcnt(24)
  s_barrier
  v_mfma_f32_16x16x32_bf16 a[0:3], v[104:107], v[48:51], a[0:3]
  s_add_u32 m0, s43, 0
  s_add_u32 s42, s38, 640
  buffer_load_dwordx4 v1, s[8:11], s42 offen lds
  v_mfma_f32_16x16x32_bf16 a[4:7], v[104:107], v[52:55], a[4:7]
  ds_read_b64_tr_b16 v[80:81], v5 offset:40960
  v_mfma_f32_16x16x32_bf16 a[8:11], v[104:107], v[56:59], a[8:11]
  v_mfma_f32_16x16x32_bf16 a[12:15], v[104:107], v[60:63], a[12:15]
  ds_read_b64_tr_b16 v[82:83], v5 offset:41984
  v_mfma_f32_16x16x32_bf16 a[16:19], v[104:107], v[64:67], a[16:19]
  v_mfma_f32_16x16x32_bf16 a[20:23], v[104:107], v[68:71], a[20:23]
  ds_read_b64_tr_b16 v[84:85], v5 offset:40968
  s_add_u32 m0, s43, 1024
  s_add_u32 s42, s38, 21120
  buffer_load_dwordx4 v2, s[8:11], s42 offen lds
  v_mfma_f32_16x16x32_bf16 a[24:27], v[104:107], v[72:75], a[24:27]
  v_mfma_f32_16x16x32_bf16 a[28:31], v[104:107], v[76:79], a[28:31]
  ds_read_b64_tr_b16 v[86:87], v5 offset:41992
  v_mfma_f32_16x16x32_bf16 a[32:35], v[108:111], v[48:51], a[32:35]
  v_mfma_f32_16x16x32_bf16 a[36:39], v[108:111], v[52:55], a[36:39]
  ds_read_b128 v[16:19], v4 offset:32768
  v_mfma_f32_16x16x32_bf16 a[40:43], v[108:111], v[56:59], a[40:43]
  s_add_u32 m0, s40, 16384
  s_add_u32 s42, s39, 2621440
  buffer_load_dwordx4 v3, s[28:31], s42 offen lds
  v_mfma_f32_16x16x32_bf16 a[44:47], v[108:111], v[60:63], a[44:47]
  ds_read_b128 v[20:23], v4 offset:33024
  v_mfma_f32_16x16x32_bf16 a[48:51], v[108:111], v[64:67], a[48:51]
  v_mfma_f32_16x16x32_bf16 a[52:55], v[108:111], v[68:71], a[52:55]
  ds_read_b128 v[24:27], v4 offset:34816
  v_mfma_f32_16x16x32_bf16 a[56:59], v[108:111], v[72:75], a[56:59]
  v_mfma_f32_16x16x32_bf16 a[60:63], v[108:111], v[76:79], a[60:63]
  ds_read_b128 v[28:31], v4 offset:35072
  s_add_u32 m0, s40, 17408
  s_add_u32 s42, s39, 2654208
  buffer_load_dwordx4 v3, s[28:31], s42 offen lds
  v_mfma_f32_16x16x32_bf16 a[64:67], v[112:115], v[48:51], a[64:67]
  v_mfma_f32_16x16x32_bf16 a[68:71], v[112:115], v[52:55], a[68:71]
  ds_read_b128 v[32:35], v4 offset:36864
  v_mfma_f32_16x16x32_bf16 a[72:75], v[112:115], v[56:59], a[72:75]
  v_mfma_f32_16x16x32_bf16 a[76:79], v[112:115], v[60:63], a[76:79]
  ds_read_b128 v[36:39], v4 offset:37120
  v_mfma_f32_16x16x32_bf16 a[80:83], v[112:115], v[64:67], a[80:83]
  s_add_u32 m0, s40, 24576
  s_add_u32 s42, s39, 2621440
  buffer_load_dwordx4 v3, s[32:35], s42 offen lds
  v_mfma_f32_16x16x32_bf16 a[84:87], v[112:115], v[68:71], a[84:87]
  ds_read_b128 v[40:43], v4 offset:38912
  v_mfma_f32_16x16x32_bf16 a[88:91], v[112:115], v[72:75], a[88:91]
  v_mfma_f32_16x16x32_bf16 a[92:95], v[112:115], v[76:79], a[92:95]
  ds_read_b128 v[44:47], v4 offset:39168
  v_mfma_f32_16x16x32_bf16 a[96:99], v[116:119], v[48:51], a[96:99]
  v_mfma_f32_16x16x32_bf16 a[100:103], v[116:119], v[52:55], a[100:103]
  ds_read_b64_tr_b16 v[88:89], v5 offset:49152
  s_add_u32 m0, s40, 25600
  s_add_u32 s42, s39, 2654208
  buffer_load_dwordx4 v3, s[32:35], s42 offen lds
  v_mfma_f32_16x16x32_bf16 a[104:107], v[116:119], v[56:59], a[104:107]
  v_mfma_f32_16x16x32_bf16 a[108:111], v[116:119], v[60:63], a[108:111]
  ds_read_b64_tr_b16 v[90:91], v5 offset:50176
  v_mfma_f32_16x16x32_bf16 a[112:115], v[116:119], v[64:67], a[112:115]
  v_mfma_f32_16x16x32_bf16 a[116:119], v[116:119], v[68:71], a[116:119]
  ds_read_b64_tr_b16 v[92:93], v5 offset:49160
  v_mfma_f32_16x16x32_bf16 a[120:123], v[116:119], v[72:75], a[120:123]
  s_add_u32 m0, s40, 8192
  s_add_u32 s42, s39, 2621440
  buffer_load_dwordx4 v3, s[12:15], s42 offen lds
  v_mfma_f32_16x16x32_bf16 a[124:127], v[116:119], v[76:79], a[124:127]
  ds_read_b64_tr_b16 v[94:95], v5 offset:50184
  v_mfma_f32_16x16x32_bf16 a[128:131], v[48:51], v[120:123], a[128:131]
  v_mfma_f32_16x16x32_bf16 a[132:135], v[52:55], v[120:123], a[132:135]
  ds_read_b64_tr_b16 v[96:97], v6 offset:57344
  v_mfma_f32_16x16x32_bf16 a[136:139], v[56:59], v[120:123], a[136:139]
  v_mfma_f32_16x16x32_bf16 a[140:143], v[60:63], v[120:123], a[140:143]
  ds_read_b64_tr_b16 v[98:99], v6 offset:58368
  s_add_u32 m0, s40, 9216
  s_add_u32 s42, s39, 2654208
  buffer_load_dwordx4 v3, s[12:15], s42 offen lds
  v_mfma_f32_16x16x32_bf16 a[144:147], v[64:67], v[120:123], a[144:147]
  v_mfma_f32_16x16x32_bf16 a[148:151], v[68:71], v[120:123], a[148:151]
  ds_read_b64_tr_b16 v[100:101], v6 offset:57376
  v_mfma_f32_16x16x32_bf16 a[152:155], v[72:75], v[120:123], a[152:155]
  v_mfma_f32_16x16x32_bf16 a[156:159], v[76:79], v[120:123], a[156:159]
  ds_read_b64_tr_b16 v[102:103], v6 offset:58400
  v_mfma_f32_16x16x32_bf16 a[160:163], v[48:51], v[124:127], a[160:163]
  v_mfma_f32_16x16x32_bf16 a[164:167], v[52:55], v[124:127], a[164:167]
  v_mfma_f32_16x16x32_bf16 a[168:171], v[56:59], v[124:127], a[168:171]
  v_mfma_f32_16x16x32_bf16 a[172:175], v[60:63], v[124:127], a[172:175]
  v_mfma_f32_16x16x32_bf16 a[176:179], v[64:67], v[124:127], a[176:179]
  v_mfma_f32_16x16x32_bf16 a[180:183], v[68:71], v[124:127], a[180:183]
  v_mfma_f32_16x16x32_bf16 a[184:187], v[72:75], v[124:127], a[184:187]
  v_mfma_f32_16x16x32_bf16 a[188:191], v[76:79], v[124:127], a[188:191]
  s_waitcnt lgkmcnt(0)
  s_waitcnt vmcnt(24)
  s_barrier
  v_mfma_f32_16x16x32_bf16 a[0:3], v[80:83], v[16:19], a[0:3]
  s_add_u32 m0, s43, 32768
  s_add_u32 s42, s38, 704
  buffer_load_dwordx4 v1, s[8:11], s42 offen lds
  v_mfma_f32_16x16x32_bf16 a[4:7], v[80:83], v[20:23], a[4:7]
  ds_read_b64_tr_b16 v[104:105], v8 offset:8192
  v_mfma_f32_16x16x32_bf16 a[8:11], v[80:83], v[24:27], a[8:11]
  v_mfma_f32_16x16x32_bf16 a[12:15], v[80:83], v[28:31], a[12:15]
  ds_read_b64_tr_b16 v[106:107], v8 offset:9216
  v_mfma_f32_16x16x32_bf16 a[16:19], v[80:83], v[32:35], a[16:19]
  v_mfma_f32_16x16x32_bf16 a[20:23], v[80:83], v[36:39], a[20:23]
  ds_read_b64_tr_b16 v[108:109], v8 offset:8200
  s_add_u32 m0, s43, 33792
  s_add_u32 s42, s38, 21184
  buffer_load_dwordx4 v2, s[8:11], s42 offen lds
  v_mfma_f32_16x16x32_bf16 a[24:27], v[80:83], v[40:43], a[24:27]
  v_mfma_f32_16x16x32_bf16 a[28:31], v[80:83], v[44:47], a[28:31]
  ds_read_b64_tr_b16 v[110:111], v8 offset:9224
  v_mfma_f32_16x16x32_bf16 a[32:35], v[84:87], v[16:19], a[32:35]
  v_mfma_f32_16x16x32_bf16 a[36:39], v[84:87], v[20:23], a[36:39]
  ds_read_b128 v[48:51], v7 offset:0
  v_mfma_f32_16x16x32_bf16 a[40:43], v[84:87], v[24:27], a[40:43]
  s_add_u32 m0, s40, 49152
  s_add_u32 s42, s39, 2883584
  buffer_load_dwordx4 v3, s[28:31], s42 offen lds
  v_mfma_f32_16x16x32_bf16 a[44:47], v[84:87], v[28:31], a[44:47]
  ds_read_b128 v[52:55], v7 offset:256
  v_mfma_f32_16x16x32_bf16 a[48:51], v[84:87], v[32:35], a[48:51]
  v_mfma_f32_16x16x32_bf16 a[52:55], v[84:87], v[36:39], a[52:55]
  ds_read_b128 v[56:59], v7 offset:2048
  v_mfma_f32_16x16x32_bf16 a[56:59], v[84:87], v[40:43], a[56:59]
  v_mfma_f32_16x16x32_bf16 a[60:63], v[84:87], v[44:47], a[60:63]
  ds_read_b128 v[60:63], v7 offset:2304
  s_add_u32 m0, s40, 50176
  s_add_u32 s42, s39, 2916352
  buffer_load_dwordx4 v3, s[28:31], s42 offen lds
  v_mfma_f32_16x16x32_bf16 a[64:67], v[88:91], v[16:19], a[64:67]
  v_mfma_f32_16x16x32_bf16 a[68:71], v[88:91], v[20:23], a[68:71]
  ds_read_b128 v[64:67], v7 offset:4096
  v_mfma_f32_16x16x32_bf16 a[72:75], v[88:91], v[24:27], a[72:75]
  v_mfma_f32_16x16x32_bf16 a[76:79], v[88:91], v[28:31], a[76:79]
  ds_read_b128 v[68:71], v7 offset:4352
  v_mfma_f32_16x16x32_bf16 a[80:83], v[88:91], v[32:35], a[80:83]
  s_add_u32 m0, s40, 57344
  s_add_u32 s42, s39, 2883584
  buffer_load_dwordx4 v3, s[32:35], s42 offen lds
  v_mfma_f32_16x16x32_bf16 a[84:87], v[88:91], v[36:39], a[84:87]
  ds_read_b128 v[72:75], v7 offset:6144
  v_mfma_f32_16x16x32_bf16 a[88:91], v[88:91], v[40:43], a[88:91]
  v_mfma_f32_16x16x32_bf16 a[92:95], v[88:91], v[44:47], a[92:95]
  ds_read_b128 v[76:79], v7 offset:6400
  v_mfma_f32_16x16x32_bf16 a[96:99], v[92:95], v[16:19], a[96:99]
  v_mfma_f32_16x16x32_bf16 a[100:103], v[92:95], v[20:23], a[100:103]
  ds_read_b64_tr_b16 v[112:113], v8 offset:16384
  s_add_u32 m0, s40, 58368
  s_add_u32 s42, s39, 2916352
  buffer_load_dwordx4 v3, s[32:35], s42 offen lds
  v_mfma_f32_16x16x32_bf16 a[104:107], v[92:95], v[24:27], a[104:107]
  v_mfma_f32_16x16x32_bf16 a[108:111], v[92:95], v[28:31], a[108:111]
  ds_read_b64_tr_b16 v[114:115], v8 offset:17408
  v_mfma_f32_16x16x32_bf16 a[112:115], v[92:95], v[32:35], a[112:115]
  v_mfma_f32_16x16x32_bf16 a[116:119], v[92:95], v[36:39], a[116:119]
  ds_read_b64_tr_b16 v[116:117], v8 offset:16392
  v_mfma_f32_16x16x32_bf16 a[120:123], v[92:95], v[40:43], a[120:123]
  s_add_u32 m0, s40, 40960
  s_add_u32 s42, s39, 2883584
  buffer_load_dwordx4 v3, s[12:15], s42 offen lds
  v_mfma_f32_16x16x32_bf16 a[124:127], v[92:95], v[44:47], a[124:127]
  ds_read_b64_tr_b16 v[118:119], v8 offset:17416
  v_mfma_f32_16x16x32_bf16 a[128:131], v[16:19], v[96:99], a[128:131]
  v_mfma_f32_16x16x32_bf16 a[132:135], v[20:23], v[96:99], a[132:135]
  ds_read_b64_tr_b16 v[120:121], v9 offset:24576
  v_mfma_f32_16x16x32_bf16 a[136:139], v[24:27], v[96:99], a[136:139]
  v_mfma_f32_16x16x32_bf16 a[140:143], v[28:31], v[96:99], a[140:143]
  ds_read_b64_tr_b16 v[122:123], v9 offset:25600
  s_add_u32 m0, s40, 41984
  s_add_u32 s42, s39, 2916352
  buffer_load_dwordx4 v3, s[12:15], s42 offen lds
  v_mfma_f32_16x16x32_bf16 a[144:147], v[32:35], v[96:99], a[144:147]
  v_mfma_f32_16x16x32_bf16 a[148:151], v[36:39], v[96:99], a[148:151]
  ds_read_b64_tr_b16 v[124:125], v9 offset:24608
  v_mfma_f32_16x16x32_bf16 a[152:155], v[40:43], v[96:99], a[152:155]
  v_mfma_f32_16x16x32_bf16 a[156:159], v[44:47], v[96:99], a[156:159]
  ds_read_b64_tr_b16 v[126:127], v9 offset:25632
  v_mfma_f32_16x16x32_bf16 a[160:163], v[16:19], v[100:103], a[160:163]
  v_mfma_f32_16x16x32_bf16 a[164:167], v[20:23], v[100:103], a[164:167]
  v_mfma_f32_16x16x32_bf16 a[168:171], v[24:27], v[100:103], a[168:171]
  v_mfma_f32_16x16x32_bf16 a[172:175], v[28:31], v[100:103], a[172:175]
  v_mfma_f32_16x16x32_bf16 a[176:179], v[32:35], v[100:103], a[176:179]
  v_mfma_f32_16x16x32_bf16 a[180:183], v[36:39], v[100:103], a[180:183]
  v_mfma_f32_16x16x32_bf16 a[184:187], v[40:43], v[100:103], a[184:187]
  v_mfma_f32_16x16x32_bf16 a[188:191], v[44:47], v[100:103], a[188:191]
  s_waitcnt lgkmcnt(0)
  s_waitcnt vmcnt(24)
  s_barrier
  v_mfma_f32_16x16x32_bf16 a[0:3], v[104:107], v[48:51], a[0:3]
  s_add_u32 m0, s43, 65536
  s_add_u32 s42, s38, 768
  buffer_load_dwordx4 v1, s[8:11], s42 offen lds
  v_mfma_f32_16x16x32_bf16 a[4:7], v[104:107], v[52:55], a[4:7]
  ds_read_b64_tr_b16 v[80:81], v8 offset:40960
  v_mfma_f32_16x16x32_bf16 a[8:11], v[104:107], v[56:59], a[8:11]
  v_mfma_f32_16x16x32_bf16 a[12:15], v[104:107], v[60:63], a[12:15]
  ds_read_b64_tr_b16 v[82:83], v8 offset:41984
  v_mfma_f32_16x16x32_bf16 a[16:19], v[104:107], v[64:67], a[16:19]
  v_mfma_f32_16x16x32_bf16 a[20:23], v[104:107], v[68:71], a[20:23]
  ds_read_b64_tr_b16 v[84:85], v8 offset:40968
  s_add_u32 m0, s43, 66560
  s_add_u32 s42, s38, 21248
  buffer_load_dwordx4 v2, s[8:11], s42 offen lds
  v_mfma_f32_16x16x32_bf16 a[24:27], v[104:107], v[72:75], a[24:27]
  v_mfma_f32_16x16x32_bf16 a[28:31], v[104:107], v[76:79], a[28:31]
  ds_read_b64_tr_b16 v[86:87], v8 offset:41992
  v_mfma_f32_16x16x32_bf16 a[32:35], v[108:111], v[48:51], a[32:35]
  v_mfma_f32_16x16x32_bf16 a[36:39], v[108:111], v[52:55], a[36:39]
  ds_read_b128 v[16:19], v7 offset:32768
  v_mfma_f32_16x16x32_bf16 a[40:43], v[108:111], v[56:59], a[40:43]
  s_add_u32 m0, s40, 81920
  s_add_u32 s42, s39, 3145728
  buffer_load_dwordx4 v3, s[28:31], s42 offen lds
  v_mfma_f32_16x16x32_bf16 a[44:47], v[108:111], v[60:63], a[44:47]
  ds_read_b128 v[20:23], v7 offset:33024
  v_mfma_f32_16x16x32_bf16 a[48:51], v[108:111], v[64:67], a[48:51]
  v_mfma_f32_16x16x32_bf16 a[52:55], v[108:111], v[68:71], a[52:55]
  ds_read_b128 v[24:27], v7 offset:34816
  v_mfma_f32_16x16x32_bf16 a[56:59], v[108:111], v[72:75], a[56:59]
  v_mfma_f32_16x16x32_bf16 a[60:63], v[108:111], v[76:79], a[60:63]
  ds_read_b128 v[28:31], v7 offset:35072
  s_add_u32 m0, s40, 82944
  s_add_u32 s42, s39, 3178496
  buffer_load_dwordx4 v3, s[28:31], s42 offen lds
  v_mfma_f32_16x16x32_bf16 a[64:67], v[112:115], v[48:51], a[64:67]
  v_mfma_f32_16x16x32_bf16 a[68:71], v[112:115], v[52:55], a[68:71]
  ds_read_b128 v[32:35], v7 offset:36864
  v_mfma_f32_16x16x32_bf16 a[72:75], v[112:115], v[56:59], a[72:75]
  v_mfma_f32_16x16x32_bf16 a[76:79], v[112:115], v[60:63], a[76:79]
  ds_read_b128 v[36:39], v7 offset:37120
  v_mfma_f32_16x16x32_bf16 a[80:83], v[112:115], v[64:67], a[80:83]
  s_add_u32 m0, s40, 90112
  s_add_u32 s42, s39, 3145728
  buffer_load_dwordx4 v3, s[32:35], s42 offen lds
  v_mfma_f32_16x16x32_bf16 a[84:87], v[112:115], v[68:71], a[84:87]
  ds_read_b128 v[40:43], v7 offset:38912
  v_mfma_f32_16x16x32_bf16 a[88:91], v[112:115], v[72:75], a[88:91]
  v_mfma_f32_16x16x32_bf16 a[92:95], v[112:115], v[76:79], a[92:95]
  ds_read_b128 v[44:47], v7 offset:39168
  v_mfma_f32_16x16x32_bf16 a[96:99], v[116:119], v[48:51], a[96:99]
  v_mfma_f32_16x16x32_bf16 a[100:103], v[116:119], v[52:55], a[100:103]
  ds_read_b64_tr_b16 v[88:89], v8 offset:49152
  s_add_u32 m0, s40, 91136
  s_add_u32 s42, s39, 3178496
  buffer_load_dwordx4 v3, s[32:35], s42 offen lds
  v_mfma_f32_16x16x32_bf16 a[104:107], v[116:119], v[56:59], a[104:107]
  v_mfma_f32_16x16x32_bf16 a[108:111], v[116:119], v[60:63], a[108:111]
  ds_read_b64_tr_b16 v[90:91], v8 offset:50176
  v_mfma_f32_16x16x32_bf16 a[112:115], v[116:119], v[64:67], a[112:115]
  v_mfma_f32_16x16x32_bf16 a[116:119], v[116:119], v[68:71], a[116:119]
  ds_read_b64_tr_b16 v[92:93], v8 offset:49160
  v_mfma_f32_16x16x32_bf16 a[120:123], v[116:119], v[72:75], a[120:123]
  s_add_u32 m0, s40, 73728
  s_add_u32 s42, s39, 3145728
  buffer_load_dwordx4 v3, s[12:15], s42 offen lds
  v_mfma_f32_16x16x32_bf16 a[124:127], v[116:119], v[76:79], a[124:127]
  ds_read_b64_tr_b16 v[94:95], v8 offset:50184
  v_mfma_f32_16x16x32_bf16 a[128:131], v[48:51], v[120:123], a[128:131]
  v_mfma_f32_16x16x32_bf16 a[132:135], v[52:55], v[120:123], a[132:135]
  ds_read_b64_tr_b16 v[96:97], v9 offset:57344
  v_mfma_f32_16x16x32_bf16 a[136:139], v[56:59], v[120:123], a[136:139]
  v_mfma_f32_16x16x32_bf16 a[140:143], v[60:63], v[120:123], a[140:143]
  ds_read_b64_tr_b16 v[98:99], v9 offset:58368
  s_add_u32 m0, s40, 74752
  s_add_u32 s42, s39, 3178496
  buffer_load_dwordx4 v3, s[12:15], s42 offen lds
  v_mfma_f32_16x16x32_bf16 a[144:147], v[64:67], v[120:123], a[144:147]
  v_mfma_f32_16x16x32_bf16 a[148:151], v[68:71], v[120:123], a[148:151]
  ds_read_b64_tr_b16 v[100:101], v9 offset:57376
  v_mfma_f32_16x16x32_bf16 a[152:155], v[72:75], v[120:123], a[152:155]
  v_mfma_f32_16x16x32_bf16 a[156:159], v[76:79], v[120:123], a[156:159]
  ds_read_b64_tr_b16 v[102:103], v9 offset:58400
  v_mfma_f32_16x16x32_bf16 a[160:163], v[48:51], v[124:127], a[160:163]
  v_mfma_f32_16x16x32_bf16 a[164:167], v[52:55], v[124:127], a[164:167]
  v_mfma_f32_16x16x32_bf16 a[168:171], v[56:59], v[124:127], a[168:171]
  v_mfma_f32_16x16x32_bf16 a[172:175], v[60:63], v[124:127], a[172:175]
  v_mfma_f32_16x16x32_bf16 a[176:179], v[64:67], v[124:127], a[176:179]
  v_mfma_f32_16x16x32_bf16 a[180:183], v[68:71], v[124:127], a[180:183]
  v_mfma_f32_16x16x32_bf16 a[184:187], v[72:75], v[124:127], a[184:187]
  v_mfma_f32_16x16x32_bf16 a[188:191], v[76:79], v[124:127], a[188:191]
  s_waitcnt lgkmcnt(0)
  s_waitcnt vmcnt(24)
  s_barrier
  v_mfma_f32_16x16x32_bf16 a[0:3], v[80:83], v[16:19], a[0:3]
  s_add_u32 m0, s43, 98304
  s_add_u32 s42, s38, 832
  buffer_load_dwordx4 v1, s[8:11], s42 offen lds
  v_mfma_f32_16x16x32_bf16 a[4:7], v[80:83], v[20:23], a[4:7]
  ds_read_b64_tr_b16 v[104:105], v11 offset:8192
  v_mfma_f32_16x16x32_bf16 a[8:11], v[80:83], v[24:27], a[8:11]
  v_mfma_f32_16x16x32_bf16 a[12:15], v[80:83], v[28:31], a[12:15]
  ds_read_b64_tr_b16 v[106:107], v11 offset:9216
  v_mfma_f32_16x16x32_bf16 a[16:19], v[80:83], v[32:35], a[16:19]
  v_mfma_f32_16x16x32_bf16 a[20:23], v[80:83], v[36:39], a[20:23]
  ds_read_b64_tr_b16 v[108:109], v11 offset:8200
  s_add_u32 m0, s43, 99328
  s_add_u32 s42, s38, 21312
  buffer_load_dwordx4 v2, s[8:11], s42 offen lds
  v_mfma_f32_16x16x32_bf16 a[24:27], v[80:83], v[40:43], a[24:27]
  v_mfma_f32_16x16x32_bf16 a[28:31], v[80:83], v[44:47], a[28:31]
  ds_read_b64_tr_b16 v[110:111], v11 offset:9224
  v_mfma_f32_16x16x32_bf16 a[32:35], v[84:87], v[16:19], a[32:35]
  v_mfma_f32_16x16x32_bf16 a[36:39], v[84:87], v[20:23], a[36:39]
  ds_read_b128 v[48:51], v10 offset:0
  v_mfma_f32_16x16x32_bf16 a[40:43], v[84:87], v[24:27], a[40:43]
  s_add_u32 m0, s40, 114688
  s_add_u32 s42, s39, 3407872
  buffer_load_dwordx4 v3, s[28:31], s42 offen lds
  v_mfma_f32_16x16x32_bf16 a[44:47], v[84:87], v[28:31], a[44:47]
  ds_read_b128 v[52:55], v10 offset:256
  v_mfma_f32_16x16x32_bf16 a[48:51], v[84:87], v[32:35], a[48:51]
  v_mfma_f32_16x16x32_bf16 a[52:55], v[84:87], v[36:39], a[52:55]
  ds_read_b128 v[56:59], v10 offset:2048
  v_mfma_f32_16x16x32_bf16 a[56:59], v[84:87], v[40:43], a[56:59]
  v_mfma_f32_16x16x32_bf16 a[60:63], v[84:87], v[44:47], a[60:63]
  ds_read_b128 v[60:63], v10 offset:2304
  s_add_u32 m0, s40, 115712
  s_add_u32 s42, s39, 3440640
  buffer_load_dwordx4 v3, s[28:31], s42 offen lds
  v_mfma_f32_16x16x32_bf16 a[64:67], v[88:91], v[16:19], a[64:67]
  v_mfma_f32_16x16x32_bf16 a[68:71], v[88:91], v[20:23], a[68:71]
  ds_read_b128 v[64:67], v10 offset:4096
  v_mfma_f32_16x16x32_bf16 a[72:75], v[88:91], v[24:27], a[72:75]
  v_mfma_f32_16x16x32_bf16 a[76:79], v[88:91], v[28:31], a[76:79]
  ds_read_b128 v[68:71], v10 offset:4352
  v_mfma_f32_16x16x32_bf16 a[80:83], v[88:91], v[32:35], a[80:83]
  s_add_u32 m0, s40, 122880
  s_add_u32 s42, s39, 3407872
  buffer_load_dwordx4 v3, s[32:35], s42 offen lds
  v_mfma_f32_16x16x32_bf16 a[84:87], v[88:91], v[36:39], a[84:87]
  ds_read_b128 v[72:75], v10 offset:6144
  v_mfma_f32_16x16x32_bf16 a[88:91], v[88:91], v[40:43], a[88:91]
  v_mfma_f32_16x16x32_bf16 a[92:95], v[88:91], v[44:47], a[92:95]
  ds_read_b128 v[76:79], v10 offset:6400
  v_mfma_f32_16x16x32_bf16 a[96:99], v[92:95], v[16:19], a[96:99]
  v_mfma_f32_16x16x32_bf16 a[100:103], v[92:95], v[20:23], a[100:103]
  ds_read_b64_tr_b16 v[112:113], v11 offset:16384
  s_add_u32 m0, s40, 123904
  s_add_u32 s42, s39, 3440640
  buffer_load_dwordx4 v3, s[32:35], s42 offen lds
  v_mfma_f32_16x16x32_bf16 a[104:107], v[92:95], v[24:27], a[104:107]
  v_mfma_f32_16x16x32_bf16 a[108:111], v[92:95], v[28:31], a[108:111]
  ds_read_b64_tr_b16 v[114:115], v11 offset:17408
  v_mfma_f32_16x16x32_bf16 a[112:115], v[92:95], v[32:35], a[112:115]
  v_mfma_f32_16x16x32_bf16 a[116:119], v[92:95], v[36:39], a[116:119]
  ds_read_b64_tr_b16 v[116:117], v11 offset:16392
  v_mfma_f32_16x16x32_bf16 a[120:123], v[92:95], v[40:43], a[120:123]
  s_add_u32 m0, s40, 106496
  s_add_u32 s42, s39, 3407872
  buffer_load_dwordx4 v3, s[12:15], s42 offen lds
  v_mfma_f32_16x16x32_bf16 a[124:127], v[92:95], v[44:47], a[124:127]
  ds_read_b64_tr_b16 v[118:119], v11 offset:17416
  v_mfma_f32_16x16x32_bf16 a[128:131], v[16:19], v[96:99], a[128:131]
  v_mfma_f32_16x16x32_bf16 a[132:135], v[20:23], v[96:99], a[132:135]
  ds_read_b64_tr_b16 v[120:121], v12 offset:24576
  v_mfma_f32_16x16x32_bf16 a[136:139], v[24:27], v[96:99], a[136:139]
  v_mfma_f32_16x16x32_bf16 a[140:143], v[28:31], v[96:99], a[140:143]
  ds_read_b64_tr_b16 v[122:123], v12 offset:25600
  s_add_u32 m0, s40, 107520
  s_add_u32 s42, s39, 3440640
  buffer_load_dwordx4 v3, s[12:15], s42 offen lds
  v_mfma_f32_16x16x32_bf16 a[144:147], v[32:35], v[96:99], a[144:147]
  v_mfma_f32_16x16x32_bf16 a[148:151], v[36:39], v[96:99], a[148:151]
  ds_read_b64_tr_b16 v[124:125], v12 offset:24608
  v_mfma_f32_16x16x32_bf16 a[152:155], v[40:43], v[96:99], a[152:155]
  v_mfma_f32_16x16x32_bf16 a[156:159], v[44:47], v[96:99], a[156:159]
  ds_read_b64_tr_b16 v[126:127], v12 offset:25632
  v_mfma_f32_16x16x32_bf16 a[160:163], v[16:19], v[100:103], a[160:163]
  v_mfma_f32_16x16x32_bf16 a[164:167], v[20:23], v[100:103], a[164:167]
  v_mfma_f32_16x16x32_bf16 a[168:171], v[24:27], v[100:103], a[168:171]
  v_mfma_f32_16x16x32_bf16 a[172:175], v[28:31], v[100:103], a[172:175]
  v_mfma_f32_16x16x32_bf16 a[176:179], v[32:35], v[100:103], a[176:179]
  v_mfma_f32_16x16x32_bf16 a[180:183], v[36:39], v[100:103], a[180:183]
  v_mfma_f32_16x16x32_bf16 a[184:187], v[40:43], v[100:103], a[184:187]
  v_mfma_f32_16x16x32_bf16 a[188:191], v[44:47], v[100:103], a[188:191]
  s_waitcnt lgkmcnt(0)
  s_waitcnt vmcnt(24)
  s_barrier
  v_mfma_f32_16x16x32_bf16 a[0:3], v[104:107], v[48:51], a[0:3]
  s_add_u32 m0, s43, 131072
  s_add_u32 s42, s38, 896
  buffer_load_dwordx4 v1, s[8:11], s42 offen lds
  v_mfma_f32_16x16x32_bf16 a[4:7], v[104:107], v[52:55], a[4:7]
  ds_read_b64_tr_b16 v[80:81], v5 offset:8192
  v_mfma_f32_16x16x32_bf16 a[8:11], v[104:107], v[56:59], a[8:11]
  v_mfma_f32_16x16x32_bf16 a[12:15], v[104:107], v[60:63], a[12:15]
  ds_read_b64_tr_b16 v[82:83], v5 offset:9216
  v_mfma_f32_16x16x32_bf16 a[16:19], v[104:107], v[64:67], a[16:19]
  v_mfma_f32_16x16x32_bf16 a[20:23], v[104:107], v[68:71], a[20:23]
  ds_read_b64_tr_b16 v[84:85], v5 offset:8200
  s_add_u32 m0, s43, 132096
  s_add_u32 s42, s38, 21376
  buffer_load_dwordx4 v2, s[8:11], s42 offen lds
  v_mfma_f32_16x16x32_bf16 a[24:27], v[104:107], v[72:75], a[24:27]
  v_mfma_f32_16x16x32_bf16 a[28:31], v[104:107], v[76:79], a[28:31]
  ds_read_b64_tr_b16 v[86:87], v5 offset:9224
  v_mfma_f32_16x16x32_bf16 a[32:35], v[108:111], v[48:51], a[32:35]
  v_mfma_f32_16x16x32_bf16 a[36:39], v[108:111], v[52:55], a[36:39]
  ds_read_b128 v[16:19], v4 offset:0
  v_mfma_f32_16x16x32_bf16 a[40:43], v[108:111], v[56:59], a[40:43]
  s_add_u32 m0, s40, 147456
  s_add_u32 s42, s39, 3670016
  buffer_load_dwordx4 v3, s[28:31], s42 offen lds
  v_mfma_f32_16x16x32_bf16 a[44:47], v[108:111], v[60:63], a[44:47]
  ds_read_b128 v[20:23], v4 offset:256
  v_mfma_f32_16x16x32_bf16 a[48:51], v[108:111], v[64:67], a[48:51]
  v_mfma_f32_16x16x32_bf16 a[52:55], v[108:111], v[68:71], a[52:55]
  ds_read_b128 v[24:27], v4 offset:2048
  v_mfma_f32_16x16x32_bf16 a[56:59], v[108:111], v[72:75], a[56:59]
  v_mfma_f32_16x16x32_bf16 a[60:63], v[108:111], v[76:79], a[60:63]
  ds_read_b128 v[28:31], v4 offset:2304
  s_add_u32 m0, s40, 148480
  s_add_u32 s42, s39, 3702784
  buffer_load_dwordx4 v3, s[28:31], s42 offen lds
  v_mfma_f32_16x16x32_bf16 a[64:67], v[112:115], v[48:51], a[64:67]
  v_mfma_f32_16x16x32_bf16 a[68:71], v[112:115], v[52:55], a[68:71]
  ds_read_b128 v[32:35], v4 offset:4096
  v_mfma_f32_16x16x32_bf16 a[72:75], v[112:115], v[56:59], a[72:75]
  v_mfma_f32_16x16x32_bf16 a[76:79], v[112:115], v[60:63], a[76:79]
  ds_read_b128 v[36:39], v4 offset:4352
  v_mfma_f32_16x16x32_bf16 a[80:83], v[112:115], v[64:67], a[80:83]
  s_add_u32 m0, s40, 155648
  s_add_u32 s42, s39, 3670016
  buffer_load_dwordx4 v3, s[32:35], s42 offen lds
  v_mfma_f32_16x16x32_bf16 a[84:87], v[112:115], v[68:71], a[84:87]
  ds_read_b128 v[40:43], v4 offset:6144
  v_mfma_f32_16x16x32_bf16 a[88:91], v[112:115], v[72:75], a[88:91]
  v_mfma_f32_16x16x32_bf16 a[92:95], v[112:115], v[76:79], a[92:95]
  ds_read_b128 v[44:47], v4 offset:6400
  v_mfma_f32_16x16x32_bf16 a[96:99], v[116:119], v[48:51], a[96:99]
  v_mfma_f32_16x16x32_bf16 a[100:103], v[116:119], v[52:55], a[100:103]
  ds_read_b64_tr_b16 v[88:89], v5 offset:16384
  s_add_u32 m0, s40, 156672
  s_add_u32 s42, s39, 3702784
  buffer_load_dwordx4 v3, s[32:35], s42 offen lds
  v_mfma_f32_16x16x32_bf16 a[104:107], v[116:119], v[56:59], a[104:107]
  v_mfma_f32_16x16x32_bf16 a[108:111], v[116:119], v[60:63], a[108:111]
  ds_read_b64_tr_b16 v[90:91], v5 offset:17408
  v_mfma_f32_16x16x32_bf16 a[112:115], v[116:119], v[64:67], a[112:115]
  v_mfma_f32_16x16x32_bf16 a[116:119], v[116:119], v[68:71], a[116:119]
  ds_read_b64_tr_b16 v[92:93], v5 offset:16392
  v_mfma_f32_16x16x32_bf16 a[120:123], v[116:119], v[72:75], a[120:123]
  s_add_u32 m0, s40, 139264
  s_add_u32 s42, s39, 3670016
  buffer_load_dwordx4 v3, s[12:15], s42 offen lds
  v_mfma_f32_16x16x32_bf16 a[124:127], v[116:119], v[76:79], a[124:127]
  ds_read_b64_tr_b16 v[94:95], v5 offset:17416
  v_mfma_f32_16x16x32_bf16 a[128:131], v[48:51], v[120:123], a[128:131]
  v_mfma_f32_16x16x32_bf16 a[132:135], v[52:55], v[120:123], a[132:135]
  ds_read_b64_tr_b16 v[96:97], v6 offset:24576
  v_mfma_f32_16x16x32_bf16 a[136:139], v[56:59], v[120:123], a[136:139]
  v_mfma_f32_16x16x32_bf16 a[140:143], v[60:63], v[120:123], a[140:143]
  ds_read_b64_tr_b16 v[98:99], v6 offset:25600
  s_add_u32 m0, s40, 140288
  s_add_u32 s42, s39, 3702784
  buffer_load_dwordx4 v3, s[12:15], s42 offen lds
  v_mfma_f32_16x16x32_bf16 a[144:147], v[64:67], v[120:123], a[144:147]
  v_mfma_f32_16x16x32_bf16 a[148:151], v[68:71], v[120:123], a[148:151]
  ds_read_b64_tr_b16 v[100:101], v6 offset:24608
  v_mfma_f32_16x16x32_bf16 a[152:155], v[72:75], v[120:123], a[152:155]
  v_mfma_f32_16x16x32_bf16 a[156:159], v[76:79], v[120:123], a[156:159]
  ds_read_b64_tr_b16 v[102:103], v6 offset:25632
  v_mfma_f32_16x16x32_bf16 a[160:163], v[48:51], v[124:127], a[160:163]
  v_mfma_f32_16x16x32_bf16 a[164:167], v[52:55], v[124:127], a[164:167]
  v_mfma_f32_16x16x32_bf16 a[168:171], v[56:59], v[124:127], a[168:171]
  v_mfma_f32_16x16x32_bf16 a[172:175], v[60:63], v[124:127], a[172:175]
  v_mfma_f32_16x16x32_bf16 a[176:179], v[64:67], v[124:127], a[176:179]
  v_mfma_f32_16x16x32_bf16 a[180:183], v[68:71], v[124:127], a[180:183]
  v_mfma_f32_16x16x32_bf16 a[184:187], v[72:75], v[124:127], a[184:187]
  v_mfma_f32_16x16x32_bf16 a[188:191], v[76:79], v[124:127], a[188:191]
  s_waitcnt lgkmcnt(0)
  s_waitcnt vmcnt(24)
  s_barrier
  v_mfma_f32_16x16x32_bf16 a[0:3], v[80:83], v[16:19], a[0:3]
  s_add_u32 m0, s43, 0
  s_add_u32 s42, s38, 960
  buffer_load_dwordx4 v1, s[8:11], s42 offen lds
  v_mfma_f32_16x16x32_bf16 a[4:7], v[80:83], v[20:23], a[4:7]
  ds_read_b64_tr_b16 v[104:105], v5 offset:40960
  v_mfma_f32_16x16x32_bf16 a[8:11], v[80:83], v[24:27], a[8:11]
  v_mfma_f32_16x16x32_bf16 a[12:15], v[80:83], v[28:31], a[12:15]
  ds_read_b64_tr_b16 v[106:107], v5 offset:41984
  v_mfma_f32_16x16x32_bf16 a[16:19], v[80:83], v[32:35], a[16:19]
  v_mfma_f32_16x16x32_bf16 a[20:23], v[80:83], v[36:39], a[20:23]
  ds_read_b64_tr_b16 v[108:109], v5 offset:40968
  s_add_u32 m0, s43, 1024
  s_add_u32 s42, s38, 21440
  buffer_load_dwordx4 v2, s[8:11], s42 offen lds
  v_mfma_f32_16x16x32_bf16 a[24:27], v[80:83], v[40:43], a[24:27]
  v_mfma_f32_16x16x32_bf16 a[28:31], v[80:83], v[44:47], a[28:31]
  ds_read_b64_tr_b16 v[110:111], v5 offset:41992
  v_mfma_f32_16x16x32_bf16 a[32:35], v[84:87], v[16:19], a[32:35]
  v_mfma_f32_16x16x32_bf16 a[36:39], v[84:87], v[20:23], a[36:39]
  ds_read_b128 v[48:51], v4 offset:32768
  v_mfma_f32_16x16x32_bf16 a[40:43], v[84:87], v[24:27], a[40:43]
  s_add_u32 m0, s40, 16384
  s_add_u32 s42, s39, 3932160
  buffer_load_dwordx4 v3, s[28:31], s42 offen lds
  v_mfma_f32_16x16x32_bf16 a[44:47], v[84:87], v[28:31], a[44:47]
  ds_read_b128 v[52:55], v4 offset:33024
  v_mfma_f32_16x16x32_bf16 a[48:51], v[84:87], v[32:35], a[48:51]
  v_mfma_f32_16x16x32_bf16 a[52:55], v[84:87], v[36:39], a[52:55]
  ds_read_b128 v[56:59], v4 offset:34816
  v_mfma_f32_16x16x32_bf16 a[56:59], v[84:87], v[40:43], a[56:59]
  v_mfma_f32_16x16x32_bf16 a[60:63], v[84:87], v[44:47], a[60:63]
  ds_read_b128 v[60:63], v4 offset:35072
  s_add_u32 m0, s40, 17408
  s_add_u32 s42, s39, 3964928
  buffer_load_dwordx4 v3, s[28:31], s42 offen lds
  v_mfma_f32_16x16x32_bf16 a[64:67], v[88:91], v[16:19], a[64:67]
  v_mfma_f32_16x16x32_bf16 a[68:71], v[88:91], v[20:23], a[68:71]
  ds_read_b128 v[64:67], v4 offset:36864
  v_mfma_f32_16x16x32_bf16 a[72:75], v[88:91], v[24:27], a[72:75]
  v_mfma_f32_16x16x32_bf16 a[76:79], v[88:91], v[28:31], a[76:79]
  ds_read_b128 v[68:71], v4 offset:37120
  v_mfma_f32_16x16x32_bf16 a[80:83], v[88:91], v[32:35], a[80:83]
  s_add_u32 m0, s40, 24576
  s_add_u32 s42, s39, 3932160
  buffer_load_dwordx4 v3, s[32:35], s42 offen lds
  v_mfma_f32_16x16x32_bf16 a[84:87], v[88:91], v[36:39], a[84:87]
  ds_read_b128 v[72:75], v4 offset:38912
  v_mfma_f32_16x16x32_bf16 a[88:91], v[88:91], v[40:43], a[88:91]
  v_mfma_f32_16x16x32_bf16 a[92:95], v[88:91], v[44:47], a[92:95]
  ds_read_b128 v[76:79], v4 offset:39168
  v_mfma_f32_16x16x32_bf16 a[96:99], v[92:95], v[16:19], a[96:99]
  v_mfma_f32_16x16x32_bf16 a[100:103], v[92:95], v[20:23], a[100:103]
  ds_read_b64_tr_b16 v[112:113], v5 offset:49152
  s_add_u32 m0, s40, 25600
  s_add_u32 s42, s39, 3964928
  buffer_load_dwordx4 v3, s[32:35], s42 offen lds
  v_mfma_f32_16x16x32_bf16 a[104:107], v[92:95], v[24:27], a[104:107]
  v_mfma_f32_16x16x32_bf16 a[108:111], v[92:95], v[28:31], a[108:111]
  ds_read_b64_tr_b16 v[114:115], v5 offset:50176
  v_mfma_f32_16x16x32_bf16 a[112:115], v[92:95], v[32:35], a[112:115]
  v_mfma_f32_16x16x32_bf16 a[116:119], v[92:95], v[36:39], a[116:119]
  ds_read_b64_tr_b16 v[116:117], v5 offset:49160
  v_mfma_f32_16x16x32_bf16 a[120:123], v[92:95], v[40:43], a[120:123]
  s_add_u32 m0, s40, 8192
  s_add_u32 s42, s39, 3932160
  buffer_load_dwordx4 v3, s[12:15], s42 offen lds
  v_mfma_f32_16x16x32_bf16 a[124:127], v[92:95], v[44:47], a[124:127]
  ds_read_b64_tr_b16 v[118:119], v5 offset:50184
  v_mfma_f32_16x16x32_bf16 a[128:131], v[16:19], v[96:99], a[128:131]
  v_mfma_f32_16x16x32_bf16 a[132:135], v[20:23], v[96:99], a[132:135]
  ds_read_b64_tr_b16 v[120:121], v6 offset:57344
  v_mfma_f32_16x16x32_bf16 a[136:139], v[24:27], v[96:99], a[136:139]
  v_mfma_f32_16x16x32_bf16 a[140:143], v[28:31], v[96:99], a[140:143]
  ds_read_b64_tr_b16 v[122:123], v6 offset:58368
  s_add_u32 m0, s40, 9216
  s_add_u32 s42, s39, 3964928
  buffer_load_dwordx4 v3, s[12:15], s42 offen lds
  v_mfma_f32_16x16x32_bf16 a[144:147], v[32:35], v[96:99], a[144:147]
  v_mfma_f32_16x16x32_bf16 a[148:151], v[36:39], v[96:99], a[148:151]
  ds_read_b64_tr_b16 v[124:125], v6 offset:57376
  v_mfma_f32_16x16x32_bf16 a[152:155], v[40:43], v[96:99], a[152:155]
  v_mfma_f32_16x16x32_bf16 a[156:159], v[44:47], v[96:99], a[156:159]
  ds_read_b64_tr_b16 v[126:127], v6 offset:58400
  v_mfma_f32_16x16x32_bf16 a[160:163], v[16:19], v[100:103], a[160:163]
  v_mfma_f32_16x16x32_bf16 a[164:167], v[20:23], v[100:103], a[164:167]
  v_mfma_f32_16x16x32_bf16 a[168:171], v[24:27], v[100:103], a[168:171]
  v_mfma_f32_16x16x32_bf16 a[172:175], v[28:31], v[100:103], a[172:175]
  v_mfma_f32_16x16x32_bf16 a[176:179], v[32:35], v[100:103], a[176:179]
  v_mfma_f32_16x16x32_bf16 a[180:183], v[36:39], v[100:103], a[180:183]
  v_mfma_f32_16x16x32_bf16 a[184:187], v[40:43], v[100:103], a[184:187]
  v_mfma_f32_16x16x32_bf16 a[188:191], v[44:47], v[100:103], a[188:191]
  s_waitcnt lgkmcnt(0)
  s_waitcnt vmcnt(24)
  s_barrier
  v_mfma_f32_16x16x32_bf16 a[0:3], v[104:107], v[48:51], a[0:3]
  s_add_u32 m0, s43, 32768
  s_add_u32 s42, s38, 1024
  buffer_load_dwordx4 v1, s[8:11], s42 offen lds
  v_mfma_f32_16x16x32_bf16 a[4:7], v[104:107], v[52:55], a[4:7]
  ds_read_b64_tr_b16 v[80:81], v8 offset:8192
  v_mfma_f32_16x16x32_bf16 a[8:11], v[104:107], v[56:59], a[8:11]
  v_mfma_f32_16x16x32_bf16 a[12:15], v[104:107], v[60:63], a[12:15]
  ds_read_b64_tr_b16 v[82:83], v8 offset:9216
  v_mfma_f32_16x16x32_bf16 a[16:19], v[104:107], v[64:67], a[16:19]
  v_mfma_f32_16x16x32_bf16 a[20:23], v[104:107], v[68:71], a[20:23]
  ds_read_b64_tr_b16 v[84:85], v8 offset:8200
  s_add_u32 m0, s43, 33792
  s_add_u32 s42, s38, 21504
  buffer_load_dwordx4 v2, s[8:11], s42 offen lds
  v_mfma_f32_16x16x32_bf16 a[24:27], v[104:107], v[72:75], a[24:27]
  v_mfma_f32_16x16x32_bf16 a[28:31], v[104:107], v[76:79], a[28:31]
  ds_read_b64_tr_b16 v[86:87], v8 offset:9224
  v_mfma_f32_16x16x32_bf16 a[32:35], v[108:111], v[48:51], a[32:35]
  v_mfma_f32_16x16x32_bf16 a[36:39], v[108:111], v[52:55], a[36:39]
  ds_read_b128 v[16:19], v7 offset:0
  v_mfma_f32_16x16x32_bf16 a[40:43], v[108:111], v[56:59], a[40:43]
  s_add_u32 m0, s40, 49152
  s_add_u32 s42, s39, 4194304
  buffer_load_dwordx4 v3, s[28:31], s42 offen lds
  v_mfma_f32_16x16x32_bf16 a[44:47], v[108:111], v[60:63], a[44:47]
  ds_read_b128 v[20:23], v7 offset:256
  v_mfma_f32_16x16x32_bf16 a[48:51], v[108:111], v[64:67], a[48:51]
  v_mfma_f32_16x16x32_bf16 a[52:55], v[108:111], v[68:71], a[52:55]
  ds_read_b128 v[24:27], v7 offset:2048
  v_mfma_f32_16x16x32_bf16 a[56:59], v[108:111], v[72:75], a[56:59]
  v_mfma_f32_16x16x32_bf16 a[60:63], v[108:111], v[76:79], a[60:63]
  ds_read_b128 v[28:31], v7 offset:2304
  s_add_u32 m0, s40, 50176
  s_add_u32 s42, s39, 4227072
  buffer_load_dwordx4 v3, s[28:31], s42 offen lds
  v_mfma_f32_16x16x32_bf16 a[64:67], v[112:115], v[48:51], a[64:67]
  v_mfma_f32_16x16x32_bf16 a[68:71], v[112:115], v[52:55], a[68:71]
  ds_read_b128 v[32:35], v7 offset:4096
  v_mfma_f32_16x16x32_bf16 a[72:75], v[112:115], v[56:59], a[72:75]
  v_mfma_f32_16x16x32_bf16 a[76:79], v[112:115], v[60:63], a[76:79]
  ds_read_b128 v[36:39], v7 offset:4352
  v_mfma_f32_16x16x32_bf16 a[80:83], v[112:115], v[64:67], a[80:83]
  s_add_u32 m0, s40, 57344
  s_add_u32 s42, s39, 4194304
  buffer_load_dwordx4 v3, s[32:35], s42 offen lds
  v_mfma_f32_16x16x32_bf16 a[84:87], v[112:115], v[68:71], a[84:87]
  ds_read_b128 v[40:43], v7 offset:6144
  v_mfma_f32_16x16x32_bf16 a[88:91], v[112:115], v[72:75], a[88:91]
  v_mfma_f32_16x16x32_bf16 a[92:95], v[112:115], v[76:79], a[92:95]
  ds_read_b128 v[44:47], v7 offset:6400
  v_mfma_f32_16x16x32_bf16 a[96:99], v[116:119], v[48:51], a[96:99]
  v_mfma_f32_16x16x32_bf16 a[100:103], v[116:119], v[52:55], a[100:103]
  ds_read_b64_tr_b16 v[88:89], v8 offset:16384
  s_add_u32 m0, s40, 58368
  s_add_u32 s42, s39, 4227072
  buffer_load_dwordx4 v3, s[32:35], s42 offen lds
  v_mfma_f32_16x16x32_bf16 a[104:107], v[116:119], v[56:59], a[104:107]
  v_mfma_f32_16x16x32_bf16 a[108:111], v[116:119], v[60:63], a[108:111]
  ds_read_b64_tr_b16 v[90:91], v8 offset:17408
  v_mfma_f32_16x16x32_bf16 a[112:115], v[116:119], v[64:67], a[112:115]
  v_mfma_f32_16x16x32_bf16 a[116:119], v[116:119], v[68:71], a[116:119]
  ds_read_b64_tr_b16 v[92:93], v8 offset:16392
  v_mfma_f32_16x16x32_bf16 a[120:123], v[116:119], v[72:75], a[120:123]
  s_add_u32 m0, s40, 40960
  s_add_u32 s42, s39, 4194304
  buffer_load_dwordx4 v3, s[12:15], s42 offen lds
  v_mfma_f32_16x16x32_bf16 a[124:127], v[116:119], v[76:79], a[124:127]
  ds_read_b64_tr_b16 v[94:95], v8 offset:17416
  v_mfma_f32_16x16x32_bf16 a[128:131], v[48:51], v[120:123], a[128:131]
  v_mfma_f32_16x16x32_bf16 a[132:135], v[52:55], v[120:123], a[132:135]
  ds_read_b64_tr_b16 v[96:97], v9 offset:24576
  v_mfma_f32_16x16x32_bf16 a[136:139], v[56:59], v[120:123], a[136:139]
  v_mfma_f32_16x16x32_bf16 a[140:143], v[60:63], v[120:123], a[140:143]
  ds_read_b64_tr_b16 v[98:99], v9 offset:25600
  s_add_u32 m0, s40, 41984
  s_add_u32 s42, s39, 4227072
  buffer_load_dwordx4 v3, s[12:15], s42 offen lds
  v_mfma_f32_16x16x32_bf16 a[144:147], v[64:67], v[120:123], a[144:147]
  v_mfma_f32_16x16x32_bf16 a[148:151], v[68:71], v[120:123], a[148:151]
  ds_read_b64_tr_b16 v[100:101], v9 offset:24608
  v_mfma_f32_16x16x32_bf16 a[152:155], v[72:75], v[120:123], a[152:155]
  v_mfma_f32_16x16x32_bf16 a[156:159], v[76:79], v[120:123], a[156:159]
  ds_read_b64_tr_b16 v[102:103], v9 offset:25632
  v_mfma_f32_16x16x32_bf16 a[160:163], v[48:51], v[124:127], a[160:163]
  v_mfma_f32_16x16x32_bf16 a[164:167], v[52:55], v[124:127], a[164:167]
  v_mfma_f32_16x16x32_bf16 a[168:171], v[56:59], v[124:127], a[168:171]
  v_mfma_f32_16x16x32_bf16 a[172:175], v[60:63], v[124:127], a[172:175]
  v_mfma_f32_16x16x32_bf16 a[176:179], v[64:67], v[124:127], a[176:179]
  v_mfma_f32_16x16x32_bf16 a[180:183], v[68:71], v[124:127], a[180:183]
  v_mfma_f32_16x16x32_bf16 a[184:187], v[72:75], v[124:127], a[184:187]
  v_mfma_f32_16x16x32_bf16 a[188:191], v[76:79], v[124:127], a[188:191]
  s_waitcnt lgkmcnt(0)
  s_waitcnt vmcnt(24)
  s_barrier
  v_mfma_f32_16x16x32_bf16 a[0:3], v[80:83], v[16:19], a[0:3]
  s_add_u32 m0, s43, 65536
  s_add_u32 s42, s38, 1088
  buffer_load_dwordx4 v1, s[8:11], s42 offen lds
  v_mfma_f32_16x16x32_bf16 a[4:7], v[80:83], v[20:23], a[4:7]
  ds_read_b64_tr_b16 v[104:105], v8 offset:40960
  v_mfma_f32_16x16x32_bf16 a[8:11], v[80:83], v[24:27], a[8:11]
  v_mfma_f32_16x16x32_bf16 a[12:15], v[80:83], v[28:31], a[12:15]
  ds_read_b64_tr_b16 v[106:107], v8 offset:41984
  v_mfma_f32_16x16x32_bf16 a[16:19], v[80:83], v[32:35], a[16:19]
  v_mfma_f32_16x16x32_bf16 a[20:23], v[80:83], v[36:39], a[20:23]
  ds_read_b64_tr_b16 v[108:109], v8 offset:40968
  s_add_u32 m0, s43, 66560
  s_add_u32 s42, s38, 21568
  buffer_load_dwordx4 v2, s[8:11], s42 offen lds
  v_mfma_f32_16x16x32_bf16 a[24:27], v[80:83], v[40:43], a[24:27]
  v_mfma_f32_16x16x32_bf16 a[28:31], v[80:83], v[44:47], a[28:31]
  ds_read_b64_tr_b16 v[110:111], v8 offset:41992
  v_mfma_f32_16x16x32_bf16 a[32:35], v[84:87], v[16:19], a[32:35]
  v_mfma_f32_16x16x32_bf16 a[36:39], v[84:87], v[20:23], a[36:39]
  ds_read_b128 v[48:51], v7 offset:32768
  v_mfma_f32_16x16x32_bf16 a[40:43], v[84:87], v[24:27], a[40:43]
  s_add_u32 m0, s40, 81920
  s_add_u32 s42, s39, 4456448
  buffer_load_dwordx4 v3, s[28:31], s42 offen lds
  v_mfma_f32_16x16x32_bf16 a[44:47], v[84:87], v[28:31], a[44:47]
  ds_read_b128 v[52:55], v7 offset:33024
  v_mfma_f32_16x16x32_bf16 a[48:51], v[84:87], v[32:35], a[48:51]
  v_mfma_f32_16x16x32_bf16 a[52:55], v[84:87], v[36:39], a[52:55]
  ds_read_b128 v[56:59], v7 offset:34816
  v_mfma_f32_16x16x32_bf16 a[56:59], v[84:87], v[40:43], a[56:59]
  v_mfma_f32_16x16x32_bf16 a[60:63], v[84:87], v[44:47], a[60:63]
  ds_read_b128 v[60:63], v7 offset:35072
  s_add_u32 m0, s40, 82944
  s_add_u32 s42, s39, 4489216
  buffer_load_dwordx4 v3, s[28:31], s42 offen lds
  v_mfma_f32_16x16x32_bf16 a[64:67], v[88:91], v[16:19], a[64:67]
  v_mfma_f32_16x16x32_bf16 a[68:71], v[88:91], v[20:23], a[68:71]
  ds_read_b128 v[64:67], v7 offset:36864
  v_mfma_f32_16x16x32_bf16 a[72:75], v[88:91], v[24:27], a[72:75]
  v_mfma_f32_16x16x32_bf16 a[76:79], v[88:91], v[28:31], a[76:79]
  ds_read_b128 v[68:71], v7 offset:37120
  v_mfma_f32_16x16x32_bf16 a[80:83], v[88:91], v[32:35], a[80:83]
  s_add_u32 m0, s40, 90112
  s_add_u32 s42, s39, 4456448
  buffer_load_dwordx4 v3, s[32:35], s42 offen lds
  v_mfma_f32_16x16x32_bf16 a[84:87], v[88:91], v[36:39], a[84:87]
  ds_read_b128 v[72:75], v7 offset:38912
  v_mfma_f32_16x16x32_bf16 a[88:91], v[88:91], v[40:43], a[88:91]
  v_mfma_f32_16x16x32_bf16 a[92:95], v[88:91], v[44:47], a[92:95]
  ds_read_b128 v[76:79], v7 offset:39168
  v_mfma_f32_16x16x32_bf16 a[96:99], v[92:95], v[16:19], a[96:99]
  v_mfma_f32_16x16x32_bf16 a[100:103], v[92:95], v[20:23], a[100:103]
  ds_read_b64_tr_b16 v[112:113], v8 offset:49152
  s_add_u32 m0, s40, 91136
  s_add_u32 s42, s39, 4489216
  buffer_load_dwordx4 v3, s[32:35], s42 offen lds
  v_mfma_f32_16x16x32_bf16 a[104:107], v[92:95], v[24:27], a[104:107]
  v_mfma_f32_16x16x32_bf16 a[108:111], v[92:95], v[28:31], a[108:111]
  ds_read_b64_tr_b16 v[114:115], v8 offset:50176
  v_mfma_f32_16x16x32_bf16 a[112:115], v[92:95], v[32:35], a[112:115]
  v_mfma_f32_16x16x32_bf16 a[116:119], v[92:95], v[36:39], a[116:119]
  ds_read_b64_tr_b16 v[116:117], v8 offset:49160
  v_mfma_f32_16x16x32_bf16 a[120:123], v[92:95], v[40:43], a[120:123]
  s_add_u32 m0, s40, 73728
  s_add_u32 s42, s39, 4456448
  buffer_load_dwordx4 v3, s[12:15], s42 offen lds
  v_mfma_f32_16x16x32_bf16 a[124:127], v[92:95], v[44:47], a[124:127]
  ds_read_b64_tr_b16 v[118:119], v8 offset:50184
  v_mfma_f32_16x16x32_bf16 a[128:131], v[16:19], v[96:99], a[128:131]
  v_mfma_f32_16x16x32_bf16 a[132:135], v[20:23], v[96:99], a[132:135]
  ds_read_b64_tr_b16 v[120:121], v9 offset:57344
  v_mfma_f32_16x16x32_bf16 a[136:139], v[24:27], v[96:99], a[136:139]
  v_mfma_f32_16x16x32_bf16 a[140:143], v[28:31], v[96:99], a[140:143]
  ds_read_b64_tr_b16 v[122:123], v9 offset:58368
  s_add_u32 m0, s40, 74752
  s_add_u32 s42, s39, 4489216
  buffer_load_dwordx4 v3, s[12:15], s42 offen lds
  v_mfma_f32_16x16x32_bf16 a[144:147], v[32:35], v[96:99], a[144:147]
  v_mfma_f32_16x16x32_bf16 a[148:151], v[36:39], v[96:99], a[148:151]
  ds_read_b64_tr_b16 v[124:125], v9 offset:57376
  v_mfma_f32_16x16x32_bf16 a[152:155], v[40:43], v[96:99], a[152:155]
  v_mfma_f32_16x16x32_bf16 a[156:159], v[44:47], v[96:99], a[156:159]
  ds_read_b64_tr_b16 v[126:127], v9 offset:58400
  v_mfma_f32_16x16x32_bf16 a[160:163], v[16:19], v[100:103], a[160:163]
  v_mfma_f32_16x16x32_bf16 a[164:167], v[20:23], v[100:103], a[164:167]
  v_mfma_f32_16x16x32_bf16 a[168:171], v[24:27], v[100:103], a[168:171]
  v_mfma_f32_16x16x32_bf16 a[172:175], v[28:31], v[100:103], a[172:175]
  v_mfma_f32_16x16x32_bf16 a[176:179], v[32:35], v[100:103], a[176:179]
  v_mfma_f32_16x16x32_bf16 a[180:183], v[36:39], v[100:103], a[180:183]
  v_mfma_f32_16x16x32_bf16 a[184:187], v[40:43], v[100:103], a[184:187]
  v_mfma_f32_16x16x32_bf16 a[188:191], v[44:47], v[100:103], a[188:191]
  s_waitcnt lgkmcnt(0)
  s_waitcnt vmcnt(24)
  s_barrier
  v_mfma_f32_16x16x32_bf16 a[0:3], v[104:107], v[48:51], a[0:3]
  s_add_u32 m0, s43, 98304
  s_add_u32 s42, s38, 1152
  buffer_load_dwordx4 v1, s[8:11], s42 offen lds
  v_mfma_f32_16x16x32_bf16 a[4:7], v[104:107], v[52:55], a[4:7]
  ds_read_b64_tr_b16 v[80:81], v11 offset:8192
  v_mfma_f32_16x16x32_bf16 a[8:11], v[104:107], v[56:59], a[8:11]
  v_mfma_f32_16x16x32_bf16 a[12:15], v[104:107], v[60:63], a[12:15]
  ds_read_b64_tr_b16 v[82:83], v11 offset:9216
  v_mfma_f32_16x16x32_bf16 a[16:19], v[104:107], v[64:67], a[16:19]
  v_mfma_f32_16x16x32_bf16 a[20:23], v[104:107], v[68:71], a[20:23]
  ds_read_b64_tr_b16 v[84:85], v11 offset:8200
  s_add_u32 m0, s43, 99328
  s_add_u32 s42, s38, 21632
  buffer_load_dwordx4 v2, s[8:11], s42 offen lds
  v_mfma_f32_16x16x32_bf16 a[24:27], v[104:107], v[72:75], a[24:27]
  v_mfma_f32_16x16x32_bf16 a[28:31], v[104:107], v[76:79], a[28:31]
  ds_read_b64_tr_b16 v[86:87], v11 offset:9224
  v_mfma_f32_16x16x32_bf16 a[32:35], v[108:111], v[48:51], a[32:35]
  v_mfma_f32_16x16x32_bf16 a[36:39], v[108:111], v[52:55], a[36:39]
  ds_read_b128 v[16:19], v10 offset:0
  v_mfma_f32_16x16x32_bf16 a[40:43], v[108:111], v[56:59], a[40:43]
  s_add_u32 m0, s40, 114688
  s_add_u32 s42, s39, 4718592
  buffer_load_dwordx4 v3, s[28:31], s42 offen lds
  v_mfma_f32_16x16x32_bf16 a[44:47], v[108:111], v[60:63], a[44:47]
  ds_read_b128 v[20:23], v10 offset:256
  v_mfma_f32_16x16x32_bf16 a[48:51], v[108:111], v[64:67], a[48:51]
  v_mfma_f32_16x16x32_bf16 a[52:55], v[108:111], v[68:71], a[52:55]
  ds_read_b128 v[24:27], v10 offset:2048
  v_mfma_f32_16x16x32_bf16 a[56:59], v[108:111], v[72:75], a[56:59]
  v_mfma_f32_16x16x32_bf16 a[60:63], v[108:111], v[76:79], a[60:63]
  ds_read_b128 v[28:31], v10 offset:2304
  s_add_u32 m0, s40, 115712
  s_add_u32 s42, s39, 4751360
  buffer_load_dwordx4 v3, s[28:31], s42 offen lds
  v_mfma_f32_16x16x32_bf16 a[64:67], v[112:115], v[48:51], a[64:67]
  v_mfma_f32_16x16x32_bf16 a[68:71], v[112:115], v[52:55], a[68:71]
  ds_read_b128 v[32:35], v10 offset:4096
  v_mfma_f32_16x16x32_bf16 a[72:75], v[112:115], v[56:59], a[72:75]
  v_mfma_f32_16x16x32_bf16 a[76:79], v[112:115], v[60:63], a[76:79]
  ds_read_b128 v[36:39], v10 offset:4352
  v_mfma_f32_16x16x32_bf16 a[80:83], v[112:115], v[64:67], a[80:83]
  s_add_u32 m0, s40, 122880
  s_add_u32 s42, s39, 4718592
  buffer_load_dwordx4 v3, s[32:35], s42 offen lds
  v_mfma_f32_16x16x32_bf16 a[84:87], v[112:115], v[68:71], a[84:87]
  ds_read_b128 v[40:43], v10 offset:6144
  v_mfma_f32_16x16x32_bf16 a[88:91], v[112:115], v[72:75], a[88:91]
  v_mfma_f32_16x16x32_bf16 a[92:95], v[112:115], v[76:79], a[92:95]
  ds_read_b128 v[44:47], v10 offset:6400
  v_mfma_f32_16x16x32_bf16 a[96:99], v[116:119], v[48:51], a[96:99]
  v_mfma_f32_16x16x32_bf16 a[100:103], v[116:119], v[52:55], a[100:103]
  ds_read_b64_tr_b16 v[88:89], v11 offset:16384
  s_add_u32 m0, s40, 123904
  s_add_u32 s42, s39, 4751360
  buffer_load_dwordx4 v3, s[32:35], s42 offen lds
  v_mfma_f32_16x16x32_bf16 a[104:107], v[116:119], v[56:59], a[104:107]
  v_mfma_f32_16x16x32_bf16 a[108:111], v[116:119], v[60:63], a[108:111]
  ds_read_b64_tr_b16 v[90:91], v11 offset:17408
  v_mfma_f32_16x16x32_bf16 a[112:115], v[116:119], v[64:67], a[112:115]
  v_mfma_f32_16x16x32_bf16 a[116:119], v[116:119], v[68:71], a[116:119]
  ds_read_b64_tr_b16 v[92:93], v11 offset:16392
  v_mfma_f32_16x16x32_bf16 a[120:123], v[116:119], v[72:75], a[120:123]
  s_add_u32 m0, s40, 106496
  s_add_u32 s42, s39, 4718592
  buffer_load_dwordx4 v3, s[12:15], s42 offen lds
  v_mfma_f32_16x16x32_bf16 a[124:127], v[116:119], v[76:79], a[124:127]
  ds_read_b64_tr_b16 v[94:95], v11 offset:17416
  v_mfma_f32_16x16x32_bf16 a[128:131], v[48:51], v[120:123], a[128:131]
  v_mfma_f32_16x16x32_bf16 a[132:135], v[52:55], v[120:123], a[132:135]
  ds_read_b64_tr_b16 v[96:97], v12 offset:24576
  v_mfma_f32_16x16x32_bf16 a[136:139], v[56:59], v[120:123], a[136:139]
  v_mfma_f32_16x16x32_bf16 a[140:143], v[60:63], v[120:123], a[140:143]
  ds_read_b64_tr_b16 v[98:99], v12 offset:25600
  s_add_u32 m0, s40, 107520
  s_add_u32 s42, s39, 4751360
  buffer_load_dwordx4 v3, s[12:15], s42 offen lds
  v_mfma_f32_16x16x32_bf16 a[144:147], v[64:67], v[120:123], a[144:147]
  v_mfma_f32_16x16x32_bf16 a[148:151], v[68:71], v[120:123], a[148:151]
  ds_read_b64_tr_b16 v[100:101], v12 offset:24608
  v_mfma_f32_16x16x32_bf16 a[152:155], v[72:75], v[120:123], a[152:155]
  v_mfma_f32_16x16x32_bf16 a[156:159], v[76:79], v[120:123], a[156:159]
  ds_read_b64_tr_b16 v[102:103], v12 offset:25632
  v_mfma_f32_16x16x32_bf16 a[160:163], v[48:51], v[124:127], a[160:163]
  v_mfma_f32_16x16x32_bf16 a[164:167], v[52:55], v[124:127], a[164:167]
  v_mfma_f32_16x16x32_bf16 a[168:171], v[56:59], v[124:127], a[168:171]
  v_mfma_f32_16x16x32_bf16 a[172:175], v[60:63], v[124:127], a[172:175]
  v_mfma_f32_16x16x32_bf16 a[176:179], v[64:67], v[124:127], a[176:179]
  v_mfma_f32_16x16x32_bf16 a[180:183], v[68:71], v[124:127], a[180:183]
  v_mfma_f32_16x16x32_bf16 a[184:187], v[72:75], v[124:127], a[184:187]
  v_mfma_f32_16x16x32_bf16 a[188:191], v[76:79], v[124:127], a[188:191]
  s_waitcnt lgkmcnt(0)
  s_waitcnt vmcnt(24)
  s_barrier
  v_mfma_f32_16x16x32_bf16 a[0:3], v[80:83], v[16:19], a[0:3]
  s_add_u32 m0, s43, 131072
  s_add_u32 s42, s38, 1216
  buffer_load_dwordx4 v1, s[8:11], s42 offen lds
  v_mfma_f32_16x16x32_bf16 a[4:7], v[80:83], v[20:23], a[4:7]
  ds_read_b64_tr_b16 v[104:105], v5 offset:8192
  v_mfma_f32_16x16x32_bf16 a[8:11], v[80:83], v[24:27], a[8:11]
  v_mfma_f32_16x16x32_bf16 a[12:15], v[80:83], v[28:31], a[12:15]
  ds_read_b64_tr_b16 v[106:107], v5 offset:9216
  v_mfma_f32_16x16x32_bf16 a[16:19], v[80:83], v[32:35], a[16:19]
  v_mfma_f32_16x16x32_bf16 a[20:23], v[80:83], v[36:39], a[20:23]
  ds_read_b64_tr_b16 v[108:109], v5 offset:8200
  s_add_u32 m0, s43, 132096
  s_add_u32 s42, s38, 21696
  buffer_load_dwordx4 v2, s[8:11], s42 offen lds
  v_mfma_f32_16x16x32_bf16 a[24:27], v[80:83], v[40:43], a[24:27]
  v_mfma_f32_16x16x32_bf16 a[28:31], v[80:83], v[44:47], a[28:31]
  ds_read_b64_tr_b16 v[110:111], v5 offset:9224
  v_mfma_f32_16x16x32_bf16 a[32:35], v[84:87], v[16:19], a[32:35]
  v_mfma_f32_16x16x32_bf16 a[36:39], v[84:87], v[20:23], a[36:39]
  ds_read_b128 v[48:51], v4 offset:0
  v_mfma_f32_16x16x32_bf16 a[40:43], v[84:87], v[24:27], a[40:43]
  s_add_u32 m0, s40, 147456
  s_add_u32 s42, s39, 4980736
  buffer_load_dwordx4 v3, s[28:31], s42 offen lds
  v_mfma_f32_16x16x32_bf16 a[44:47], v[84:87], v[28:31], a[44:47]
  ds_read_b128 v[52:55], v4 offset:256
  v_mfma_f32_16x16x32_bf16 a[48:51], v[84:87], v[32:35], a[48:51]
  v_mfma_f32_16x16x32_bf16 a[52:55], v[84:87], v[36:39], a[52:55]
  ds_read_b128 v[56:59], v4 offset:2048
  v_mfma_f32_16x16x32_bf16 a[56:59], v[84:87], v[40:43], a[56:59]
  v_mfma_f32_16x16x32_bf16 a[60:63], v[84:87], v[44:47], a[60:63]
  ds_read_b128 v[60:63], v4 offset:2304
  s_add_u32 m0, s40, 148480
  s_add_u32 s42, s39, 5013504
  buffer_load_dwordx4 v3, s[28:31], s42 offen lds
  v_mfma_f32_16x16x32_bf16 a[64:67], v[88:91], v[16:19], a[64:67]
  v_mfma_f32_16x16x32_bf16 a[68:71], v[88:91], v[20:23], a[68:71]
  ds_read_b128 v[64:67], v4 offset:4096
  v_mfma_f32_16x16x32_bf16 a[72:75], v[88:91], v[24:27], a[72:75]
  v_mfma_f32_16x16x32_bf16 a[76:79], v[88:91], v[28:31], a[76:79]
  ds_read_b128 v[68:71], v4 offset:4352
  v_mfma_f32_16x16x32_bf16 a[80:83], v[88:91], v[32:35], a[80:83]
  s_add_u32 m0, s40, 155648
  s_add_u32 s42, s39, 4980736
  buffer_load_dwordx4 v3, s[32:35], s42 offen lds
  v_mfma_f32_16x16x32_bf16 a[84:87], v[88:91], v[36:39], a[84:87]
  ds_read_b128 v[72:75], v4 offset:6144
  v_mfma_f32_16x16x32_bf16 a[88:91], v[88:91], v[40:43], a[88:91]
  v_mfma_f32_16x16x32_bf16 a[92:95], v[88:91], v[44:47], a[92:95]
  ds_read_b128 v[76:79], v4 offset:6400
  v_mfma_f32_16x16x32_bf16 a[96:99], v[92:95], v[16:19], a[96:99]
  v_mfma_f32_16x16x32_bf16 a[100:103], v[92:95], v[20:23], a[100:103]
  ds_read_b64_tr_b16 v[112:113], v5 offset:16384
  s_add_u32 m0, s40, 156672
  s_add_u32 s42, s39, 5013504
  buffer_load_dwordx4 v3, s[32:35], s42 offen lds
  v_mfma_f32_16x16x32_bf16 a[104:107], v[92:95], v[24:27], a[104:107]
  v_mfma_f32_16x16x32_bf16 a[108:111], v[92:95], v[28:31], a[108:111]
  ds_read_b64_tr_b16 v[114:115], v5 offset:17408
  v_mfma_f32_16x16x32_bf16 a[112:115], v[92:95], v[32:35], a[112:115]
  v_mfma_f32_16x16x32_bf16 a[116:119], v[92:95], v[36:39], a[116:119]
  ds_read_b64_tr_b16 v[116:117], v5 offset:16392
  v_mfma_f32_16x16x32_bf16 a[120:123], v[92:95], v[40:43], a[120:123]
  s_add_u32 m0, s40, 139264
  s_add_u32 s42, s39, 4980736
  buffer_load_dwordx4 v3, s[12:15], s42 offen lds
  v_mfma_f32_16x16x32_bf16 a[124:127], v[92:95], v[44:47], a[124:127]
  ds_read_b64_tr_b16 v[118:119], v5 offset:17416
  v_mfma_f32_16x16x32_bf16 a[128:131], v[16:19], v[96:99], a[128:131]
  v_mfma_f32_16x16x32_bf16 a[132:135], v[20:23], v[96:99], a[132:135]
  ds_read_b64_tr_b16 v[120:121], v6 offset:24576
  v_mfma_f32_16x16x32_bf16 a[136:139], v[24:27], v[96:99], a[136:139]
  v_mfma_f32_16x16x32_bf16 a[140:143], v[28:31], v[96:99], a[140:143]
  ds_read_b64_tr_b16 v[122:123], v6 offset:25600
  s_add_u32 m0, s40, 140288
  s_add_u32 s42, s39, 5013504
  buffer_load_dwordx4 v3, s[12:15], s42 offen lds
  v_mfma_f32_16x16x32_bf16 a[144:147], v[32:35], v[96:99], a[144:147]
  v_mfma_f32_16x16x32_bf16 a[148:151], v[36:39], v[96:99], a[148:151]
  ds_read_b64_tr_b16 v[124:125], v6 offset:24608
  v_mfma_f32_16x16x32_bf16 a[152:155], v[40:43], v[96:99], a[152:155]
  v_mfma_f32_16x16x32_bf16 a[156:159], v[44:47], v[96:99], a[156:159]
  ds_read_b64_tr_b16 v[126:127], v6 offset:25632
  v_mfma_f32_16x16x32_bf16 a[160:163], v[16:19], v[100:103], a[160:163]
  v_mfma_f32_16x16x32_bf16 a[164:167], v[20:23], v[100:103], a[164:167]
  v_mfma_f32_16x16x32_bf16 a[168:171], v[24:27], v[100:103], a[168:171]
  v_mfma_f32_16x16x32_bf16 a[172:175], v[28:31], v[100:103], a[172:175]
  v_mfma_f32_16x16x32_bf16 a[176:179], v[32:35], v[100:103], a[176:179]
  v_mfma_f32_16x16x32_bf16 a[180:183], v[36:39], v[100:103], a[180:183]
  v_mfma_f32_16x16x32_bf16 a[184:187], v[40:43], v[100:103], a[184:187]
  v_mfma_f32_16x16x32_bf16 a[188:191], v[44:47], v[100:103], a[188:191]
  s_waitcnt lgkmcnt(0)
  s_waitcnt vmcnt(24)
  s_barrier
  v_mfma_f32_16x16x32_bf16 a[0:3], v[104:107], v[48:51], a[0:3]
  v_mfma_f32_16x16x32_bf16 a[4:7], v[104:107], v[52:55], a[4:7]
  ds_read_b64_tr_b16 v[80:81], v5 offset:40960
  v_mfma_f32_16x16x32_bf16 a[8:11], v[104:107], v[56:59], a[8:11]
  v_mfma_f32_16x16x32_bf16 a[12:15], v[104:107], v[60:63], a[12:15]
  ds_read_b64_tr_b16 v[82:83], v5 offset:41984
  v_mfma_f32_16x16x32_bf16 a[16:19], v[104:107], v[64:67], a[16:19]
  v_mfma_f32_16x16x32_bf16 a[20:23], v[104:107], v[68:71], a[20:23]
  ds_read_b64_tr_b16 v[84:85], v5 offset:40968
  v_mfma_f32_16x16x32_bf16 a[24:27], v[104:107], v[72:75], a[24:27]
  v_mfma_f32_16x16x32_bf16 a[28:31], v[104:107], v[76:79], a[28:31]
  ds_read_b64_tr_b16 v[86:87], v5 offset:41992
  v_mfma_f32_16x16x32_bf16 a[32:35], v[108:111], v[48:51], a[32:35]
  v_mfma_f32_16x16x32_bf16 a[36:39], v[108:111], v[52:55], a[36:39]
  ds_read_b128 v[16:19], v4 offset:32768
  v_mfma_f32_16x16x32_bf16 a[40:43], v[108:111], v[56:59], a[40:43]
  v_mfma_f32_16x16x32_bf16 a[44:47], v[108:111], v[60:63], a[44:47]
  ds_read_b128 v[20:23], v4 offset:33024
  v_mfma_f32_16x16x32_bf16 a[48:51], v[108:111], v[64:67], a[48:51]
  v_mfma_f32_16x16x32_bf16 a[52:55], v[108:111], v[68:71], a[52:55]
  ds_read_b128 v[24:27], v4 offset:34816
  v_mfma_f32_16x16x32_bf16 a[56:59], v[108:111], v[72:75], a[56:59]
  v_mfma_f32_16x16x32_bf16 a[60:63], v[108:111], v[76:79], a[60:63]
  ds_read_b128 v[28:31], v4 offset:35072
  v_mfma_f32_16x16x32_bf16 a[64:67], v[112:115], v[48:51], a[64:67]
  v_mfma_f32_16x16x32_bf16 a[68:71], v[112:115], v[52:55], a[68:71]
  ds_read_b128 v[32:35], v4 offset:36864
  v_mfma_f32_16x16x32_bf16 a[72:75], v[112:115], v[56:59], a[72:75]
  v_mfma_f32_16x16x32_bf16 a[76:79], v[112:115], v[60:63], a[76:79]
  ds_read_b128 v[36:39], v4 offset:37120
  v_mfma_f32_16x16x32_bf16 a[80:83], v[112:115], v[64:67], a[80:83]
  v_mfma_f32_16x16x32_bf16 a[84:87], v[112:115], v[68:71], a[84:87]
  ds_read_b128 v[40:43], v4 offset:38912
  v_mfma_f32_16x16x32_bf16 a[88:91], v[112:115], v[72:75], a[88:91]
  v_mfma_f32_16x16x32_bf16 a[92:95], v[112:115], v[76:79], a[92:95]
  ds_read_b128 v[44:47], v4 offset:39168
  v_mfma_f32_16x16x32_bf16 a[96:99], v[116:119], v[48:51], a[96:99]
  v_mfma_f32_16x16x32_bf16 a[100:103], v[116:119], v[52:55], a[100:103]
  ds_read_b64_tr_b16 v[88:89], v5 offset:49152
  v_mfma_f32_16x16x32_bf16 a[104:107], v[116:119], v[56:59], a[104:107]
  v_mfma_f32_16x16x32_bf16 a[108:111], v[116:119], v[60:63], a[108:111]
  ds_read_b64_tr_b16 v[90:91], v5 offset:50176
  v_mfma_f32_16x16x32_bf16 a[112:115], v[116:119], v[64:67], a[112:115]
  v_mfma_f32_16x16x32_bf16 a[116:119], v[116:119], v[68:71], a[116:119]
  ds_read_b64_tr_b16 v[92:93], v5 offset:49160
  v_mfma_f32_16x16x32_bf16 a[120:123], v[116:119], v[72:75], a[120:123]
  v_mfma_f32_16x16x32_bf16 a[124:127], v[116:119], v[76:79], a[124:127]
  ds_read_b64_tr_b16 v[94:95], v5 offset:50184
  v_mfma_f32_16x16x32_bf16 a[128:131], v[48:51], v[120:123], a[128:131]
  v_mfma_f32_16x16x32_bf16 a[132:135], v[52:55], v[120:123], a[132:135]
  ds_read_b64_tr_b16 v[96:97], v6 offset:57344
  v_mfma_f32_16x16x32_bf16 a[136:139], v[56:59], v[120:123], a[136:139]
  v_mfma_f32_16x16x32_bf16 a[140:143], v[60:63], v[120:123], a[140:143]
  ds_read_b64_tr_b16 v[98:99], v6 offset:58368
  v_mfma_f32_16x16x32_bf16 a[144:147], v[64:67], v[120:123], a[144:147]
  v_mfma_f32_16x16x32_bf16 a[148:151], v[68:71], v[120:123], a[148:151]
  ds_read_b64_tr_b16 v[100:101], v6 offset:57376
  v_mfma_f32_16x16x32_bf16 a[152:155], v[72:75], v[120:123], a[152:155]
  v_mfma_f32_16x16x32_bf16 a[156:159], v[76:79], v[120:123], a[156:159]
  ds_read_b64_tr_b16 v[102:103], v6 offset:58400
  v_mfma_f32_16x16x32_bf16 a[160:163], v[48:51], v[124:127], a[160:163]
  v_mfma_f32_16x16x32_bf16 a[164:167], v[52:55], v[124:127], a[164:167]
  v_mfma_f32_16x16x32_bf16 a[168:171], v[56:59], v[124:127], a[168:171]
  v_mfma_f32_16x16x32_bf16 a[172:175], v[60:63], v[124:127], a[172:175]
  v_mfma_f32_16x16x32_bf16 a[176:179], v[64:67], v[124:127], a[176:179]
  v_mfma_f32_16x16x32_bf16 a[180:183], v[68:71], v[124:127], a[180:183]
  v_mfma_f32_16x16x32_bf16 a[184:187], v[72:75], v[124:127], a[184:187]
  v_mfma_f32_16x16x32_bf16 a[188:191], v[76:79], v[124:127], a[188:191]
  s_waitcnt lgkmcnt(0)
  s_waitcnt vmcnt(16)
  s_barrier
  v_mfma_f32_16x16x32_bf16 a[0:3], v[80:83], v[16:19], a[0:3]
  v_mfma_f32_16x16x32_bf16 a[4:7], v[80:83], v[20:23], a[4:7]
  ds_read_b64_tr_b16 v[104:105], v8 offset:8192
  v_mfma_f32_16x16x32_bf16 a[8:11], v[80:83], v[24:27], a[8:11]
  v_mfma_f32_16x16x32_bf16 a[12:15], v[80:83], v[28:31], a[12:15]
  ds_read_b64_tr_b16 v[106:107], v8 offset:9216
  v_mfma_f32_16x16x32_bf16 a[16:19], v[80:83], v[32:35], a[16:19]
  v_mfma_f32_16x16x32_bf16 a[20:23], v[80:83], v[36:39], a[20:23]
  ds_read_b64_tr_b16 v[108:109], v8 offset:8200
  v_mfma_f32_16x16x32_bf16 a[24:27], v[80:83], v[40:43], a[24:27]
  v_mfma_f32_16x16x32_bf16 a[28:31], v[80:83], v[44:47], a[28:31]
  ds_read_b64_tr_b16 v[110:111], v8 offset:9224
  v_mfma_f32_16x16x32_bf16 a[32:35], v[84:87], v[16:19], a[32:35]
  v_mfma_f32_16x16x32_bf16 a[36:39], v[84:87], v[20:23], a[36:39]
  ds_read_b128 v[48:51], v7 offset:0
  v_mfma_f32_16x16x32_bf16 a[40:43], v[84:87], v[24:27], a[40:43]
  v_mfma_f32_16x16x32_bf16 a[44:47], v[84:87], v[28:31], a[44:47]
  ds_read_b128 v[52:55], v7 offset:256
  v_mfma_f32_16x16x32_bf16 a[48:51], v[84:87], v[32:35], a[48:51]
  v_mfma_f32_16x16x32_bf16 a[52:55], v[84:87], v[36:39], a[52:55]
  ds_read_b128 v[56:59], v7 offset:2048
  v_mfma_f32_16x16x32_bf16 a[56:59], v[84:87], v[40:43], a[56:59]
  v_mfma_f32_16x16x32_bf16 a[60:63], v[84:87], v[44:47], a[60:63]
  ds_read_b128 v[60:63], v7 offset:2304
  v_mfma_f32_16x16x32_bf16 a[64:67], v[88:91], v[16:19], a[64:67]
  v_mfma_f32_16x16x32_bf16 a[68:71], v[88:91], v[20:23], a[68:71]
  ds_read_b128 v[64:67], v7 offset:4096
  v_mfma_f32_16x16x32_bf16 a[72:75], v[88:91], v[24:27], a[72:75]
  v_mfma_f32_16x16x32_bf16 a[76:79], v[88:91], v[28:31], a[76:79]
  ds_read_b128 v[68:71], v7 offset:4352
  v_mfma_f32_16x16x32_bf16 a[80:83], v[88:91], v[32:35], a[80:83]
  v_mfma_f32_16x16x32_bf16 a[84:87], v[88:91], v[36:39], a[84:87]
  ds_read_b128 v[72:75], v7 offset:6144
  v_mfma_f32_16x16x32_bf16 a[88:91], v[88:91], v[40:43], a[88:91]
  v_mfma_f32_16x16x32_bf16 a[92:95], v[88:91], v[44:47], a[92:95]
  ds_read_b128 v[76:79], v7 offset:6400
  v_mfma_f32_16x16x32_bf16 a[96:99], v[92:95], v[16:19], a[96:99]
  v_mfma_f32_16x16x32_bf16 a[100:103], v[92:95], v[20:23], a[100:103]
  ds_read_b64_tr_b16 v[112:113], v8 offset:16384
  v_mfma_f32_16x16x32_bf16 a[104:107], v[92:95], v[24:27], a[104:107]
  v_mfma_f32_16x16x32_bf16 a[108:111], v[92:95], v[28:31], a[108:111]
  ds_read_b64_tr_b16 v[114:115], v8 offset:17408
  v_mfma_f32_16x16x32_bf16 a[112:115], v[92:95], v[32:35], a[112:115]
  v_mfma_f32_16x16x32_bf16 a[116:119], v[92:95], v[36:39], a[116:119]
  ds_read_b64_tr_b16 v[116:117], v8 offset:16392
  v_mfma_f32_16x16x32_bf16 a[120:123], v[92:95], v[40:43], a[120:123]
  v_mfma_f32_16x16x32_bf16 a[124:127], v[92:95], v[44:47], a[124:127]
  ds_read_b64_tr_b16 v[118:119], v8 offset:17416
  v_mfma_f32_16x16x32_bf16 a[128:131], v[16:19], v[96:99], a[128:131]
  v_mfma_f32_16x16x32_bf16 a[132:135], v[20:23], v[96:99], a[132:135]
  ds_read_b64_tr_b16 v[120:121], v9 offset:24576
  v_mfma_f32_16x16x32_bf16 a[136:139], v[24:27], v[96:99], a[136:139]
  v_mfma_f32_16x16x32_bf16 a[140:143], v[28:31], v[96:99], a[140:143]
  ds_read_b64_tr_b16 v[122:123], v9 offset:25600
  v_mfma_f32_16x16x32_bf16 a[144:147], v[32:35], v[96:99], a[144:147]
  v_mfma_f32_16x16x32_bf16 a[148:151], v[36:39], v[96:99], a[148:151]
  ds_read_b64_tr_b16 v[124:125], v9 offset:24608
  v_mfma_f32_16x16x32_bf16 a[152:155], v[40:43], v[96:99], a[152:155]
  v_mfma_f32_16x16x32_bf16 a[156:159], v[44:47], v[96:99], a[156:159]
  ds_read_b64_tr_b16 v[126:127], v9 offset:25632
  v_mfma_f32_16x16x32_bf16 a[160:163], v[16:19], v[100:103], a[160:163]
  v_mfma_f32_16x16x32_bf16 a[164:167], v[20:23], v[100:103], a[164:167]
  v_mfma_f32_16x16x32_bf16 a[168:171], v[24:27], v[100:103], a[168:171]
  v_mfma_f32_16x16x32_bf16 a[172:175], v[28:31], v[100:103], a[172:175]
  v_mfma_f32_16x16x32_bf16 a[176:179], v[32:35], v[100:103], a[176:179]
  v_mfma_f32_16x16x32_bf16 a[180:183], v[36:39], v[100:103], a[180:183]
  v_mfma_f32_16x16x32_bf16 a[184:187], v[40:43], v[100:103], a[184:187]
  v_mfma_f32_16x16x32_bf16 a[188:191], v[44:47], v[100:103], a[188:191]
  s_waitcnt lgkmcnt(0)
  s_waitcnt vmcnt(8)
  s_barrier
  v_mfma_f32_16x16x32_bf16 a[0:3], v[104:107], v[48:51], a[0:3]
  v_mfma_f32_16x16x32_bf16 a[4:7], v[104:107], v[52:55], a[4:7]
  ds_read_b64_tr_b16 v[80:81], v8 offset:40960
  v_mfma_f32_16x16x32_bf16 a[8:11], v[104:107], v[56:59], a[8:11]
  v_mfma_f32_16x16x32_bf16 a[12:15], v[104:107], v[60:63], a[12:15]
  ds_read_b64_tr_b16 v[82:83], v8 offset:41984
  v_mfma_f32_16x16x32_bf16 a[16:19], v[104:107], v[64:67], a[16:19]
  v_mfma_f32_16x16x32_bf16 a[20:23], v[104:107], v[68:71], a[20:23]
  ds_read_b64_tr_b16 v[84:85], v8 offset:40968
  v_mfma_f32_16x16x32_bf16 a[24:27], v[104:107], v[72:75], a[24:27]
  v_mfma_f32_16x16x32_bf16 a[28:31], v[104:107], v[76:79], a[28:31]
  ds_read_b64_tr_b16 v[86:87], v8 offset:41992
  v_mfma_f32_16x16x32_bf16 a[32:35], v[108:111], v[48:51], a[32:35]
  v_mfma_f32_16x16x32_bf16 a[36:39], v[108:111], v[52:55], a[36:39]
  ds_read_b128 v[16:19], v7 offset:32768
  v_mfma_f32_16x16x32_bf16 a[40:43], v[108:111], v[56:59], a[40:43]
  v_mfma_f32_16x16x32_bf16 a[44:47], v[108:111], v[60:63], a[44:47]
  ds_read_b128 v[20:23], v7 offset:33024
  v_mfma_f32_16x16x32_bf16 a[48:51], v[108:111], v[64:67], a[48:51]
  v_mfma_f32_16x16x32_bf16 a[52:55], v[108:111], v[68:71], a[52:55]
  ds_read_b128 v[24:27], v7 offset:34816
  v_mfma_f32_16x16x32_bf16 a[56:59], v[108:111], v[72:75], a[56:59]
  v_mfma_f32_16x16x32_bf16 a[60:63], v[108:111], v[76:79], a[60:63]
  ds_read_b128 v[28:31], v7 offset:35072
  v_mfma_f32_16x16x32_bf16 a[64:67], v[112:115], v[48:51], a[64:67]
  v_mfma_f32_16x16x32_bf16 a[68:71], v[112:115], v[52:55], a[68:71]
  ds_read_b128 v[32:35], v7 offset:36864
  v_mfma_f32_16x16x32_bf16 a[72:75], v[112:115], v[56:59], a[72:75]
  v_mfma_f32_16x16x32_bf16 a[76:79], v[112:115], v[60:63], a[76:79]
  ds_read_b128 v[36:39], v7 offset:37120
  v_mfma_f32_16x16x32_bf16 a[80:83], v[112:115], v[64:67], a[80:83]
  v_mfma_f32_16x16x32_bf16 a[84:87], v[112:115], v[68:71], a[84:87]
  ds_read_b128 v[40:43], v7 offset:38912
  v_mfma_f32_16x16x32_bf16 a[88:91], v[112:115], v[72:75], a[88:91]
  v_mfma_f32_16x16x32_bf16 a[92:95], v[112:115], v[76:79], a[92:95]
  ds_read_b128 v[44:47], v7 offset:39168
  v_mfma_f32_16x16x32_bf16 a[96:99], v[116:119], v[48:51], a[96:99]
  v_mfma_f32_16x16x32_bf16 a[100:103], v[116:119], v[52:55], a[100:103]
  ds_read_b64_tr_b16 v[88:89], v8 offset:49152
  v_mfma_f32_16x16x32_bf16 a[104:107], v[116:119], v[56:59], a[104:107]
  v_mfma_f32_16x16x32_bf16 a[108:111], v[116:119], v[60:63], a[108:111]
  ds_read_b64_tr_b16 v[90:91], v8 offset:50176
  v_mfma_f32_16x16x32_bf16 a[112:115], v[116:119], v[64:67], a[112:115]
  v_mfma_f32_16x16x32_bf16 a[116:119], v[116:119], v[68:71], a[116:119]
  ds_read_b64_tr_b16 v[92:93], v8 offset:49160
  v_mfma_f32_16x16x32_bf16 a[120:123], v[116:119], v[72:75], a[120:123]
  v_mfma_f32_16x16x32_bf16 a[124:127], v[116:119], v[76:79], a[124:127]
  ds_read_b64_tr_b16 v[94:95], v8 offset:50184
  v_mfma_f32_16x16x32_bf16 a[128:131], v[48:51], v[120:123], a[128:131]
  v_mfma_f32_16x16x32_bf16 a[132:135], v[52:55], v[120:123], a[132:135]
  ds_read_b64_tr_b16 v[96:97], v9 offset:57344
  v_mfma_f32_16x16x32_bf16 a[136:139], v[56:59], v[120:123], a[136:139]
  v_mfma_f32_16x16x32_bf16 a[140:143], v[60:63], v[120:123], a[140:143]
  ds_read_b64_tr_b16 v[98:99], v9 offset:58368
  v_mfma_f32_16x16x32_bf16 a[144:147], v[64:67], v[120:123], a[144:147]
  v_mfma_f32_16x16x32_bf16 a[148:151], v[68:71], v[120:123], a[148:151]
  ds_read_b64_tr_b16 v[100:101], v9 offset:57376
  v_mfma_f32_16x16x32_bf16 a[152:155], v[72:75], v[120:123], a[152:155]
  v_mfma_f32_16x16x32_bf16 a[156:159], v[76:79], v[120:123], a[156:159]
  ds_read_b64_tr_b16 v[102:103], v9 offset:58400
  v_mfma_f32_16x16x32_bf16 a[160:163], v[48:51], v[124:127], a[160:163]
  v_mfma_f32_16x16x32_bf16 a[164:167], v[52:55], v[124:127], a[164:167]
  v_mfma_f32_16x16x32_bf16 a[168:171], v[56:59], v[124:127], a[168:171]
  v_mfma_f32_16x16x32_bf16 a[172:175], v[60:63], v[124:127], a[172:175]
  v_mfma_f32_16x16x32_bf16 a[176:179], v[64:67], v[124:127], a[176:179]
  v_mfma_f32_16x16x32_bf16 a[180:183], v[68:71], v[124:127], a[180:183]
  v_mfma_f32_16x16x32_bf16 a[184:187], v[72:75], v[124:127], a[184:187]
  v_mfma_f32_16x16x32_bf16 a[188:191], v[76:79], v[124:127], a[188:191]
  s_waitcnt lgkmcnt(0)
  s_waitcnt vmcnt(0)
  s_barrier
  v_mfma_f32_16x16x32_bf16 a[0:3], v[80:83], v[16:19], a[0:3]
  v_mfma_f32_16x16x32_bf16 a[4:7], v[80:83], v[20:23], a[4:7]
  ds_read_b64_tr_b16 v[104:105], v11 offset:8192
  v_mfma_f32_16x16x32_bf16 a[8:11], v[80:83], v[24:27], a[8:11]
  v_mfma_f32_16x16x32_bf16 a[12:15], v[80:83], v[28:31], a[12:15]
  ds_read_b64_tr_b16 v[106:107], v11 offset:9216
  v_mfma_f32_16x16x32_bf16 a[16:19], v[80:83], v[32:35], a[16:19]
  v_mfma_f32_16x16x32_bf16 a[20:23], v[80:83], v[36:39], a[20:23]
  ds_read_b64_tr_b16 v[108:109], v11 offset:8200
  v_mfma_f32_16x16x32_bf16 a[24:27], v[80:83], v[40:43], a[24:27]
  v_mfma_f32_16x16x32_bf16 a[28:31], v[80:83], v[44:47], a[28:31]
  ds_read_b64_tr_b16 v[110:111], v11 offset:9224
  v_mfma_f32_16x16x32_bf16 a[32:35], v[84:87], v[16:19], a[32:35]
  v_mfma_f32_16x16x32_bf16 a[36:39], v[84:87], v[20:23], a[36:39]
  ds_read_b128 v[48:51], v10 offset:0
  v_mfma_f32_16x16x32_bf16 a[40:43], v[84:87], v[24:27], a[40:43]
  v_mfma_f32_16x16x32_bf16 a[44:47], v[84:87], v[28:31], a[44:47]
  ds_read_b128 v[52:55], v10 offset:256
  v_mfma_f32_16x16x32_bf16 a[48:51], v[84:87], v[32:35], a[48:51]
  v_mfma_f32_16x16x32_bf16 a[52:55], v[84:87], v[36:39], a[52:55]
  ds_read_b128 v[56:59], v10 offset:2048
  v_mfma_f32_16x16x32_bf16 a[56:59], v[84:87], v[40:43], a[56:59]
  v_mfma_f32_16x16x32_bf16 a[60:63], v[84:87], v[44:47], a[60:63]
  ds_read_b128 v[60:63], v10 offset:2304
  v_mfma_f32_16x16x32_bf16 a[64:67], v[88:91], v[16:19], a[64:67]
  v_mfma_f32_16x16x32_bf16 a[68:71], v[88:91], v[20:23], a[68:71]
  ds_read_b128 v[64:67], v10 offset:4096
  v_mfma_f32_16x16x32_bf16 a[72:75], v[88:91], v[24:27], a[72:75]
  v_mfma_f32_16x16x32_bf16 a[76:79], v[88:91], v[28:31], a[76:79]
  ds_read_b128 v[68:71], v10 offset:4352
  v_mfma_f32_16x16x32_bf16 a[80:83], v[88:91], v[32:35], a[80:83]
  v_mfma_f32_16x16x32_bf16 a[84:87], v[88:91], v[36:39], a[84:87]
  ds_read_b128 v[72:75], v10 offset:6144
  v_mfma_f32_16x16x32_bf16 a[88:91], v[88:91], v[40:43], a[88:91]
  v_mfma_f32_16x16x32_bf16 a[92:95], v[88:91], v[44:47], a[92:95]
  ds_read_b128 v[76:79], v10 offset:6400
  v_mfma_f32_16x16x32_bf16 a[96:99], v[92:95], v[16:19], a[96:99]
  v_mfma_f32_16x16x32_bf16 a[100:103], v[92:95], v[20:23], a[100:103]
  ds_read_b64_tr_b16 v[112:113], v11 offset:16384
  v_mfma_f32_16x16x32_bf16 a[104:107], v[92:95], v[24:27], a[104:107]
  v_mfma_f32_16x16x32_bf16 a[108:111], v[92:95], v[28:31], a[108:111]
  ds_read_b64_tr_b16 v[114:115], v11 offset:17408
  v_mfma_f32_16x16x32_bf16 a[112:115], v[92:95], v[32:35], a[112:115]
  v_mfma_f32_16x16x32_bf16 a[116:119], v[92:95], v[36:39], a[116:119]
  ds_read_b64_tr_b16 v[116:117], v11 offset:16392
  v_mfma_f32_16x16x32_bf16 a[120:123], v[92:95], v[40:43], a[120:123]
  v_mfma_f32_16x16x32_bf16 a[124:127], v[92:95], v[44:47], a[124:127]
  ds_read_b64_tr_b16 v[118:119], v11 offset:17416
  v_mfma_f32_16x16x32_bf16 a[128:131], v[16:19], v[96:99], a[128:131]
  v_mfma_f32_16x16x32_bf16 a[132:135], v[20:23], v[96:99], a[132:135]
  ds_read_b64_tr_b16 v[120:121], v12 offset:24576
  v_mfma_f32_16x16x32_bf16 a[136:139], v[24:27], v[96:99], a[136:139]
  v_mfma_f32_16x16x32_bf16 a[140:143], v[28:31], v[96:99], a[140:143]
  ds_read_b64_tr_b16 v[122:123], v12 offset:25600
  v_mfma_f32_16x16x32_bf16 a[144:147], v[32:35], v[96:99], a[144:147]
  v_mfma_f32_16x16x32_bf16 a[148:151], v[36:39], v[96:99], a[148:151]
  ds_read_b64_tr_b16 v[124:125], v12 offset:24608
  v_mfma_f32_16x16x32_bf16 a[152:155], v[40:43], v[96:99], a[152:155]
  v_mfma_f32_16x16x32_bf16 a[156:159], v[44:47], v[96:99], a[156:159]
  ds_read_b64_tr_b16 v[126:127], v12 offset:25632
  v_mfma_f32_16x16x32_bf16 a[160:163], v[16:19], v[100:103], a[160:163]
  v_mfma_f32_16x16x32_bf16 a[164:167], v[20:23], v[100:103], a[164:167]
  v_mfma_f32_16x16x32_bf16 a[168:171], v[24:27], v[100:103], a[168:171]
  v_mfma_f32_16x16x32_bf16 a[172:175], v[28:31], v[100:103], a[172:175]
  v_mfma_f32_16x16x32_bf16 a[176:179], v[32:35], v[100:103], a[176:179]
  v_mfma_f32_16x16x32_bf16 a[180:183], v[36:39], v[100:103], a[180:183]
  v_mfma_f32_16x16x32_bf16 a[184:187], v[40:43], v[100:103], a[184:187]
  v_mfma_f32_16x16x32_bf16 a[188:191], v[44:47], v[100:103], a[188:191]
  s_waitcnt lgkmcnt(0)
  s_barrier
  v_mfma_f32_16x16x32_bf16 a[0:3], v[104:107], v[48:51], a[0:3]
  v_mfma_f32_16x16x32_bf16 a[4:7], v[104:107], v[52:55], a[4:7]
  v_mfma_f32_16x16x32_bf16 a[8:11], v[104:107], v[56:59], a[8:11]
  v_mfma_f32_16x16x32_bf16 a[12:15], v[104:107], v[60:63], a[12:15]
  v_mfma_f32_16x16x32_bf16 a[16:19], v[104:107], v[64:67], a[16:19]
  v_mfma_f32_16x16x32_bf16 a[20:23], v[104:107], v[68:71], a[20:23]
  v_mfma_f32_16x16x32_bf16 a[24:27], v[104:107], v[72:75], a[24:27]
  v_mfma_f32_16x16x32_bf16 a[28:31], v[104:107], v[76:79], a[28:31]
  v_mfma_f32_16x16x32_bf16 a[32:35], v[108:111], v[48:51], a[32:35]
  v_mfma_f32_16x16x32_bf16 a[36:39], v[108:111], v[52:55], a[36:39]
  v_mfma_f32_16x16x32_bf16 a[40:43], v[108:111], v[56:59], a[40:43]
  v_mfma_f32_16x16x32_bf16 a[44:47], v[108:111], v[60:63], a[44:47]
  v_mfma_f32_16x16x32_bf16 a[48:51], v[108:111], v[64:67], a[48:51]
  v_mfma_f32_16x16x32_bf16 a[52:55], v[108:111], v[68:71], a[52:55]
  v_mfma_f32_16x16x32_bf16 a[56:59], v[108:111], v[72:75], a[56:59]
  v_mfma_f32_16x16x32_bf16 a[60:63], v[108:111], v[76:79], a[60:63]
  v_mfma_f32_16x16x32_bf16 a[64:67], v[112:115], v[48:51], a[64:67]
  v_mfma_f32_16x16x32_bf16 a[68:71], v[112:115], v[52:55], a[68:71]
  v_mfma_f32_16x16x32_bf16 a[72:75], v[112:115], v[56:59], a[72:75]
  v_mfma_f32_16x16x32_bf16 a[76:79], v[112:115], v[60:63], a[76:79]
  v_mfma_f32_16x16x32_bf16 a[80:83], v[112:115], v[64:67], a[80:83]
  v_mfma_f32_16x16x32_bf16 a[84:87], v[112:115], v[68:71], a[84:87]
  v_mfma_f32_16x16x32_bf16 a[88:91], v[112:115], v[72:75], a[88:91]
  v_mfma_f32_16x16x32_bf16 a[92:95], v[112:115], v[76:79], a[92:95]
  v_mfma_f32_16x16x32_bf16 a[96:99], v[116:119], v[48:51], a[96:99]
  v_mfma_f32_16x16x32_bf16 a[100:103], v[116:119], v[52:55], a[100:103]
  v_mfma_f32_16x16x32_bf16 a[104:107], v[116:119], v[56:59], a[104:107]
  v_mfma_f32_16x16x32_bf16 a[108:111], v[116:119], v[60:63], a[108:111]
  v_mfma_f32_16x16x32_bf16 a[112:115], v[116:119], v[64:67], a[112:115]
  v_mfma_f32_16x16x32_bf16 a[116:119], v[116:119], v[68:71], a[116:119]
  v_mfma_f32_16x16x32_bf16 a[120:123], v[116:119], v[72:75], a[120:123]
  v_mfma_f32_16x16x32_bf16 a[124:127], v[116:119], v[76:79], a[124:127]
  v_mfma_f32_16x16x32_bf16 a[128:131], v[48:51], v[120:123], a[128:131]
  v_mfma_f32_16x16x32_bf16 a[132:135], v[52:55], v[120:123], a[132:135]
  v_mfma_f32_16x16x32_bf16 a[136:139], v[56:59], v[120:123], a[136:139]
  v_mfma_f32_16x16x32_bf16 a[140:143], v[60:63], v[120:123], a[140:143]
  v_mfma_f32_16x16x32_bf16 a[144:147], v[64:67], v[120:123], a[144:147]
  v_mfma_f32_16x16x32_bf16 a[148:151], v[68:71], v[120:123], a[148:151]
  v_mfma_f32_16x16x32_bf16 a[152:155], v[72:75], v[120:123], a[152:155]
  v_mfma_f32_16x16x32_bf16 a[156:159], v[76:79], v[120:123], a[156:159]
  v_mfma_f32_16x16x32_bf16 a[160:163], v[48:51], v[124:127], a[160:163]
  v_mfma_f32_16x16x32_bf16 a[164:167], v[52:55], v[124:127], a[164:167]
  v_mfma_f32_16x16x32_bf16 a[168:171], v[56:59], v[124:127], a[168:171]
  v_mfma_f32_16x16x32_bf16 a[172:175], v[60:63], v[124:127], a[172:175]
  v_mfma_f32_16x16x32_bf16 a[176:179], v[64:67], v[124:127], a[176:179]
  v_mfma_f32_16x16x32_bf16 a[180:183], v[68:71], v[124:127], a[180:183]
  v_mfma_f32_16x16x32_bf16 a[184:187], v[72:75], v[124:127], a[184:187]
  v_mfma_f32_16x16x32_bf16 a[188:191], v[76:79], v[124:127], a[188:191]
  s_lshl_b32 s41, s36, 5
  s_add_u32 s41, s41, s37
  s_lshl_b32 s41, s41, 13
  s_lshl_b32 s23, s20, 11
  s_add_u32 s41, s41, s23
  s_add_u32 s42, s41, 0x0
  v_accvgpr_read_b32 v20, a64
  v_accvgpr_read_b32 v21, a65
  v_accvgpr_read_b32 v22, a66
  v_accvgpr_read_b32 v23, a67
  v_accvgpr_read_b32 v24, a96
  v_accvgpr_read_b32 v25, a97
  v_accvgpr_read_b32 v26, a98
  v_accvgpr_read_b32 v27, a99
  v_cvt_pk_bf16_f32 v16, v20, v21
  v_cvt_pk_bf16_f32 v17, v22, v23
  v_cvt_pk_bf16_f32 v18, v24, v25
  v_cvt_pk_bf16_f32 v19, v26, v27
  buffer_store_dwordx4 v[16:19], v0, s[4:7], s42 offen offset:0 sc1
  v_accvgpr_read_b32 v32, a68
  v_accvgpr_read_b32 v33, a69
  v_accvgpr_read_b32 v34, a70
  v_accvgpr_read_b32 v35, a71
  v_accvgpr_read_b32 v36, a100
  v_accvgpr_read_b32 v37, a101
  v_accvgpr_read_b32 v38, a102
  v_accvgpr_read_b32 v39, a103
  v_cvt_pk_bf16_f32 v28, v32, v33
  v_cvt_pk_bf16_f32 v29, v34, v35
  v_cvt_pk_bf16_f32 v30, v36, v37
  v_cvt_pk_bf16_f32 v31, v38, v39
  buffer_store_dwordx4 v[28:31], v0, s[4:7], s42 offen offset:1024 sc1
  s_add_u32 s42, s41, 0x40000
  v_accvgpr_read_b32 v44, a72
  v_accvgpr_read_b32 v45, a73
  v_accvgpr_read_b32 v46, a74
  v_accvgpr_read_b32 v47, a75
  v_accvgpr_read_b32 v48, a104
  v_accvgpr_read_b32 v49, a105
  v_accvgpr_read_b32 v50, a106
  v_accvgpr_read_b32 v51, a107
  v_cvt_pk_bf16_f32 v40, v44, v45
  v_cvt_pk_bf16_f32 v41, v46, v47
  v_cvt_pk_bf16_f32 v42, v48, v49
  v_cvt_pk_bf16_f32 v43, v50, v51
  buffer_store_dwordx4 v[40:43], v0, s[4:7], s42 offen offset:0 sc1
  v_accvgpr_read_b32 v56, a76
  v_accvgpr_read_b32 v57, a77
  v_accvgpr_read_b32 v58, a78
  v_accvgpr_read_b32 v59, a79
  v_accvgpr_read_b32 v60, a108
  v_accvgpr_read_b32 v61, a109
  v_accvgpr_read_b32 v62, a110
  v_accvgpr_read_b32 v63, a111
  v_cvt_pk_bf16_f32 v52, v56, v57
  v_cvt_pk_bf16_f32 v53, v58, v59
  v_cvt_pk_bf16_f32 v54, v60, v61
  v_cvt_pk_bf16_f32 v55, v62, v63
  buffer_store_dwordx4 v[52:55], v0, s[4:7], s42 offen offset:1024 sc1
  s_add_u32 s42, s41, 0x80000
  v_accvgpr_read_b32 v20, a80
  v_accvgpr_read_b32 v21, a81
  v_accvgpr_read_b32 v22, a82
  v_accvgpr_read_b32 v23, a83
  v_accvgpr_read_b32 v24, a112
  v_accvgpr_read_b32 v25, a113
  v_accvgpr_read_b32 v26, a114
  v_accvgpr_read_b32 v27, a115
  v_cvt_pk_bf16_f32 v16, v20, v21
  v_cvt_pk_bf16_f32 v17, v22, v23
  v_cvt_pk_bf16_f32 v18, v24, v25
  v_cvt_pk_bf16_f32 v19, v26, v27
  buffer_store_dwordx4 v[16:19], v0, s[4:7], s42 offen offset:0 sc1
  v_accvgpr_read_b32 v32, a84
  v_accvgpr_read_b32 v33, a85
  v_accvgpr_read_b32 v34, a86
  v_accvgpr_read_b32 v35, a87
  v_accvgpr_read_b32 v36, a116
  v_accvgpr_read_b32 v37, a117
  v_accvgpr_read_b32 v38, a118
  v_accvgpr_read_b32 v39, a119
  v_cvt_pk_bf16_f32 v28, v32, v33
  v_cvt_pk_bf16_f32 v29, v34, v35
  v_cvt_pk_bf16_f32 v30, v36, v37
  v_cvt_pk_bf16_f32 v31, v38, v39
  buffer_store_dwordx4 v[28:31], v0, s[4:7], s42 offen offset:1024 sc1
  s_add_u32 s42, s41, 0xc0000
  v_accvgpr_read_b32 v44, a88
  v_accvgpr_read_b32 v45, a89
  v_accvgpr_read_b32 v46, a90
  v_accvgpr_read_b32 v47, a91
  v_accvgpr_read_b32 v48, a120
  v_accvgpr_read_b32 v49, a121
  v_accvgpr_read_b32 v50, a122
  v_accvgpr_read_b32 v51, a123
  v_cvt_pk_bf16_f32 v40, v44, v45
  v_cvt_pk_bf16_f32 v41, v46, v47
  v_cvt_pk_bf16_f32 v42, v48, v49
  v_cvt_pk_bf16_f32 v43, v50, v51
  buffer_store_dwordx4 v[40:43], v0, s[4:7], s42 offen offset:0 sc1
  v_accvgpr_read_b32 v56, a92
  v_accvgpr_read_b32 v57, a93
  v_accvgpr_read_b32 v58, a94
  v_accvgpr_read_b32 v59, a95
  v_accvgpr_read_b32 v60, a124
  v_accvgpr_read_b32 v61, a125
  v_accvgpr_read_b32 v62, a126
  v_accvgpr_read_b32 v63, a127
  v_cvt_pk_bf16_f32 v52, v56, v57
  v_cvt_pk_bf16_f32 v53, v58, v59
  v_cvt_pk_bf16_f32 v54, v60, v61
  v_cvt_pk_bf16_f32 v55, v62, v63
  buffer_store_dwordx4 v[52:55], v0, s[4:7], s42 offen offset:1024 sc1
  s_add_u32 s42, s41, 0x2000000
  v_accvgpr_read_b32 v20, a0
  v_accvgpr_read_b32 v21, a1
  v_accvgpr_read_b32 v22, a2
  v_accvgpr_read_b32 v23, a3
  v_accvgpr_read_b32 v24, a32
  v_accvgpr_read_b32 v25, a33
  v_accvgpr_read_b32 v26, a34
  v_accvgpr_read_b32 v27, a35
  v_cvt_pk_bf16_f32 v16, v20, v21
  v_cvt_pk_bf16_f32 v17, v22, v23
  v_cvt_pk_bf16_f32 v18, v24, v25
  v_cvt_pk_bf16_f32 v19, v26, v27
  buffer_store_dwordx4 v[16:19], v0, s[4:7], s42 offen offset:0 sc1
  v_accvgpr_read_b32 v32, a4
  v_accvgpr_read_b32 v33, a5
  v_accvgpr_read_b32 v34, a6
  v_accvgpr_read_b32 v35, a7
  v_accvgpr_read_b32 v36, a36
  v_accvgpr_read_b32 v37, a37
  v_accvgpr_read_b32 v38, a38
  v_accvgpr_read_b32 v39, a39
  v_cvt_pk_bf16_f32 v28, v32, v33
  v_cvt_pk_bf16_f32 v29, v34, v35
  v_cvt_pk_bf16_f32 v30, v36, v37
  v_cvt_pk_bf16_f32 v31, v38, v39
  buffer_store_dwordx4 v[28:31], v0, s[4:7], s42 offen offset:1024 sc1
  s_add_u32 s42, s41, 0x2040000
  v_accvgpr_read_b32 v44, a8
  v_accvgpr_read_b32 v45, a9
  v_accvgpr_read_b32 v46, a10
  v_accvgpr_read_b32 v47, a11
  v_accvgpr_read_b32 v48, a40
  v_accvgpr_read_b32 v49, a41
  v_accvgpr_read_b32 v50, a42
  v_accvgpr_read_b32 v51, a43
  v_cvt_pk_bf16_f32 v40, v44, v45
  v_cvt_pk_bf16_f32 v41, v46, v47
  v_cvt_pk_bf16_f32 v42, v48, v49
  v_cvt_pk_bf16_f32 v43, v50, v51
  buffer_store_dwordx4 v[40:43], v0, s[4:7], s42 offen offset:0 sc1
  v_accvgpr_read_b32 v56, a12
  v_accvgpr_read_b32 v57, a13
  v_accvgpr_read_b32 v58, a14
  v_accvgpr_read_b32 v59, a15
  v_accvgpr_read_b32 v60, a44
  v_accvgpr_read_b32 v61, a45
  v_accvgpr_read_b32 v62, a46
  v_accvgpr_read_b32 v63, a47
  v_cvt_pk_bf16_f32 v52, v56, v57
  v_cvt_pk_bf16_f32 v53, v58, v59
  v_cvt_pk_bf16_f32 v54, v60, v61
  v_cvt_pk_bf16_f32 v55, v62, v63
  buffer_store_dwordx4 v[52:55], v0, s[4:7], s42 offen offset:1024 sc1
  s_add_u32 s42, s41, 0x2080000
  v_accvgpr_read_b32 v20, a16
  v_accvgpr_read_b32 v21, a17
  v_accvgpr_read_b32 v22, a18
  v_accvgpr_read_b32 v23, a19
  v_accvgpr_read_b32 v24, a48
  v_accvgpr_read_b32 v25, a49
  v_accvgpr_read_b32 v26, a50
  v_accvgpr_read_b32 v27, a51
  v_cvt_pk_bf16_f32 v16, v20, v21
  v_cvt_pk_bf16_f32 v17, v22, v23
  v_cvt_pk_bf16_f32 v18, v24, v25
  v_cvt_pk_bf16_f32 v19, v26, v27
  buffer_store_dwordx4 v[16:19], v0, s[4:7], s42 offen offset:0 sc1
  v_accvgpr_read_b32 v32, a20
  v_accvgpr_read_b32 v33, a21
  v_accvgpr_read_b32 v34, a22
  v_accvgpr_read_b32 v35, a23
  v_accvgpr_read_b32 v36, a52
  v_accvgpr_read_b32 v37, a53
  v_accvgpr_read_b32 v38, a54
  v_accvgpr_read_b32 v39, a55
  v_cvt_pk_bf16_f32 v28, v32, v33
  v_cvt_pk_bf16_f32 v29, v34, v35
  v_cvt_pk_bf16_f32 v30, v36, v37
  v_cvt_pk_bf16_f32 v31, v38, v39
  buffer_store_dwordx4 v[28:31], v0, s[4:7], s42 offen offset:1024 sc1
  s_add_u32 s42, s41, 0x20c0000
  v_accvgpr_read_b32 v44, a24
  v_accvgpr_read_b32 v45, a25
  v_accvgpr_read_b32 v46, a26
  v_accvgpr_read_b32 v47, a27
  v_accvgpr_read_b32 v48, a56
  v_accvgpr_read_b32 v49, a57
  v_accvgpr_read_b32 v50, a58
  v_accvgpr_read_b32 v51, a59
  v_cvt_pk_bf16_f32 v40, v44, v45
  v_cvt_pk_bf16_f32 v41, v46, v47
  v_cvt_pk_bf16_f32 v42, v48, v49
  v_cvt_pk_bf16_f32 v43, v50, v51
  buffer_store_dwordx4 v[40:43], v0, s[4:7], s42 offen offset:0 sc1
  v_accvgpr_read_b32 v56, a28
  v_accvgpr_read_b32 v57, a29
  v_accvgpr_read_b32 v58, a30
  v_accvgpr_read_b32 v59, a31
  v_accvgpr_read_b32 v60, a60
  v_accvgpr_read_b32 v61, a61
  v_accvgpr_read_b32 v62, a62
  v_accvgpr_read_b32 v63, a63
  v_cvt_pk_bf16_f32 v52, v56, v57
  v_cvt_pk_bf16_f32 v53, v58, v59
  v_cvt_pk_bf16_f32 v54, v60, v61
  v_cvt_pk_bf16_f32 v55, v62, v63
  buffer_store_dwordx4 v[52:55], v0, s[4:7], s42 offen offset:1024 sc1
  s_add_u32 s42, s41, 0x1000000
  v_accvgpr_read_b32 v20, a128
  v_accvgpr_read_b32 v21, a129
  v_accvgpr_read_b32 v22, a130
  v_accvgpr_read_b32 v23, a131
  v_accvgpr_read_b32 v24, a132
  v_accvgpr_read_b32 v25, a133
  v_accvgpr_read_b32 v26, a134
  v_accvgpr_read_b32 v27, a135
  v_cvt_pk_bf16_f32 v16, v20, v21
  v_cvt_pk_bf16_f32 v17, v22, v23
  v_cvt_pk_bf16_f32 v18, v24, v25
  v_cvt_pk_bf16_f32 v19, v26, v27
  buffer_store_dwordx4 v[16:19], v0, s[4:7], s42 offen offset:0 sc1
  v_accvgpr_read_b32 v32, a160
  v_accvgpr_read_b32 v33, a161
  v_accvgpr_read_b32 v34, a162
  v_accvgpr_read_b32 v35, a163
  v_accvgpr_read_b32 v36, a164
  v_accvgpr_read_b32 v37, a165
  v_accvgpr_read_b32 v38, a166
  v_accvgpr_read_b32 v39, a167
  v_cvt_pk_bf16_f32 v28, v32, v33
  v_cvt_pk_bf16_f32 v29, v34, v35
  v_cvt_pk_bf16_f32 v30, v36, v37
  v_cvt_pk_bf16_f32 v31, v38, v39
  buffer_store_dwordx4 v[28:31], v0, s[4:7], s42 offen offset:1024 sc1
  s_add_u32 s42, s41, 0x1040000
  v_accvgpr_read_b32 v44, a136
  v_accvgpr_read_b32 v45, a137
  v_accvgpr_read_b32 v46, a138
  v_accvgpr_read_b32 v47, a139
  v_accvgpr_read_b32 v48, a140
  v_accvgpr_read_b32 v49, a141
  v_accvgpr_read_b32 v50, a142
  v_accvgpr_read_b32 v51, a143
  v_cvt_pk_bf16_f32 v40, v44, v45
  v_cvt_pk_bf16_f32 v41, v46, v47
  v_cvt_pk_bf16_f32 v42, v48, v49
  v_cvt_pk_bf16_f32 v43, v50, v51
  buffer_store_dwordx4 v[40:43], v0, s[4:7], s42 offen offset:0 sc1
  v_accvgpr_read_b32 v56, a168
  v_accvgpr_read_b32 v57, a169
  v_accvgpr_read_b32 v58, a170
  v_accvgpr_read_b32 v59, a171
  v_accvgpr_read_b32 v60, a172
  v_accvgpr_read_b32 v61, a173
  v_accvgpr_read_b32 v62, a174
  v_accvgpr_read_b32 v63, a175
  v_cvt_pk_bf16_f32 v52, v56, v57
  v_cvt_pk_bf16_f32 v53, v58, v59
  v_cvt_pk_bf16_f32 v54, v60, v61
  v_cvt_pk_bf16_f32 v55, v62, v63
  buffer_store_dwordx4 v[52:55], v0, s[4:7], s42 offen offset:1024 sc1
  s_add_u32 s42, s41, 0x1080000
  v_accvgpr_read_b32 v20, a144
  v_accvgpr_read_b32 v21, a145
  v_accvgpr_read_b32 v22, a146
  v_accvgpr_read_b32 v23, a147
  v_accvgpr_read_b32 v24, a148
  v_accvgpr_read_b32 v25, a149
  v_accvgpr_read_b32 v26, a150
  v_accvgpr_read_b32 v27, a151
  v_cvt_pk_bf16_f32 v16, v20, v21
  v_cvt_pk_bf16_f32 v17, v22, v23
  v_cvt_pk_bf16_f32 v18, v24, v25
  v_cvt_pk_bf16_f32 v19, v26, v27
  buffer_store_dwordx4 v[16:19], v0, s[4:7], s42 offen offset:0 sc1
  v_accvgpr_read_b32 v32, a176
  v_accvgpr_read_b32 v33, a177
  v_accvgpr_read_b32 v34, a178
  v_accvgpr_read_b32 v35, a179
  v_accvgpr_read_b32 v36, a180
  v_accvgpr_read_b32 v37, a181
  v_accvgpr_read_b32 v38, a182
  v_accvgpr_read_b32 v39, a183
  v_cvt_pk_bf16_f32 v28, v32, v33
  v_cvt_pk_bf16_f32 v29, v34, v35
  v_cvt_pk_bf16_f32 v30, v36, v37
  v_cvt_pk_bf16_f32 v31, v38, v39
  buffer_store_dwordx4 v[28:31], v0, s[4:7], s42 offen offset:1024 sc1
  s_add_u32 s42, s41, 0x10c0000
  v_accvgpr_read_b32 v44, a152
  v_accvgpr_read_b32 v45, a153
  v_accvgpr_read_b32 v46, a154
  v_accvgpr_read_b32 v47, a155
  v_accvgpr_read_b32 v48, a156
  v_accvgpr_read_b32 v49, a157
  v_accvgpr_read_b32 v50, a158
  v_accvgpr_read_b32 v51, a159
  v_cvt_pk_bf16_f32 v40, v44, v45
  v_cvt_pk_bf16_f32 v41, v46, v47
  v_cvt_pk_bf16_f32 v42, v48, v49
  v_cvt_pk_bf16_f32 v43, v50, v51
  buffer_store_dwordx4 v[40:43], v0, s[4:7], s42 offen offset:0 sc1
  v_accvgpr_read_b32 v56, a184
  v_accvgpr_read_b32 v57, a185
  v_accvgpr_read_b32 v58, a186
  v_accvgpr_read_b32 v59, a187
  v_accvgpr_read_b32 v60, a188
  v_accvgpr_read_b32 v61, a189
  v_accvgpr_read_b32 v62, a190
  v_accvgpr_read_b32 v63, a191
  v_cvt_pk_bf16_f32 v52, v56, v57
  v_cvt_pk_bf16_f32 v53, v58, v59
  v_cvt_pk_bf16_f32 v54, v60, v61
  v_cvt_pk_bf16_f32 v55, v62, v63
  buffer_store_dwordx4 v[52:55], v0, s[4:7], s42 offen offset:1024 sc1
  s_waitcnt vmcnt(0)
  s_barrier
  s_branch L_tdone
L_t2:
  s_mul_i32 s38, s36, 40960
  s_and_b32 s43, s20, 3
  s_mul_i32 s23, s43, 20480
  s_lshl_b32 s43, s43, 10
  s_add_u32 s38, s38, s23
  s_lshl_b32 s39, s37, 8
  s_lshl_b32 s23, s20, 16
  s_add_u32 s39, s39, s23
  s_lshl_b32 s40, s20, 11
  s_add_u32 m0, s43, 0
  s_add_u32 s42, s38, 0
  buffer_load_dwordx4 v13, s[8:11], s42 offen lds
  s_add_u32 m0, s40, 16384
  s_add_u32 s42, s39, 0
  buffer_load_dwordx4 v3, s[28:31], s42 offen lds
  s_add_u32 m0, s40, 17408
  s_add_u32 s42, s39, 32768
  buffer_load_dwordx4 v3, s[28:31], s42 offen lds
  s_add_u32 m0, s40, 24576
  s_add_u32 s42, s39, 0
  buffer_load_dwordx4 v3, s[32:35], s42 offen lds
  s_add_u32 m0, s40, 25600
  s_add_u32 s42, s39, 32768
  buffer_load_dwordx4 v3, s[32:35], s42 offen lds
  s_add_u32 m0, s40, 8192
  s_add_u32 s42, s39, 0
  buffer_load_dwordx4 v3, s[12:15], s42 offen lds
  s_add_u32 m0, s40, 9216
  s_add_u32 s42, s39, 32768
  buffer_load_dwordx4 v3, s[12:15], s42 offen lds
  s_add_u32 m0, s43, 32768
  s_add_u32 s42, s38, 64
  buffer_load_dwordx4 v13, s[8:11], s42 offen lds
  s_add_u32 m0, s40, 49152
  s_add_u32 s42, s39, 262144
  buffer_load_dwordx4 v3, s[28:31], s42 offen lds
  s_add_u32 m0, s40, 50176
  s_add_u32 s42, s39, 294912
  buffer_load_dwordx4 v3, s[28:31], s42 offen lds
  s_add_u32 m0, s40, 57344
  s_add_u32 s42, s39, 262144
  buffer_load_dwordx4 v3, s[32:35], s42 offen lds
  s_add_u32 m0, s40, 58368
  s_add_u32 s42, s39, 294912
  buffer_load_dwordx4 v3, s[32:35], s42 offen lds
  s_add_u32 m0, s40, 40960
  s_add_u32 s42, s39, 262144
  buffer_load_dwordx4 v3, s[12:15], s42 offen lds
  s_add_u32 m0, s40, 41984
  s_add_u32 s42, s39, 294912
  buffer_load_dwordx4 v3, s[12:15], s42 offen lds
  s_add_u32 m0, s43, 65536
  s_add_u32 s42, s38, 128
  buffer_load_dwordx4 v13, s[8:11], s42 offen lds
  s_add_u32 m0, s40, 81920
  s_add_u32 s42, s39, 524288
  buffer_load_dwordx4 v3, s[28:31], s42 offen lds
  s_add_u32 m0, s40, 82944
  s_add_u32 s42, s39, 557056
  buffer_load_dwordx4 v3, s[28:31], s42 offen lds
  s_add_u32 m0, s40, 90112
  s_add_u32 s42, s39, 524288
  buffer_load_dwordx4 v3, s[32:35], s42 offen lds
  s_add_u32 m0, s40, 91136
  s_add_u32 s42, s39, 557056
  buffer_load_dwordx4 v3, s[32:35], s42 offen lds
  s_add_u32 m0, s40, 73728
  s_add_u32 s42, s39, 524288
  buffer_load_dwordx4 v3, s[12:15], s42 offen lds
  s_add_u32 m0, s40, 74752
  s_add_u32 s42, s39, 557056
  buffer_load_dwordx4 v3, s[12:15], s42 offen lds
  s_add_u32 m0, s43, 98304
  s_add_u32 s42, s38, 192
  buffer_load_dwordx4 v13, s[8:11], s42 offen lds
  s_add_u32 m0, s40, 114688
  s_add_u32 s42, s39, 786432
  buffer_load_dwordx4 v3, s[28:31], s42 offen lds
  s_add_u32 m0, s40, 115712
  s_add_u32 s42, s39, 819200
  buffer_load_dwordx4 v3, s[28:31], s42 offen lds
  s_add_u32 m0, s40, 122880
  s_add_u32 s42, s39, 786432
  buffer_load_dwordx4 v3, s[32:35], s42 offen lds
  s_add_u32 m0, s40, 123904
  s_add_u32 s42, s39, 819200
  buffer_load_dwordx4 v3, s[32:35], s42 offen lds
  s_add_u32 m0, s40, 106496
  s_add_u32 s42, s39, 786432
  buffer_load_dwordx4 v3, s[12:15], s42 offen lds
  s_add_u32 m0, s40, 107520
  s_add_u32 s42, s39, 819200
  buffer_load_dwordx4 v3, s[12:15], s42 offen lds
  s_add_u32 m0, s43, 131072
  s_add_u32 s42, s38, 256
  buffer_load_dwordx4 v13, s[8:11], s42 offen lds
  s_add_u32 m0, s40, 147456
  s_add_u32 s42, s39, 1048576
  buffer_load_dwordx4 v3, s[28:31], s42 offen lds
  s_add_u32 m0, s40, 148480
  s_add_u32 s42, s39, 1081344
  buffer_load_dwordx4 v3, s[28:31], s42 offen lds
  s_add_u32 m0, s40, 155648
  s_add_u32 s42, s39, 1048576
  buffer_load_dwordx4 v3, s[32:35], s42 offen lds
  s_add_u32 m0, s40, 156672
  s_add_u32 s42, s39, 1081344
  buffer_load_dwordx4 v3, s[32:35], s42 offen lds
  s_add_u32 m0, s40, 139264
  s_add_u32 s42, s39, 1048576
  buffer_load_dwordx4 v3, s[12:15], s42 offen lds
  s_add_u32 m0, s40, 140288
  s_add_u32 s42, s39, 1081344
  buffer_load_dwordx4 v3, s[12:15], s42 offen lds
  v_accvgpr_write_b32 a0, 0
  v_accvgpr_write_b32 a1, 0
  v_accvgpr_write_b32 a2, 0
  v_accvgpr_write_b32 a3, 0
  v_accvgpr_write_b32 a4, 0
  v_accvgpr_write_b32 a5, 0
  v_accvgpr_write_b32 a6, 0
  v_accvgpr_write_b32 a7, 0
  v_accvgpr_write_b32 a8, 0
  v_accvgpr_write_b32 a9, 0
  v_accvgpr_write_b32 a10, 0
  v_accvgpr_write_b32 a11, 0
  v_accvgpr_write_b32 a12, 0
  v_accvgpr_write_b32 a13, 0
  v_accvgpr_write_b32 a14, 0
  v_accvgpr_write_b32 a15, 0
  v_accvgpr_write_b32 a32, 0
  v_accvgpr_write_b32 a33, 0
  v_accvgpr_write_b32 a34, 0
  v_accvgpr_write_b32 a35, 0
  v_accvgpr_write_b32 a36, 0
  v_accvgpr_write_b32 a37, 0
  v_accvgpr_write_b32 a38, 0
  v_accvgpr_write_b32 a39, 0
  v_accvgpr_write_b32 a40, 0
  v_accvgpr_write_b32 a41, 0
  v_accvgpr_write_b32 a42, 0
  v_accvgpr_write_b32 a43, 0
  v_accvgpr_write_b32 a44, 0
  v_accvgpr_write_b32 a45, 0
  v_accvgpr_write_b32 a46, 0
  v_accvgpr_write_b32 a47, 0
  v_accvgpr_write_b32 a64, 0
  v_accvgpr_write_b32 a65, 0
  v_accvgpr_write_b32 a66, 0
  v_accvgpr_write_b32 a67, 0
  v_accvgpr_write_b32 a68, 0
  v_accvgpr_write_b32 a69, 0
  v_accvgpr_write_b32 a70, 0
  v_accvgpr_write_b32 a71, 0
  v_accvgpr_write_b32 a72, 0
  v_accvgpr_write_b32 a73, 0
  v_accvgpr_write_b32 a74, 0
  v_accvgpr_write_b32 a75, 0
  v_accvgpr_write_b32 a76, 0
  v_accvgpr_write_b32 a77, 0
  v_accvgpr_write_b32 a78, 0
  v_accvgpr_write_b32 a79, 0
  v_accvgpr_write_b32 a96, 0
  v_accvgpr_write_b32 a97, 0
  v_accvgpr_write_b32 a98, 0
  v_accvgpr_write_b32 a99, 0
  v_accvgpr_write_b32 a100, 0
  v_accvgpr_write_b32 a101, 0
  v_accvgpr_write_b32 a102, 0
  v_accvgpr_write_b32 a103, 0
  v_accvgpr_write_b32 a104, 0
  v_accvgpr_write_b32 a105, 0
  v_accvgpr_write_b32 a106, 0
  v_accvgpr_write_b32 a107, 0
  v_accvgpr_write_b32 a108, 0
  v_accvgpr_write_b32 a109, 0
  v_accvgpr_write_b32 a110, 0
  v_accvgpr_write_b32 a111, 0
  v_accvgpr_write_b32 a128, 0
  v_accvgpr_write_b32 a129, 0
  v_accvgpr_write_b32 a130, 0
  v_accvgpr_write_b32 a131, 0
  v_accvgpr_write_b32 a132, 0
  v_accvgpr_write_b32 a133, 0
  v_accvgpr_write_b32 a134, 0
  v_accvgpr_write_b32 a135, 0
  v_accvgpr_write_b32 a136, 0
  v_accvgpr_write_b32 a137, 0
  v_accvgpr_write_b32 a138, 0
  v_accvgpr_write_b32 a139, 0
  v_accvgpr_write_b32 a140, 0
  v_accvgpr_write_b32 a141, 0
  v_accvgpr_write_b32 a142, 0
  v_accvgpr_write_b32 a143, 0
  v_accvgpr_write_b32 a160, 0
  v_accvgpr_write_b32 a161, 0
  v_accvgpr_write_b32 a162, 0
  v_accvgpr_write_b32 a163, 0
  v_accvgpr_write_b32 a164, 0
  v_accvgpr_write_b32 a165, 0
  v_accvgpr_write_b32 a166, 0
  v_accvgpr_write_b32 a167, 0
  v_accvgpr_write_b32 a168, 0
  v_accvgpr_write_b32 a169, 0
  v_accvgpr_write_b32 a170, 0
  v_accvgpr_write_b32 a171, 0
  v_accvgpr_write_b32 a172, 0
  v_accvgpr_write_b32 a173, 0
  v_accvgpr_write_b32 a174, 0
  v_accvgpr_write_b32 a175, 0
  s_waitcnt vmcnt(28)
  s_barrier
  ds_read_b64_tr_b16 v[80:81], v5 offset:8192
  ds_read_b64_tr_b16 v[82:83], v5 offset:9216
  ds_read_b64_tr_b16 v[84:85], v5 offset:8200
  ds_read_b64_tr_b16 v[86:87], v5 offset:9224
  ds_read_b128 v[16:19], v4 offset:0
  ds_read_b128 v[20:23], v4 offset:256
  ds_read_b128 v[24:27], v4 offset:2048
  ds_read_b128 v[28:31], v4 offset:2304
  ds_read_b64_tr_b16 v[88:89], v5 offset:16384
  ds_read_b64_tr_b16 v[90:91], v5 offset:17408
  ds_read_b64_tr_b16 v[92:93], v5 offset:16392
  ds_read_b64_tr_b16 v[94:95], v5 offset:17416
  ds_read_b64_tr_b16 v[96:97], v6 offset:24576
  ds_read_b64_tr_b16 v[98:99], v6 offset:25600
  ds_read_b64_tr_b16 v[100:101], v6 offset:24608
  ds_read_b64_tr_b16 v[102:103], v6 offset:25632
  s_waitcnt lgkmcnt(0)
  s_waitcnt vmcnt(21)
  s_barrier
  v_mfma_f32_16x16x32_bf16 a[0:3], v[80:83], v[16:19], a[0:3]
  ds_read_b64_tr_b16 v[104:105], v5 offset:40960
  s_add_u32 m0, s43, 0
  s_add_u32 s42, s38, 320
  buffer_load_dwordx4 v13, s[8:11], s42 offen lds
  v_mfma_f32_16x16x32_bf16 a[4:7], v[80:83], v[20:23], a[4:7]
  ds_read_b64_tr_b16 v[106:107], v5 offset:41984
  v_mfma_f32_16x16x32_bf16 a[8:11], v[80:83], v[24:27], a[8:11]
  ds_read_b64_tr_b16 v[108:109], v5 offset:40968
  v_mfma_f32_16x16x32_bf16 a[12:15], v[80:83], v[28:31], a[12:15]
  s_add_u32 m0, s40, 16384
  s_add_u32 s42, s39, 1310720
  buffer_load_dwordx4 v3, s[28:31], s42 offen lds
  v_mfma_f32_16x16x32_bf16 a[32:35], v[84:87], v[16:19], a[32:35]
  ds_read_b64_tr_b16 v[110:111], v5 offset:41992
  v_mfma_f32_16x16x32_bf16 a[36:39], v[84:87], v[20:23], a[36:39]
  ds_read_b128 v[48:51], v4 offset:32768
  v_mfma_f32_16x16x32_bf16 a[40:43], v[84:87], v[24:27], a[40:43]
  ds_read_b128 v[52:55], v4 offset:33024
  s_add_u32 m0, s40, 17408
  s_add_u32 s42, s39, 1343488
  buffer_load_dwordx4 v3, s[28:31], s42 offen lds
  v_mfma_f32_16x16x32_bf16 a[44:47], v[84:87], v[28:31], a[44:47]
  v_mfma_f32_16x16x32_bf16 a[64:67], v[88:91], v[16:19], a[64:67]
  ds_read_b128 v[56:59], v4 offset:34816
  v_mfma_f32_16x16x32_bf16 a[68:71], v[88:91], v[20:23], a[68:71]
  ds_read_b128 v[60:63], v4 offset:35072
  s_add_u32 m0, s40, 24576
  s_add_u32 s42, s39, 1310720
  buffer_load_dwordx4 v3, s[32:35], s42 offen lds
  v_mfma_f32_16x16x32_bf16 a[72:75], v[88:91], v[24:27], a[72:75]
  ds_read_b64_tr_b16 v[112:113], v5 offset:49152
  v_mfma_f32_16x16x32_bf16 a[76:79], v[88:91], v[28:31], a[76:79]
  v_mfma_f32_16x16x32_bf16 a[96:99], v[92:95], v[16:19], a[96:99]
  ds_read_b64_tr_b16 v[114:115], v5 offset:50176
  s_add_u32 m0, s40, 25600
  s_add_u32 s42, s39, 1343488
  buffer_load_dwordx4 v3, s[32:35], s42 offen lds
  v_mfma_f32_16x16x32_bf16 a[100:103], v[92:95], v[20:23], a[100:103]
  ds_read_b64_tr_b16 v[116:117], v5 offset:49160
  v_mfma_f32_16x16x32_bf16 a[104:107], v[92:95], v[24:27], a[104:107]
  ds_read_b64_tr_b16 v[118:119], v5 offset:50184
  v_mfma_f32_16x16x32_bf16 a[108:111], v[92:95], v[28:31], a[108:111]
  s_add_u32 m0, s40, 8192
  s_add_u32 s42, s39, 1310720
  buffer_load_dwordx4 v3, s[12:15], s42 offen lds
  v_mfma_f32_16x16x32_bf16 a[128:131], v[16:19], v[96:99], a[128:131]
  ds_read_b64_tr_b16 v[120:121], v6 offset:57344
  v_mfma_f32_16x16x32_bf16 a[132:135], v[20:23], v[96:99], a[132:135]
  ds_read_b64_tr_b16 v[122:123], v6 offset:58368
  v_mfma_f32_16x16x32_bf16 a[136:139], v[24:27], v[96:99], a[136:139]
  ds_read_b64_tr_b16 v[124:125], v6 offset:57376
  s_add_u32 m0, s40, 9216
  s_add_u32 s42, s39, 1343488
  buffer_load_dwordx4 v3, s[12:15], s42 offen lds
  v_mfma_f32_16x16x32_bf16 a[140:143], v[28:31], v[96:99], a[140:143]
  v_mfma_f32_16x16x32_bf16 a[160:163], v[16:19], v[100:103], a[160:163]
  ds_read_b64_tr_b16 v[126:127], v6 offset:58400
  v_mfma_f32_16x16x32_bf16 a[164:167], v[20:23], v[100:103], a[164:167]
  v_mfma_f32_16x16x32_bf16 a[168:171], v[24:27], v[100:103], a[168:171]
  v_mfma_f32_16x16x32_bf16 a[172:175], v[28:31], v[100:103], a[172:175]
  s_waitcnt lgkmcnt(0)
  s_waitcnt vmcnt(21)
  s_barrier
  v_mfma_f32_16x16x32_bf16 a[0:3], v[104:107], v[48:51], a[0:3]
  ds_read_b64_tr_b16 v[80:81], v8 offset:8192
  s_add_u32 m0, s43, 32768
  s_add_u32 s42, s38, 384
  buffer_load_dwordx4 v13, s[8:11], s42 offen lds
  v_mfma_f32_16x16x32_bf16 a[4:7], v[104:107], v[52:55], a[4:7]
  ds_read_b64_tr_b16 v[82:83], v8 offset:9216
  v_mfma_f32_16x16x32_bf16 a[8:11], v[104:107], v[56:59], a[8:11]
  ds_read_b64_tr_b16 v[84:85], v8 offset:8200
  v_mfma_f32_16x16x32_bf16 a[12:15], v[104:107], v[60:63], a[12:15]
  s_add_u32 m0, s40, 49152
  s_add_u32 s42, s39, 1572864
  buffer_load_dwordx4 v3, s[28:31], s42 offen lds
  v_mfma_f32_16x16x32_bf16 a[32:35], v[108:111], v[48:51], a[32:35]
  ds_read_b64_tr_b16 v[86:87], v8 offset:9224
  v_mfma_f32_16x16x32_bf16 a[36:39], v[108:111], v[52:55], a[36:39]
  ds_read_b128 v[16:19], v7 offset:0
  v_mfma_f32_16x16x32_bf16 a[40:43], v[108:111], v[56:59], a[40:43]
  ds_read_b128 v[20:23], v7 offset:256
  s_add_u32 m0, s40, 50176
  s_add_u32 s42, s39, 1605632
  buffer_load_dwordx4 v3, s[28:31], s42 offen lds
  v_mfma_f32_16x16x32_bf16 a[44:47], v[108:111], v[60:63], a[44:47]
  v_mfma_f32_16x16x32_bf16 a[64:67], v[112:115], v[48:51], a[64:67]
  ds_read_b128 v[24:27], v7 offset:2048
  v_mfma_f32_16x16x32_bf16 a[68:71], v[112:115], v[52:55], a[68:71]
  ds_read_b128 v[28:31], v7 offset:2304
  s_add_u32 m0, s40, 57344
  s_add_u32 s42, s39, 1572864
  buffer_load_dwordx4 v3, s[32:35], s42 offen lds
  v_mfma_f32_16x16x32_bf16 a[72:75], v[112:115], v[56:59], a[72:75]
  ds_read_b64_tr_b16 v[88:89], v8 offset:16384
  v_mfma_f32_16x16x32_bf16 a[76:79], v[112:115], v[60:63], a[76:79]
  v_mfma_f32_16x16x32_bf16 a[96:99], v[116:119], v[48:51], a[96:99]
  ds_read_b64_tr_b16 v[90:91], v8 offset:17408
  s_add_u32 m0, s40, 58368
  s_add_u32 s42, s39, 1605632
  buffer_load_dwordx4 v3, s[32:35], s42 offen lds
  v_mfma_f32_16x16x32_bf16 a[100:103], v[116:119], v[52:55], a[100:103]
  ds_read_b64_tr_b16 v[92:93], v8 offset:16392
  v_mfma_f32_16x16x32_bf16 a[104:107], v[116:119], v[56:59], a[104:107]
  ds_read_b64_tr_b16 v[94:95], v8 offset:17416
  v_mfma_f32_16x16x32_bf16 a[108:111], v[116:119], v[60:63], a[108:111]
  s_add_u32 m0, s40, 40960
  s_add_u32 s42, s39, 1572864
  buffer_load_dwordx4 v3, s[12:15], s42 offen lds
  v_mfma_f32_16x16x32_bf16 a[128:131], v[48:51], v[120:123], a[128:131]
  ds_read_b64_tr_b16 v[96:97], v9 offset:24576
  v_mfma_f32_16x16x32_bf16 a[132:135], v[52:55], v[120:123], a[132:135]
  ds_read_b64_tr_b16 v[98:99], v9 offset:25600
  v_mfma_f32_16x16x32_bf16 a[136:139], v[56:59], v[120:123], a[136:139]
  ds_read_b64_tr_b16 v[100:101], v9 offset:24608
  s_add_u32 m0, s40, 41984
  s_add_u32 s42, s39, 1605632
  buffer_load_dwordx4 v3, s[12:15], s42 offen lds
  v_mfma_f32_16x16x32_bf16 a[140:143], v[60:63], v[120:123], a[140:143]
  v_mfma_f32_16x16x32_bf16 a[160:163], v[48:51], v[124:127], a[160:163]
  ds_read_b64_tr_b16 v[102:103], v9 offset:25632
  v_mfma_f32_16x16x32_bf16 a[164:167], v[52:55], v[124:127], a[164:167]
  v_mfma_f32_16x16x32_bf16 a[168:171], v[56:59], v[124:127], a[168:171]
  v_mfma_f32_16x16x32_bf16 a[172:175], v[60:63], v[124:127], a[172:175]
  s_waitcnt lgkmcnt(0)
  s_waitcnt vmcnt(21)
  s_barrier
  v_mfma_f32_16x16x32_bf16 a[0:3], v[80:83], v[16:19], a[0:3]
  ds_read_b64_tr_b16 v[104:105], v8 offset:40960
  s_add_u32 m0, s43, 65536
  s_add_u32 s42, s38, 448
  buffer_load_dwordx4 v13, s[8:11], s42 offen lds
  v_mfma_f32_16x16x32_bf16 a[4:7], v[80:83], v[20:23], a[4:7]
  ds_read_b64_tr_b16 v[106:107], v8 offset:41984
  v_mfma_f32_16x16x32_bf16 a[8:11], v[80:83], v[24:27], a[8:11]
  ds_read_b64_tr_b16 v[108:109], v8 offset:40968
  v_mfma_f32_16x16x32_bf16 a[12:15], v[80:83], v[28:31], a[12:15]
  s_add_u32 m0, s40, 81920
  s_add_u32 s42, s39, 1835008
  buffer_load_dwordx4 v3, s[28:31], s42 offen lds
  v_mfma_f32_16x16x32_bf16 a[32:35], v[84:87], v[16:19], a[32:35]
  ds_read_b64_tr_b16 v[110:111], v8 offset:41992
  v_mfma_f32_16x16x32_bf16 a[36:39], v[84:87], v[20:23], a[36:39]
  ds_read_b128 v[48:51], v7 offset:32768
  v_mfma_f32_16x16x32_bf16 a[40:43], v[84:87], v[24:27], a[40:43]
  ds_read_b128 v[52:55], v7 offset:33024
  s_add_u32 m0, s40, 82944
  s_add_u32 s42, s39, 1867776
  buffer_load_dwordx4 v3, s[28:31], s42 offen lds
  v_mfma_f32_16x16x32_bf16 a[44:47], v[84:87], v[28:31], a[44:47]
  v_mfma_f32_16x16x32_bf16 a[64:67], v[88:91], v[16:19], a[64:67]
  ds_read_b128 v[56:59], v7 offset:34816
  v_mfma_f32_16x16x32_bf16 a[68:71], v[88:91], v[20:23], a[68:71]
  ds_read_b128 v[60:63], v7 offset:35072
  s_add_u32 m0, s40, 90112
  s_add_u32 s42, s39, 1835008
  buffer_load_dwordx4 v3, s[32:35], s42 offen lds
  v_mfma_f32_16x16x32_bf16 a[72:75], v[88:91], v[24:27], a[72:75]
  ds_read_b64_tr_b16 v[112:113], v8 offset:49152
  v_mfma_f32_16x16x32_bf16 a[76:79], v[88:91], v[28:31], a[76:79]
  v_mfma_f32_16x16x32_bf16 a[96:99], v[92:95], v[16:19], a[96:99]
  ds_read_b64_tr_b16 v[114:115], v8 offset:50176
  s_add_u32 m0, s40, 91136
  s_add_u32 s42, s39, 1867776
  buffer_load_dwordx4 v3, s[32:35], s42 offen lds
  v_mfma_f32_16x16x32_bf16 a[100:103], v[92:95], v[20:23], a[100:103]
  ds_read_b64_tr_b16 v[116:117], v8 offset:49160
  v_mfma_f32_16x16x32_bf16 a[104:107], v[92:95], v[24:27], a[104:107]
  ds_read_b64_tr_b16 v[118:119], v8 offset:50184
  v_mfma_f32_16x16x32_bf16 a[108:111], v[92:95], v[28:31], a[108:111]
  s_add_u32 m0, s40, 73728
  s_add_u32 s42, s39, 1835008
  buffer_load_dwordx4 v3, s[12:15], s42 offen lds
  v_mfma_f32_16x16x32_bf16 a[128:131], v[16:19], v[96:99], a[128:131]
  ds_read_b64_tr_b16 v[120:121], v9 offset:57344
  v_mfma_f32_16x16x32_bf16 a[132:135], v[20:23], v[96:99], a[132:135]
  ds_read_b64_tr_b16 v[122:123], v9 offset:58368
  v_mfma_f32_16x16x32_bf16 a[136:139], v[24:27], v[96:99], a[136:139]
  ds_read_b64_tr_b16 v[124:125], v9 offset:57376
  s_add_u32 m0, s40, 74752
  s_add_u32 s42, s39, 1867776
  buffer_load_dwordx4 v3, s[12:15], s42 offen lds
  v_mfma_f32_16x16x32_bf16 a[140:143], v[28:31], v[96:99], a[140:143]
  v_mfma_f32_16x16x32_bf16 a[160:163], v[16:19], v[100:103], a[160:163]
  ds_read_b64_tr_b16 v[126:127], v9 offset:58400
  v_mfma_f32_16x16x32_bf16 a[164:167], v[20:23], v[100:103], a[164:167]
  v_mfma_f32_16x16x32_bf16 a[168:171], v[24:27], v[100:103], a[168:171]
  v_mfma_f32_16x16x32_bf16 a[172:175], v[28:31], v[100:103], a[172:175]
  s_waitcnt lgkmcnt(0)
  s_waitcnt vmcnt(21)
  s_barrier
  v_mfma_f32_16x16x32_bf16 a[0:3], v[104:107], v[48:51], a[0:3]
  ds_read_b64_tr_b16 v[80:81], v11 offset:8192
  s_add_u32 m0, s43, 98304
  s_add_u32 s42, s38, 512
  buffer_load_dwordx4 v13, s[8:11], s42 offen lds
  v_mfma_f32_16x16x32_bf16 a[4:7], v[104:107], v[52:55], a[4:7]
  ds_read_b64_tr_b16 v[82:83], v11 offset:9216
  v_mfma_f32_16x16x32_bf16 a[8:11], v[104:107], v[56:59], a[8:11]
  ds_read_b64_tr_b16 v[84:85], v11 offset:8200
  v_mfma_f32_16x16x32_bf16 a[12:15], v[104:107], v[60:63], a[12:15]
  s_add_u32 m0, s40, 114688
  s_add_u32 s42, s39, 2097152
  buffer_load_dwordx4 v3, s[28:31], s42 offen lds
  v_mfma_f32_16x16x32_bf16 a[32:35], v[108:111], v[48:51], a[32:35]
  ds_read_b64_tr_b16 v[86:87], v11 offset:9224
  v_mfma_f32_16x16x32_bf16 a[36:39], v[108:111], v[52:55], a[36:39]
  ds_read_b128 v[16:19], v10 offset:0
  v_mfma_f32_16x16x32_bf16 a[40:43], v[108:111], v[56:59], a[40:43]
  ds_read_b128 v[20:23], v10 offset:256
  s_add_u32 m0, s40, 115712
  s_add_u32 s42, s39, 2129920
  buffer_load_dwordx4 v3, s[28:31], s42 offen lds
  v_mfma_f32_16x16x32_bf16 a[44:47], v[108:111], v[60:63], a[44:47]
  v_mfma_f32_16x16x32_bf16 a[64:67], v[112:115], v[48:51], a[64:67]
  ds_read_b128 v[24:27], v10 offset:2048
  v_mfma_f32_16x16x32_bf16 a[68:71], v[112:115], v[52:55], a[68:71]
  ds_read_b128 v[28:31], v10 offset:2304
  s_add_u32 m0, s40, 122880
  s_add_u32 s42, s39, 2097152
  buffer_load_dwordx4 v3, s[32:35], s42 offen lds
  v_mfma_f32_16x16x32_bf16 a[72:75], v[112:115], v[56:59], a[72:75]
  ds_read_b64_tr_b16 v[88:89], v11 offset:16384
  v_mfma_f32_16x16x32_bf16 a[76:79], v[112:115], v[60:63], a[76:79]
  v_mfma_f32_16x16x32_bf16 a[96:99], v[116:119], v[48:51], a[96:99]
  ds_read_b64_tr_b16 v[90:91], v11 offset:17408
  s_add_u32 m0, s40, 123904
  s_add_u32 s42, s39, 2129920
  buffer_load_dwordx4 v3, s[32:35], s42 offen lds
  v_mfma_f32_16x16x32_bf16 a[100:103], v[116:119], v[52:55], a[100:103]
  ds_read_b64_tr_b16 v[92:93], v11 offset:16392
  v_mfma_f32_16x16x32_bf16 a[104:107], v[116:119], v[56:59], a[104:107]
  ds_read_b64_tr_b16 v[94:95], v11 offset:17416
  v_mfma_f32_16x16x32_bf16 a[108:111], v[116:119], v[60:63], a[108:111]
  s_add_u32 m0, s40, 106496
  s_add_u32 s42, s39, 2097152
  buffer_load_dwordx4 v3, s[12:15], s42 offen lds
  v_mfma_f32_16x16x32_bf16 a[128:131], v[48:51], v[120:123], a[128:131]
  ds_read_b64_tr_b16 v[96:97], v12 offset:24576
  v_mfma_f32_16x16x32_bf16 a[132:135], v[52:55], v[120:123], a[132:135]
  ds_read_b64_tr_b16 v[98:99], v12 offset:25600
  v_mfma_f32_16x16x32_bf16 a[136:139], v[56:59], v[120:123], a[136:139]
  ds_read_b64_tr_b16 v[100:101], v12 offset:24608
  s_add_u32 m0, s40, 107520
  s_add_u32 s42, s39, 2129920
  buffer_load_dwordx4 v3, s[12:15], s42 offen lds
  v_mfma_f32_16x16x32_bf16 a[140:143], v[60:63], v[120:123], a[140:143]
  v_mfma_f32_16x16x32_bf16 a[160:163], v[48:51], v[124:127], a[160:163]
  ds_read_b64_tr_b16 v[102:103], v12 offset:25632
  v_mfma_f32_16x16x32_bf16 a[164:167], v[52:55], v[124:127], a[164:167]
  v_mfma_f32_16x16x32_bf16 a[168:171], v[56:59], v[124:127], a[168:171]
  v_mfma_f32_16x16x32_bf16 a[172:175], v[60:63], v[124:127], a[172:175]
  s_waitcnt lgkmcnt(0)
  s_waitcnt vmcnt(21)
  s_barrier
  v_mfma_f32_16x16x32_bf16 a[0:3], v[80:83], v[16:19], a[0:3]
  ds_read_b64_tr_b16 v[104:105], v5 offset:8192
  s_add_u32 m0, s43, 131072
  s_add_u32 s42, s38, 576
  buffer_load_dwordx4 v13, s[8:11], s42 offen lds
  v_mfma_f32_16x16x32_bf16 a[4:7], v[80:83], v[20:23], a[4:7]
  ds_read_b64_tr_b16 v[106:107], v5 offset:9216
  v_mfma_f32_16x16x32_bf16 a[8:11], v[80:83], v[24:27], a[8:11]
  ds_read_b64_tr_b16 v[108:109], v5 offset:8200
  v_mfma_f32_16x16x32_bf16 a[12:15], v[80:83], v[28:31], a[12:15]
  s_add_u32 m0, s40, 147456
  s_add_u32 s42, s39, 2359296
  buffer_load_dwordx4 v3, s[28:31], s42 offen lds
  v_mfma_f32_16x16x32_bf16 a[32:35], v[84:87], v[16:19], a[32:35]
  ds_read_b64_tr_b16 v[110:111], v5 offset:9224
  v_mfma_f32_16x16x32_bf16 a[36:39], v[84:87], v[20:23], a[36:39]
  ds_read_b128 v[48:51], v4 offset:0
  v_mfma_f32_16x16x32_bf16 a[40:43], v[84:87], v[24:27], a[40:43]
  ds_read_b128 v[52:55], v4 offset:256
  s_add_u32 m0, s40, 148480
  s_add_u32 s42, s39, 2392064
  buffer_load_dwordx4 v3, s[28:31], s42 offen lds
  v_mfma_f32_16x16x32_bf16 a[44:47], v[84:87], v[28:31], a[44:47]
  v_mfma_f32_16x16x32_bf16 a[64:67], v[88:91], v[16:19], a[64:67]
  ds_read_b128 v[56:59], v4 offset:2048
  v_mfma_f32_16x16x32_bf16 a[68:71], v[88:91], v[20:23], a[68:71]
  ds_read_b128 v[60:63], v4 offset:2304
  s_add_u32 m0, s40, 155648
  s_add_u32 s42, s39, 2359296
  buffer_load_dwordx4 v3, s[32:35], s42 offen lds
  v_mfma_f32_16x16x32_bf16 a[72:75], v[88:91], v[24:27], a[72:75]
  ds_read_b64_tr_b16 v[112:113], v5 offset:16384
  v_mfma_f32_16x16x32_bf16 a[76:79], v[88:91], v[28:31], a[76:79]
  v_mfma_f32_16x16x32_bf16 a[96:99], v[92:95], v[16:19], a[96:99]
  ds_read_b64_tr_b16 v[114:115], v5 offset:17408
  s_add_u32 m0, s40, 156672
  s_add_u32 s42, s39, 2392064
  buffer_load_dwordx4 v3, s[32:35], s42 offen lds
  v_mfma_f32_16x16x32_bf16 a[100:103], v[92:95], v[20:23], a[100:103]
  ds_read_b64_tr_b16 v[116:117], v5 offset:16392
  v_mfma_f32_16x16x32_bf16 a[104:107], v[92:95], v[24:27], a[104:107]
  ds_read_b64_tr_b16 v[118:119], v5 offset:17416
  v_mfma_f32_16x16x32_bf16 a[108:111], v[92:95], v[28:31], a[108:111]
  s_add_u32 m0, s40, 139264
  s_add_u32 s42, s39, 2359296
  buffer_load_dwordx4 v3, s[12:15], s42 offen lds
  v_mfma_f32_16x16x32_bf16 a[128:131], v[16:19], v[96:99], a[128:131]
  ds_read_b64_tr_b16 v[120:121], v6 offset:24576
  v_mfma_f32_16x16x32_bf16 a[132:135], v[20:23], v[96:99], a[132:135]
  ds_read_b64_tr_b16 v[122:123], v6 offset:25600
  v_mfma_f32_16x16x32_bf16 a[136:139], v[24:27], v[96:99], a[136:139]
  ds_read_b64_tr_b16 v[124:125], v6 offset:24608
  s_add_u32 m0, s40, 140288
  s_add_u32 s42, s39, 2392064
  buffer_load_dwordx4 v3, s[12:15], s42 offen lds
  v_mfma_f32_16x16x32_bf16 a[140:143], v[28:31], v[96:99], a[140:143]
  v_mfma_f32_16x16x32_bf16 a[160:163], v[16:19], v[100:103], a[160:163]
  ds_read_b64_tr_b16 v[126:127], v6 offset:25632
  v_mfma_f32_16x16x32_bf16 a[164:167], v[20:23], v[100:103], a[164:167]
  v_mfma_f32_16x16x32_bf16 a[168:171], v[24:27], v[100:103], a[168:171]
  v_mfma_f32_16x16x32_bf16 a[172:175], v[28:31], v[100:103], a[172:175]
  s_waitcnt lgkmcnt(0)
  s_waitcnt vmcnt(21)
  s_barrier
  v_mfma_f32_16x16x32_bf16 a[0:3], v[104:107], v[48:51], a[0:3]
  ds_read_b64_tr_b16 v[80:81], v5 offset:40960
  s_add_u32 m0, s43, 0
  s_add_u32 s42, s38, 640
  buffer_load_dwordx4 v13, s[8:11], s42 offen lds
  v_mfma_f32_16x16x32_bf16 a[4:7], v[104:107], v[52:55], a[4:7]
  ds_read_b64_tr_b16 v[82:83], v5 offset:41984
  v_mfma_f32_16x16x32_bf16 a[8:11], v[104:107], v[56:59], a[8:11]
  ds_read_b64_tr_b16 v[84:85], v5 offset:40968
  v_mfma_f32_16x16x32_bf16 a[12:15], v[104:107], v[60:63], a[12:15]
  s_add_u32 m0, s40, 16384
  s_add_u32 s42, s39, 2621440
  buffer_load_dwordx4 v3, s[28:31], s42 offen lds
  v_mfma_f32_16x16x32_bf16 a[32:35], v[108:111], v[48:51], a[32:35]
  ds_read_b64_tr_b16 v[86:87], v5 offset:41992
  v_mfma_f32_16x16x32_bf16 a[36:39], v[108:111], v[52:55], a[36:39]
  ds_read_b128 v[16:19], v4 offset:32768
  v_mfma_f32_16x16x32_bf16 a[40:43], v[108:111], v[56:59], a[40:43]
  ds_read_b128 v[20:23], v4 offset:33024
  s_add_u32 m0, s40, 17408
  s_add_u32 s42, s39, 2654208
  buffer_load_dwordx4 v3, s[28:31], s42 offen lds
  v_mfma_f32_16x16x32_bf16 a[44:47], v[108:111], v[60:63], a[44:47]
  v_mfma_f32_16x16x32_bf16 a[64:67], v[112:115], v[48:51], a[64:67]
  ds_read_b128 v[24:27], v4 offset:34816
  v_mfma_f32_16x16x32_bf16 a[68:71], v[112:115], v[52:55], a[68:71]
  ds_read_b128 v[28:31], v4 offset:35072
  s_add_u32 m0, s40, 24576
  s_add_u32 s42, s39, 2621440
  buffer_load_dwordx4 v3, s[32:35], s42 offen lds
  v_mfma_f32_16x16x32_bf16 a[72:75], v[112:115], v[56:59], a[72:75]
  ds_read_b64_tr_b16 v[88:89], v5 offset:49152
  v_mfma_f32_16x16x32_bf16 a[76:79], v[112:115], v[60:63], a[76:79]
  v_mfma_f32_16x16x32_bf16 a[96:99], v[116:119], v[48:51], a[96:99]
  ds_read_b64_tr_b16 v[90:91], v5 offset:50176
  s_add_u32 m0, s40, 25600
  s_add_u32 s42, s39, 2654208
  buffer_load_dwordx4 v3, s[32:35], s42 offen lds
  v_mfma_f32_16x16x32_bf16 a[100:103], v[116:119], v[52:55], a[100:103]
  ds_read_b64_tr_b16 v[92:93], v5 offset:49160
  v_mfma_f32_16x16x32_bf16 a[104:107], v[116:119], v[56:59], a[104:107]
  ds_read_b64_tr_b16 v[94:95], v5 offset:50184
  v_mfma_f32_16x16x32_bf16 a[108:111], v[116:119], v[60:63], a[108:111]
  s_add_u32 m0, s40, 8192
  s_add_u32 s42, s39, 2621440
  buffer_load_dwordx4 v3, s[12:15], s42 offen lds
  v_mfma_f32_16x16x32_bf16 a[128:131], v[48:51], v[120:123], a[128:131]
  ds_read_b64_tr_b16 v[96:97], v6 offset:57344
  v_mfma_f32_16x16x32_bf16 a[132:135], v[52:55], v[120:123], a[132:135]
  ds_read_b64_tr_b16 v[98:99], v6 offset:58368
  v_mfma_f32_16x16x32_bf16 a[136:139], v[56:59], v[120:123], a[136:139]
  ds_read_b64_tr_b16 v[100:101], v6 offset:57376
  s_add_u32 m0, s40, 9216
  s_add_u32 s42, s39, 2654208
  buffer_load_dwordx4 v3, s[12:15], s42 offen lds
  v_mfma_f32_16x16x32_bf16 a[140:143], v[60:63], v[120:123], a[140:143]
  v_mfma_f32_16x16x32_bf16 a[160:163], v[48:51], v[124:127], a[160:163]
  ds_read_b64_tr_b16 v[102:103], v6 offset:58400
  v_mfma_f32_16x16x32_bf16 a[164:167], v[52:55], v[124:127], a[164:167]
  v_mfma_f32_16x16x32_bf16 a[168:171], v[56:59], v[124:127], a[168:171]
  v_mfma_f32_16x16x32_bf16 a[172:175], v[60:63], v[124:127], a[172:175]
  s_waitcnt lgkmcnt(0)
  s_waitcnt vmcnt(21)
  s_barrier
  v_mfma_f32_16x16x32_bf16 a[0:3], v[80:83], v[16:19], a[0:3]
  ds_read_b64_tr_b16 v[104:105], v8 offset:8192
  s_add_u32 m0, s43, 32768
  s_add_u32 s42, s38, 704
  buffer_load_dwordx4 v13, s[8:11], s42 offen lds
  v_mfma_f32_16x16x32_bf16 a[4:7], v[80:83], v[20:23], a[4:7]
  ds_read_b64_tr_b16 v[106:107], v8 offset:9216
  v_mfma_f32_16x16x32_bf16 a[8:11], v[80:83], v[24:27], a[8:11]
  ds_read_b64_tr_b16 v[108:109], v8 offset:8200
  v_mfma_f32_16x16x32_bf16 a[12:15], v[80:83], v[28:31], a[12:15]
  s_add_u32 m0, s40, 49152
  s_add_u32 s42, s39, 2883584
  buffer_load_dwordx4 v3, s[28:31], s42 offen lds
  v_mfma_f32_16x16x32_bf16 a[32:35], v[84:87], v[16:19], a[32:35]
  ds_read_b64_tr_b16 v[110:111], v8 offset:9224
  v_mfma_f32_16x16x32_bf16 a[36:39], v[84:87], v[20:23], a[36:39]
  ds_read_b128 v[48:51], v7 offset:0
  v_mfma_f32_16x16x32_bf16 a[40:43], v[84:87], v[24:27], a[40:43]
  ds_read_b128 v[52:55], v7 offset:256
  s_add_u32 m0, s40, 50176
  s_add_u32 s42, s39, 2916352
  buffer_load_dwordx4 v3, s[28:31], s42 offen lds
  v_mfma_f32_16x16x32_bf16 a[44:47], v[84:87], v[28:31], a[44:47]
  v_mfma_f32_16x16x32_bf16 a[64:67], v[88:91], v[16:19], a[64:67]
  ds_read_b128 v[56:59], v7 offset:2048
  v_mfma_f32_16x16x32_bf16 a[68:71], v[88:91], v[20:23], a[68:71]
  ds_read_b128 v[60:63], v7 offset:2304
  s_add_u32 m0, s40, 57344
  s_add_u32 s42, s39, 2883584
  buffer_load_dwordx4 v3, s[32:35], s42 offen lds
  v_mfma_f32_16x16x32_bf16 a[72:75], v[88:91], v[24:27], a[72:75]
  ds_read_b64_tr_b16 v[112:113], v8 offset:16384
  v_mfma_f32_16x16x32_bf16 a[76:79], v[88:91], v[28:31], a[76:79]
  v_mfma_f32_16x16x32_bf16 a[96:99], v[92:95], v[16:19], a[96:99]
  ds_read_b64_tr_b16 v[114:115], v8 offset:17408
  s_add_u32 m0, s40, 58368
  s_add_u32 s42, s39, 2916352
  buffer_load_dwordx4 v3, s[32:35], s42 offen lds
  v_mfma_f32_16x16x32_bf16 a[100:103], v[92:95], v[20:23], a[100:103]
  ds_read_b64_tr_b16 v[116:117], v8 offset:16392
  v_mfma_f32_16x16x32_bf16 a[104:107], v[92:95], v[24:27], a[104:107]
  ds_read_b64_tr_b16 v[118:119], v8 offset:17416
  v_mfma_f32_16x16x32_bf16 a[108:111], v[92:95], v[28:31], a[108:111]
  s_add_u32 m0, s40, 40960
  s_add_u32 s42, s39, 2883584
  buffer_load_dwordx4 v3, s[12:15], s42 offen lds
  v_mfma_f32_16x16x32_bf16 a[128:131], v[16:19], v[96:99], a[128:131]
  ds_read_b64_tr_b16 v[120:121], v9 offset:24576
  v_mfma_f32_16x16x32_bf16 a[132:135], v[20:23], v[96:99], a[132:135]
  ds_read_b64_tr_b16 v[122:123], v9 offset:25600
  v_mfma_f32_16x16x32_bf16 a[136:139], v[24:27], v[96:99], a[136:139]
  ds_read_b64_tr_b16 v[124:125], v9 offset:24608
  s_add_u32 m0, s40, 41984
  s_add_u32 s42, s39, 2916352
  buffer_load_dwordx4 v3, s[12:15], s42 offen lds
  v_mfma_f32_16x16x32_bf16 a[140:143], v[28:31], v[96:99], a[140:143]
  v_mfma_f32_16x16x32_bf16 a[160:163], v[16:19], v[100:103], a[160:163]
  ds_read_b64_tr_b16 v[126:127], v9 offset:25632
  v_mfma_f32_16x16x32_bf16 a[164:167], v[20:23], v[100:103], a[164:167]
  v_mfma_f32_16x16x32_bf16 a[168:171], v[24:27], v[100:103], a[168:171]
  v_mfma_f32_16x16x32_bf16 a[172:175], v[28:31], v[100:103], a[172:175]
  s_waitcnt lgkmcnt(0)
  s_waitcnt vmcnt(21)
  s_barrier
  v_mfma_f32_16x16x32_bf16 a[0:3], v[104:107], v[48:51], a[0:3]
  ds_read_b64_tr_b16 v[80:81], v8 offset:40960
  s_add_u32 m0, s43, 65536
  s_add_u32 s42, s38, 768
  buffer_load_dwordx4 v13, s[8:11], s42 offen lds
  v_mfma_f32_16x16x32_bf16 a[4:7], v[104:107], v[52:55], a[4:7]
  ds_read_b64_tr_b16 v[82:83], v8 offset:41984
  v_mfma_f32_16x16x32_bf16 a[8:11], v[104:107], v[56:59], a[8:11]
  ds_read_b64_tr_b16 v[84:85], v8 offset:40968
  v_mfma_f32_16x16x32_bf16 a[12:15], v[104:107], v[60:63], a[12:15]
  s_add_u32 m0, s40, 81920
  s_add_u32 s42, s39, 3145728
  buffer_load_dwordx4 v3, s[28:31], s42 offen lds
  v_mfma_f32_16x16x32_bf16 a[32:35], v[108:111], v[48:51], a[32:35]
  ds_read_b64_tr_b16 v[86:87], v8 offset:41992
  v_mfma_f32_16x16x32_bf16 a[36:39], v[108:111], v[52:55], a[36:39]
  ds_read_b128 v[16:19], v7 offset:32768
  v_mfma_f32_16x16x32_bf16 a[40:43], v[108:111], v[56:59], a[40:43]
  ds_read_b128 v[20:23], v7 offset:33024
  s_add_u32 m0, s40, 82944
  s_add_u32 s42, s39, 3178496
  buffer_load_dwordx4 v3, s[28:31], s42 offen lds
  v_mfma_f32_16x16x32_bf16 a[44:47], v[108:111], v[60:63], a[44:47]
  v_mfma_f32_16x16x32_bf16 a[64:67], v[112:115], v[48:51], a[64:67]
  ds_read_b128 v[24:27], v7 offset:34816
  v_mfma_f32_16x16x32_bf16 a[68:71], v[112:115], v[52:55], a[68:71]
  ds_read_b128 v[28:31], v7 offset:35072
  s_add_u32 m0, s40, 90112
  s_add_u32 s42, s39, 3145728
  buffer_load_dwordx4 v3, s[32:35], s42 offen lds
  v_mfma_f32_16x16x32_bf16 a[72:75], v[112:115], v[56:59], a[72:75]
  ds_read_b64_tr_b16 v[88:89], v8 offset:49152
  v_mfma_f32_16x16x32_bf16 a[76:79], v[112:115], v[60:63], a[76:79]
  v_mfma_f32_16x16x32_bf16 a[96:99], v[116:119], v[48:51], a[96:99]
  ds_read_b64_tr_b16 v[90:91], v8 offset:50176
  s_add_u32 m0, s40, 91136
  s_add_u32 s42, s39, 3178496
  buffer_load_dwordx4 v3, s[32:35], s42 offen lds
  v_mfma_f32_16x16x32_bf16 a[100:103], v[116:119], v[52:55], a[100:103]
  ds_read_b64_tr_b16 v[92:93], v8 offset:49160
  v_mfma_f32_16x16x32_bf16 a[104:107], v[116:119], v[56:59], a[104:107]
  ds_read_b64_tr_b16 v[94:95], v8 offset:50184
  v_mfma_f32_16x16x32_bf16 a[108:111], v[116:119], v[60:63], a[108:111]
  s_add_u32 m0, s40, 73728
  s_add_u32 s42, s39, 3145728
  buffer_load_dwordx4 v3, s[12:15], s42 offen lds
  v_mfma_f32_16x16x32_bf16 a[128:131], v[48:51], v[120:123], a[128:131]
  ds_read_b64_tr_b16 v[96:97], v9 offset:57344
  v_mfma_f32_16x16x32_bf16 a[132:135], v[52:55], v[120:123], a[132:135]
  ds_read_b64_tr_b16 v[98:99], v9 offset:58368
  v_mfma_f32_16x16x32_bf16 a[136:139], v[56:59], v[120:123], a[136:139]
  ds_read_b64_tr_b16 v[100:101], v9 offset:57376
  s_add_u32 m0, s40, 74752
  s_add_u32 s42, s39, 3178496
  buffer_load_dwordx4 v3, s[12:15], s42 offen lds
  v_mfma_f32_16x16x32_bf16 a[140:143], v[60:63], v[120:123], a[140:143]
  v_mfma_f32_16x16x32_bf16 a[160:163], v[48:51], v[124:127], a[160:163]
  ds_read_b64_tr_b16 v[102:103], v9 offset:58400
  v_mfma_f32_16x16x32_bf16 a[164:167], v[52:55], v[124:127], a[164:167]
  v_mfma_f32_16x16x32_bf16 a[168:171], v[56:59], v[124:127], a[168:171]
  v_mfma_f32_16x16x32_bf16 a[172:175], v[60:63], v[124:127], a[172:175]
  s_waitcnt lgkmcnt(0)
  s_waitcnt vmcnt(21)
  s_barrier
  v_mfma_f32_16x16x32_bf16 a[0:3], v[80:83], v[16:19], a[0:3]
  ds_read_b64_tr_b16 v[104:105], v11 offset:8192
  s_add_u32 m0, s43, 98304
  s_add_u32 s42, s38, 832
  buffer_load_dwordx4 v13, s[8:11], s42 offen lds
  v_mfma_f32_16x16x32_bf16 a[4:7], v[80:83], v[20:23], a[4:7]
  ds_read_b64_tr_b16 v[106:107], v11 offset:9216
  v_mfma_f32_16x16x32_bf16 a[8:11], v[80:83], v[24:27], a[8:11]
  ds_read_b64_tr_b16 v[108:109], v11 offset:8200
  v_mfma_f32_16x16x32_bf16 a[12:15], v[80:83], v[28:31], a[12:15]
  s_add_u32 m0, s40, 114688
  s_add_u32 s42, s39, 3407872
  buffer_load_dwordx4 v3, s[28:31], s42 offen lds
  v_mfma_f32_16x16x32_bf16 a[32:35], v[84:87], v[16:19], a[32:35]
  ds_read_b64_tr_b16 v[110:111], v11 offset:9224
  v_mfma_f32_16x16x32_bf16 a[36:39], v[84:87], v[20:23], a[36:39]
  ds_read_b128 v[48:51], v10 offset:0
  v_mfma_f32_16x16x32_bf16 a[40:43], v[84:87], v[24:27], a[40:43]
  ds_read_b128 v[52:55], v10 offset:256
  s_add_u32 m0, s40, 115712
  s_add_u32 s42, s39, 3440640
  buffer_load_dwordx4 v3, s[28:31], s42 offen lds
  v_mfma_f32_16x16x32_bf16 a[44:47], v[84:87], v[28:31], a[44:47]
  v_mfma_f32_16x16x32_bf16 a[64:67], v[88:91], v[16:19], a[64:67]
  ds_read_b128 v[56:59], v10 offset:2048
  v_mfma_f32_16x16x32_bf16 a[68:71], v[88:91], v[20:23], a[68:71]
  ds_read_b128 v[60:63], v10 offset:2304
  s_add_u32 m0, s40, 122880
  s_add_u32 s42, s39, 3407872
  buffer_load_dwordx4 v3, s[32:35], s42 offen lds
  v_mfma_f32_16x16x32_bf16 a[72:75], v[88:91], v[24:27], a[72:75]
  ds_read_b64_tr_b16 v[112:113], v11 offset:16384
  v_mfma_f32_16x16x32_bf16 a[76:79], v[88:91], v[28:31], a[76:79]
  v_mfma_f32_16x16x32_bf16 a[96:99], v[92:95], v[16:19], a[96:99]
  ds_read_b64_tr_b16 v[114:115], v11 offset:17408
  s_add_u32 m0, s40, 123904
  s_add_u32 s42, s39, 3440640
  buffer_load_dwordx4 v3, s[32:35], s42 offen lds
  v_mfma_f32_16x16x32_bf16 a[100:103], v[92:95], v[20:23], a[100:103]
  ds_read_b64_tr_b16 v[116:117], v11 offset:16392
  v_mfma_f32_16x16x32_bf16 a[104:107], v[92:95], v[24:27], a[104:107]
  ds_read_b64_tr_b16 v[118:119], v11 offset:17416
  v_mfma_f32_16x16x32_bf16 a[108:111], v[92:95], v[28:31], a[108:111]
  s_add_u32 m0, s40, 106496
  s_add_u32 s42, s39, 3407872
  buffer_load_dwordx4 v3, s[12:15], s42 offen lds
  v_mfma_f32_16x16x32_bf16 a[128:131], v[16:19], v[96:99], a[128:131]
  ds_read_b64_tr_b16 v[120:121], v12 offset:24576
  v_mfma_f32_16x16x32_bf16 a[132:135], v[20:23], v[96:99], a[132:135]
  ds_read_b64_tr_b16 v[122:123], v12 offset:25600
  v_mfma_f32_16x16x32_bf16 a[136:139], v[24:27], v[96:99], a[136:139]
  ds_read_b64_tr_b16 v[124:125], v12 offset:24608
  s_add_u32 m0, s40, 107520
  s_add_u32 s42, s39, 3440640
  buffer_load_dwordx4 v3, s[12:15], s42 offen lds
  v_mfma_f32_16x16x32_bf16 a[140:143], v[28:31], v[96:99], a[140:143]
  v_mfma_f32_16x16x32_bf16 a[160:163], v[16:19], v[100:103], a[160:163]
  ds_read_b64_tr_b16 v[126:127], v12 offset:25632
  v_mfma_f32_16x16x32_bf16 a[164:167], v[20:23], v[100:103], a[164:167]
  v_mfma_f32_16x16x32_bf16 a[168:171], v[24:27], v[100:103], a[168:171]
  v_mfma_f32_16x16x32_bf16 a[172:175], v[28:31], v[100:103], a[172:175]
  s_waitcnt lgkmcnt(0)
  s_waitcnt vmcnt(21)
  s_barrier
  v_mfma_f32_16x16x32_bf16 a[0:3], v[104:107], v[48:51], a[0:3]
  ds_read_b64_tr_b16 v[80:81], v5 offset:8192
  s_add_u32 m0, s43, 131072
  s_add_u32 s42, s38, 896
  buffer_load_dwordx4 v13, s[8:11], s42 offen lds
  v_mfma_f32_16x16x32_bf16 a[4:7], v[104:107], v[52:55], a[4:7]
  ds_read_b64_tr_b16 v[82:83], v5 offset:9216
  v_mfma_f32_16x16x32_bf16 a[8:11], v[104:107], v[56:59], a[8:11]
  ds_read_b64_tr_b16 v[84:85], v5 offset:8200
  v_mfma_f32_16x16x32_bf16 a[12:15], v[104:107], v[60:63], a[12:15]
  s_add_u32 m0, s40, 147456
  s_add_u32 s42, s39, 3670016
  buffer_load_dwordx4 v3, s[28:31], s42 offen lds
  v_mfma_f32_16x16x32_bf16 a[32:35], v[108:111], v[48:51], a[32:35]
  ds_read_b64_tr_b16 v[86:87], v5 offset:9224
  v_mfma_f32_16x16x32_bf16 a[36:39], v[108:111], v[52:55], a[36:39]
  ds_read_b128 v[16:19], v4 offset:0
  v_mfma_f32_16x16x32_bf16 a[40:43], v[108:111], v[56:59], a[40:43]
  ds_read_b128 v[20:23], v4 offset:256
  s_add_u32 m0, s40, 148480
  s_add_u32 s42, s39, 3702784
  buffer_load_dwordx4 v3, s[28:31], s42 offen lds
  v_mfma_f32_16x16x32_bf16 a[44:47], v[108:111], v[60:63], a[44:47]
  v_mfma_f32_16x16x32_bf16 a[64:67], v[112:115], v[48:51], a[64:67]
  ds_read_b128 v[24:27], v4 offset:2048
  v_mfma_f32_16x16x32_bf16 a[68:71], v[112:115], v[52:55], a[68:71]
  ds_read_b128 v[28:31], v4 offset:2304
  s_add_u32 m0, s40, 155648
  s_add_u32 s42, s39, 3670016
  buffer_load_dwordx4 v3, s[32:35], s42 offen lds
  v_mfma_f32_16x16x32_bf16 a[72:75], v[112:115], v[56:59], a[72:75]
  ds_read_b64_tr_b16 v[88:89], v5 offset:16384
  v_mfma_f32_16x16x32_bf16 a[76:79], v[112:115], v[60:63], a[76:79]
  v_mfma_f32_16x16x32_bf16 a[96:99], v[116:119], v[48:51], a[96:99]
  ds_read_b64_tr_b16 v[90:91], v5 offset:17408
  s_add_u32 m0, s40, 156672
  s_add_u32 s42, s39, 3702784
  buffer_load_dwordx4 v3, s[32:35], s42 offen lds
  v_mfma_f32_16x16x32_bf16 a[100:103], v[116:119], v[52:55], a[100:103]
  ds_read_b64_tr_b16 v[92:93], v5 offset:16392
  v_mfma_f32_16x16x32_bf16 a[104:107], v[116:119], v[56:59], a[104:107]
  ds_read_b64_tr_b16 v[94:95], v5 offset:17416
  v_mfma_f32_16x16x32_bf16 a[108:111], v[116:119], v[60:63], a[108:111]
  s_add_u32 m0, s40, 139264
  s_add_u32 s42, s39, 3670016
  buffer_load_dwordx4 v3, s[12:15], s42 offen lds
  v_mfma_f32_16x16x32_bf16 a[128:131], v[48:51], v[120:123], a[128:131]
  ds_read_b64_tr_b16 v[96:97], v6 offset:24576
  v_mfma_f32_16x16x32_bf16 a[132:135], v[52:55], v[120:123], a[132:135]
  ds_read_b64_tr_b16 v[98:99], v6 offset:25600
  v_mfma_f32_16x16x32_bf16 a[136:139], v[56:59], v[120:123], a[136:139]
  ds_read_b64_tr_b16 v[100:101], v6 offset:24608
  s_add_u32 m0, s40, 140288
  s_add_u32 s42, s39, 3702784
  buffer_load_dwordx4 v3, s[12:15], s42 offen lds
  v_mfma_f32_16x16x32_bf16 a[140:143], v[60:63], v[120:123], a[140:143]
  v_mfma_f32_16x16x32_bf16 a[160:163], v[48:51], v[124:127], a[160:163]
  ds_read_b64_tr_b16 v[102:103], v6 offset:25632
  v_mfma_f32_16x16x32_bf16 a[164:167], v[52:55], v[124:127], a[164:167]
  v_mfma_f32_16x16x32_bf16 a[168:171], v[56:59], v[124:127], a[168:171]
  v_mfma_f32_16x16x32_bf16 a[172:175], v[60:63], v[124:127], a[172:175]
  s_waitcnt lgkmcnt(0)
  s_waitcnt vmcnt(21)
  s_barrier
  v_mfma_f32_16x16x32_bf16 a[0:3], v[80:83], v[16:19], a[0:3]
  ds_read_b64_tr_b16 v[104:105], v5 offset:40960
  s_add_u32 m0, s43, 0
  s_add_u32 s42, s38, 960
  buffer_load_dwordx4 v13, s[8:11], s42 offen lds
  v_mfma_f32_16x16x32_bf16 a[4:7], v[80:83], v[20:23], a[4:7]
  ds_read_b64_tr_b16 v[106:107], v5 offset:41984
  v_mfma_f32_16x16x32_bf16 a[8:11], v[80:83], v[24:27], a[8:11]
  ds_read_b64_tr_b16 v[108:109], v5 offset:40968
  v_mfma_f32_16x16x32_bf16 a[12:15], v[80:83], v[28:31], a[12:15]
  s_add_u32 m0, s40, 16384
  s_add_u32 s42, s39, 3932160
  buffer_load_dwordx4 v3, s[28:31], s42 offen lds
  v_mfma_f32_16x16x32_bf16 a[32:35], v[84:87], v[16:19], a[32:35]
  ds_read_b64_tr_b16 v[110:111], v5 offset:41992
  v_mfma_f32_16x16x32_bf16 a[36:39], v[84:87], v[20:23], a[36:39]
  ds_read_b128 v[48:51], v4 offset:32768
  v_mfma_f32_16x16x32_bf16 a[40:43], v[84:87], v[24:27], a[40:43]
  ds_read_b128 v[52:55], v4 offset:33024
  s_add_u32 m0, s40, 17408
  s_add_u32 s42, s39, 3964928
  buffer_load_dwordx4 v3, s[28:31], s42 offen lds
  v_mfma_f32_16x16x32_bf16 a[44:47], v[84:87], v[28:31], a[44:47]
  v_mfma_f32_16x16x32_bf16 a[64:67], v[88:91], v[16:19], a[64:67]
  ds_read_b128 v[56:59], v4 offset:34816
  v_mfma_f32_16x16x32_bf16 a[68:71], v[88:91], v[20:23], a[68:71]
  ds_read_b128 v[60:63], v4 offset:35072
  s_add_u32 m0, s40, 24576
  s_add_u32 s42, s39, 3932160
  buffer_load_dwordx4 v3, s[32:35], s42 offen lds
  v_mfma_f32_16x16x32_bf16 a[72:75], v[88:91], v[24:27], a[72:75]
  ds_read_b64_tr_b16 v[112:113], v5 offset:49152
  v_mfma_f32_16x16x32_bf16 a[76:79], v[88:91], v[28:31], a[76:79]
  v_mfma_f32_16x16x32_bf16 a[96:99], v[92:95], v[16:19], a[96:99]
  ds_read_b64_tr_b16 v[114:115], v5 offset:50176
  s_add_u32 m0, s40, 25600
  s_add_u32 s42, s39, 3964928
  buffer_load_dwordx4 v3, s[32:35], s42 offen lds
  v_mfma_f32_16x16x32_bf16 a[100:103], v[92:95], v[20:23], a[100:103]
  ds_read_b64_tr_b16 v[116:117], v5 offset:49160
  v_mfma_f32_16x16x32_bf16 a[104:107], v[92:95], v[24:27], a[104:107]
  ds_read_b64_tr_b16 v[118:119], v5 offset:50184
  v_mfma_f32_16x16x32_bf16 a[108:111], v[92:95], v[28:31], a[108:111]
  s_add_u32 m0, s40, 8192
  s_add_u32 s42, s39, 3932160
  buffer_load_dwordx4 v3, s[12:15], s42 offen lds
  v_mfma_f32_16x16x32_bf16 a[128:131], v[16:19], v[96:99], a[128:131]
  ds_read_b64_tr_b16 v[120:121], v6 offset:57344
  v_mfma_f32_16x16x32_bf16 a[132:135], v[20:23], v[96:99], a[132:135]
  ds_read_b64_tr_b16 v[122:123], v6 offset:58368
  v_mfma_f32_16x16x32_bf16 a[136:139], v[24:27], v[96:99], a[136:139]
  ds_read_b64_tr_b16 v[124:125], v6 offset:57376
  s_add_u32 m0, s40, 9216
  s_add_u32 s42, s39, 3964928
  buffer_load_dwordx4 v3, s[12:15], s42 offen lds
  v_mfma_f32_16x16x32_bf16 a[140:143], v[28:31], v[96:99], a[140:143]
  v_mfma_f32_16x16x32_bf16 a[160:163], v[16:19], v[100:103], a[160:163]
  ds_read_b64_tr_b16 v[126:127], v6 offset:58400
  v_mfma_f32_16x16x32_bf16 a[164:167], v[20:23], v[100:103], a[164:167]
  v_mfma_f32_16x16x32_bf16 a[168:171], v[24:27], v[100:103], a[168:171]
  v_mfma_f32_16x16x32_bf16 a[172:175], v[28:31], v[100:103], a[172:175]
  s_waitcnt lgkmcnt(0)
  s_waitcnt vmcnt(21)
  s_barrier
  v_mfma_f32_16x16x32_bf16 a[0:3], v[104:107], v[48:51], a[0:3]
  ds_read_b64_tr_b16 v[80:81], v8 offset:8192
  s_add_u32 m0, s43, 32768
  s_add_u32 s42, s38, 1024
  buffer_load_dwordx4 v13, s[8:11], s42 offen lds
  v_mfma_f32_16x16x32_bf16 a[4:7], v[104:107], v[52:55], a[4:7]
  ds_read_b64_tr_b16 v[82:83], v8 offset:9216
  v_mfma_f32_16x16x32_bf16 a[8:11], v[104:107], v[56:59], a[8:11]
  ds_read_b64_tr_b16 v[84:85], v8 offset:8200
  v_mfma_f32_16x16x32_bf16 a[12:15], v[104:107], v[60:63], a[12:15]
  s_add_u32 m0, s40, 49152
  s_add_u32 s42, s39, 4194304
  buffer_load_dwordx4 v3, s[28:31], s42 offen lds
  v_mfma_f32_16x16x32_bf16 a[32:35], v[108:111], v[48:51], a[32:35]
  ds_read_b64_tr_b16 v[86:87], v8 offset:9224
  v_mfma_f32_16x16x32_bf16 a[36:39], v[108:111], v[52:55], a[36:39]
  ds_read_b128 v[16:19], v7 offset:0
  v_mfma_f32_16x16x32_bf16 a[40:43], v[108:111], v[56:59], a[40:43]
  ds_read_b128 v[20:23], v7 offset:256
  s_add_u32 m0, s40, 50176
  s_add_u32 s42, s39, 4227072
  buffer_load_dwordx4 v3, s[28:31], s42 offen lds
  v_mfma_f32_16x16x32_bf16 a[44:47], v[108:111], v[60:63], a[44:47]
  v_mfma_f32_16x16x32_bf16 a[64:67], v[112:115], v[48:51], a[64:67]
  ds_read_b128 v[24:27], v7 offset:2048
  v_mfma_f32_16x16x32_bf16 a[68:71], v[112:115], v[52:55], a[68:71]
  ds_read_b128 v[28:31], v7 offset:2304
  s_add_u32 m0, s40, 57344
  s_add_u32 s42, s39, 4194304
  buffer_load_dwordx4 v3, s[32:35], s42 offen lds
  v_mfma_f32_16x16x32_bf16 a[72:75], v[112:115], v[56:59], a[72:75]
  ds_read_b64_tr_b16 v[88:89], v8 offset:16384
  v_mfma_f32_16x16x32_bf16 a[76:79], v[112:115], v[60:63], a[76:79]
  v_mfma_f32_16x16x32_bf16 a[96:99], v[116:119], v[48:51], a[96:99]
  ds_read_b64_tr_b16 v[90:91], v8 offset:17408
  s_add_u32 m0, s40, 58368
  s_add_u32 s42, s39, 4227072
  buffer_load_dwordx4 v3, s[32:35], s42 offen lds
  v_mfma_f32_16x16x32_bf16 a[100:103], v[116:119], v[52:55], a[100:103]
  ds_read_b64_tr_b16 v[92:93], v8 offset:16392
  v_mfma_f32_16x16x32_bf16 a[104:107], v[116:119], v[56:59], a[104:107]
  ds_read_b64_tr_b16 v[94:95], v8 offset:17416
  v_mfma_f32_16x16x32_bf16 a[108:111], v[116:119], v[60:63], a[108:111]
  s_add_u32 m0, s40, 40960
  s_add_u32 s42, s39, 4194304
  buffer_load_dwordx4 v3, s[12:15], s42 offen lds
  v_mfma_f32_16x16x32_bf16 a[128:131], v[48:51], v[120:123], a[128:131]
  ds_read_b64_tr_b16 v[96:97], v9 offset:24576
  v_mfma_f32_16x16x32_bf16 a[132:135], v[52:55], v[120:123], a[132:135]
  ds_read_b64_tr_b16 v[98:99], v9 offset:25600
  v_mfma_f32_16x16x32_bf16 a[136:139], v[56:59], v[120:123], a[136:139]
  ds_read_b64_tr_b16 v[100:101], v9 offset:24608
  s_add_u32 m0, s40, 41984
  s_add_u32 s42, s39, 4227072
  buffer_load_dwordx4 v3, s[12:15], s42 offen lds
  v_mfma_f32_16x16x32_bf16 a[140:143], v[60:63], v[120:123], a[140:143]
  v_mfma_f32_16x16x32_bf16 a[160:163], v[48:51], v[124:127], a[160:163]
  ds_read_b64_tr_b16 v[102:103], v9 offset:25632
  v_mfma_f32_16x16x32_bf16 a[164:167], v[52:55], v[124:127], a[164:167]
  v_mfma_f32_16x16x32_bf16 a[168:171], v[56:59], v[124:127], a[168:171]
  v_mfma_f32_16x16x32_bf16 a[172:175], v[60:63], v[124:127], a[172:175]
  s_waitcnt lgkmcnt(0)
  s_waitcnt vmcnt(21)
  s_barrier
  v_mfma_f32_16x16x32_bf16 a[0:3], v[80:83], v[16:19], a[0:3]
  ds_read_b64_tr_b16 v[104:105], v8 offset:40960
  s_add_u32 m0, s43, 65536
  s_add_u32 s42, s38, 1088
  buffer_load_dwordx4 v13, s[8:11], s42 offen lds
  v_mfma_f32_16x16x32_bf16 a[4:7], v[80:83], v[20:23], a[4:7]
  ds_read_b64_tr_b16 v[106:107], v8 offset:41984
  v_mfma_f32_16x16x32_bf16 a[8:11], v[80:83], v[24:27], a[8:11]
  ds_read_b64_tr_b16 v[108:109], v8 offset:40968
  v_mfma_f32_16x16x32_bf16 a[12:15], v[80:83], v[28:31], a[12:15]
  s_add_u32 m0, s40, 81920
  s_add_u32 s42, s39, 4456448
  buffer_load_dwordx4 v3, s[28:31], s42 offen lds
  v_mfma_f32_16x16x32_bf16 a[32:35], v[84:87], v[16:19], a[32:35]
  ds_read_b64_tr_b16 v[110:111], v8 offset:41992
  v_mfma_f32_16x16x32_bf16 a[36:39], v[84:87], v[20:23], a[36:39]
  ds_read_b128 v[48:51], v7 offset:32768
  v_mfma_f32_16x16x32_bf16 a[40:43], v[84:87], v[24:27], a[40:43]
  ds_read_b128 v[52:55], v7 offset:33024
  s_add_u32 m0, s40, 82944
  s_add_u32 s42, s39, 4489216
  buffer_load_dwordx4 v3, s[28:31], s42 offen lds
  v_mfma_f32_16x16x32_bf16 a[44:47], v[84:87], v[28:31], a[44:47]
  v_mfma_f32_16x16x32_bf16 a[64:67], v[88:91], v[16:19], a[64:67]
  ds_read_b128 v[56:59], v7 offset:34816
  v_mfma_f32_16x16x32_bf16 a[68:71], v[88:91], v[20:23], a[68:71]
  ds_read_b128 v[60:63], v7 offset:35072
  s_add_u32 m0, s40, 90112
  s_add_u32 s42, s39, 4456448
  buffer_load_dwordx4 v3, s[32:35], s42 offen lds
  v_mfma_f32_16x16x32_bf16 a[72:75], v[88:91], v[24:27], a[72:75]
  ds_read_b64_tr_b16 v[112:113], v8 offset:49152
  v_mfma_f32_16x16x32_bf16 a[76:79], v[88:91], v[28:31], a[76:79]
  v_mfma_f32_16x16x32_bf16 a[96:99], v[92:95], v[16:19], a[96:99]
  ds_read_b64_tr_b16 v[114:115], v8 offset:50176
  s_add_u32 m0, s40, 91136
  s_add_u32 s42, s39, 4489216
  buffer_load_dwordx4 v3, s[32:35], s42 offen lds
  v_mfma_f32_16x16x32_bf16 a[100:103], v[92:95], v[20:23], a[100:103]
  ds_read_b64_tr_b16 v[116:117], v8 offset:49160
  v_mfma_f32_16x16x32_bf16 a[104:107], v[92:95], v[24:27], a[104:107]
  ds_read_b64_tr_b16 v[118:119], v8 offset:50184
  v_mfma_f32_16x16x32_bf16 a[108:111], v[92:95], v[28:31], a[108:111]
  s_add_u32 m0, s40, 73728
  s_add_u32 s42, s39, 4456448
  buffer_load_dwordx4 v3, s[12:15], s42 offen lds
  v_mfma_f32_16x16x32_bf16 a[128:131], v[16:19], v[96:99], a[128:131]
  ds_read_b64_tr_b16 v[120:121], v9 offset:57344
  v_mfma_f32_16x16x32_bf16 a[132:135], v[20:23], v[96:99], a[132:135]
  ds_read_b64_tr_b16 v[122:123], v9 offset:58368
  v_mfma_f32_16x16x32_bf16 a[136:139], v[24:27], v[96:99], a[136:139]
  ds_read_b64_tr_b16 v[124:125], v9 offset:57376
  s_add_u32 m0, s40, 74752
  s_add_u32 s42, s39, 4489216
  buffer_load_dwordx4 v3, s[12:15], s42 offen lds
  v_mfma_f32_16x16x32_bf16 a[140:143], v[28:31], v[96:99], a[140:143]
  v_mfma_f32_16x16x32_bf16 a[160:163], v[16:19], v[100:103], a[160:163]
  ds_read_b64_tr_b16 v[126:127], v9 offset:58400
  v_mfma_f32_16x16x32_bf16 a[164:167], v[20:23], v[100:103], a[164:167]
  v_mfma_f32_16x16x32_bf16 a[168:171], v[24:27], v[100:103], a[168:171]
  v_mfma_f32_16x16x32_bf16 a[172:175], v[28:31], v[100:103], a[172:175]
  s_waitcnt lgkmcnt(0)
  s_waitcnt vmcnt(21)
  s_barrier
  v_mfma_f32_16x16x32_bf16 a[0:3], v[104:107], v[48:51], a[0:3]
  ds_read_b64_tr_b16 v[80:81], v11 offset:8192
  s_add_u32 m0, s43, 98304
  s_add_u32 s42, s38, 1152
  buffer_load_dwordx4 v13, s[8:11], s42 offen lds
  v_mfma_f32_16x16x32_bf16 a[4:7], v[104:107], v[52:55], a[4:7]
  ds_read_b64_tr_b16 v[82:83], v11 offset:9216
  v_mfma_f32_16x16x32_bf16 a[8:11], v[104:107], v[56:59], a[8:11]
  ds_read_b64_tr_b16 v[84:85], v11 offset:8200
  v_mfma_f32_16x16x32_bf16 a[12:15], v[104:107], v[60:63], a[12:15]
  s_add_u32 m0, s40, 114688
  s_add_u32 s42, s39, 4718592
  buffer_load_dwordx4 v3, s[28:31], s42 offen lds
  v_mfma_f32_16x16x32_bf16 a[32:35], v[108:111], v[48:51], a[32:35]
  ds_read_b64_tr_b16 v[86:87], v11 offset:9224
  v_mfma_f32_16x16x32_bf16 a[36:39], v[108:111], v[52:55], a[36:39]
  ds_read_b128 v[16:19], v10 offset:0
  v_mfma_f32_16x16x32_bf16 a[40:43], v[108:111], v[56:59], a[40:43]
  ds_read_b128 v[20:23], v10 offset:256
  s_add_u32 m0, s40, 115712
  s_add_u32 s42, s39, 4751360
  buffer_load_dwordx4 v3, s[28:31], s42 offen lds
  v_mfma_f32_16x16x32_bf16 a[44:47], v[108:111], v[60:63], a[44:47]
  v_mfma_f32_16x16x32_bf16 a[64:67], v[112:115], v[48:51], a[64:67]
  ds_read_b128 v[24:27], v10 offset:2048
  v_mfma_f32_16x16x32_bf16 a[68:71], v[112:115], v[52:55], a[68:71]
  ds_read_b128 v[28:31], v10 offset:2304
  s_add_u32 m0, s40, 122880
  s_add_u32 s42, s39, 4718592
  buffer_load_dwordx4 v3, s[32:35], s42 offen lds
  v_mfma_f32_16x16x32_bf16 a[72:75], v[112:115], v[56:59], a[72:75]
  ds_read_b64_tr_b16 v[88:89], v11 offset:16384
  v_mfma_f32_16x16x32_bf16 a[76:79], v[112:115], v[60:63], a[76:79]
  v_mfma_f32_16x16x32_bf16 a[96:99], v[116:119], v[48:51], a[96:99]
  ds_read_b64_tr_b16 v[90:91], v11 offset:17408
  s_add_u32 m0, s40, 123904
  s_add_u32 s42, s39, 4751360
  buffer_load_dwordx4 v3, s[32:35], s42 offen lds
  v_mfma_f32_16x16x32_bf16 a[100:103], v[116:119], v[52:55], a[100:103]
  ds_read_b64_tr_b16 v[92:93], v11 offset:16392
  v_mfma_f32_16x16x32_bf16 a[104:107], v[116:119], v[56:59], a[104:107]
  ds_read_b64_tr_b16 v[94:95], v11 offset:17416
  v_mfma_f32_16x16x32_bf16 a[108:111], v[116:119], v[60:63], a[108:111]
  s_add_u32 m0, s40, 106496
  s_add_u32 s42, s39, 4718592
  buffer_load_dwordx4 v3, s[12:15], s42 offen lds
  v_mfma_f32_16x16x32_bf16 a[128:131], v[48:51], v[120:123], a[128:131]
  ds_read_b64_tr_b16 v[96:97], v12 offset:24576
  v_mfma_f32_16x16x32_bf16 a[132:135], v[52:55], v[120:123], a[132:135]
  ds_read_b64_tr_b16 v[98:99], v12 offset:25600
  v_mfma_f32_16x16x32_bf16 a[136:139], v[56:59], v[120:123], a[136:139]
  ds_read_b64_tr_b16 v[100:101], v12 offset:24608
  s_add_u32 m0, s40, 107520
  s_add_u32 s42, s39, 4751360
  buffer_load_dwordx4 v3, s[12:15], s42 offen lds
  v_mfma_f32_16x16x32_bf16 a[140:143], v[60:63], v[120:123], a[140:143]
  v_mfma_f32_16x16x32_bf16 a[160:163], v[48:51], v[124:127], a[160:163]
  ds_read_b64_tr_b16 v[102:103], v12 offset:25632
  v_mfma_f32_16x16x32_bf16 a[164:167], v[52:55], v[124:127], a[164:167]
  v_mfma_f32_16x16x32_bf16 a[168:171], v[56:59], v[124:127], a[168:171]
  v_mfma_f32_16x16x32_bf16 a[172:175], v[60:63], v[124:127], a[172:175]
  s_waitcnt lgkmcnt(0)
  s_waitcnt vmcnt(21)
  s_barrier
  v_mfma_f32_16x16x32_bf16 a[0:3], v[80:83], v[16:19], a[0:3]
  ds_read_b64_tr_b16 v[104:105], v5 offset:8192
  s_add_u32 m0, s43, 131072
  s_add_u32 s42, s38, 1216
  buffer_load_dwordx4 v13, s[8:11], s42 offen lds
  v_mfma_f32_16x16x32_bf16 a[4:7], v[80:83], v[20:23], a[4:7]
  ds_read_b64_tr_b16 v[106:107], v5 offset:9216
  v_mfma_f32_16x16x32_bf16 a[8:11], v[80:83], v[24:27], a[8:11]
  ds_read_b64_tr_b16 v[108:109], v5 offset:8200
  v_mfma_f32_16x16x32_bf16 a[12:15], v[80:83], v[28:31], a[12:15]
  s_add_u32 m0, s40, 147456
  s_add_u32 s42, s39, 4980736
  buffer_load_dwordx4 v3, s[28:31], s42 offen lds
  v_mfma_f32_16x16x32_bf16 a[32:35], v[84:87], v[16:19], a[32:35]
  ds_read_b64_tr_b16 v[110:111], v5 offset:9224
  v_mfma_f32_16x16x32_bf16 a[36:39], v[84:87], v[20:23], a[36:39]
  ds_read_b128 v[48:51], v4 offset:0
  v_mfma_f32_16x16x32_bf16 a[40:43], v[84:87], v[24:27], a[40:43]
  ds_read_b128 v[52:55], v4 offset:256
  s_add_u32 m0, s40, 148480
  s_add_u32 s42, s39, 5013504
  buffer_load_dwordx4 v3, s[28:31], s42 offen lds
  v_mfma_f32_16x16x32_bf16 a[44:47], v[84:87], v[28:31], a[44:47]
  v_mfma_f32_16x16x32_bf16 a[64:67], v[88:91], v[16:19], a[64:67]
  ds_read_b128 v[56:59], v4 offset:2048
  v_mfma_f32_16x16x32_bf16 a[68:71], v[88:91], v[20:23], a[68:71]
  ds_read_b128 v[60:63], v4 offset:2304
  s_add_u32 m0, s40, 155648
  s_add_u32 s42, s39, 4980736
  buffer_load_dwordx4 v3, s[32:35], s42 offen lds
  v_mfma_f32_16x16x32_bf16 a[72:75], v[88:91], v[24:27], a[72:75]
  ds_read_b64_tr_b16 v[112:113], v5 offset:16384
  v_mfma_f32_16x16x32_bf16 a[76:79], v[88:91], v[28:31], a[76:79]
  v_mfma_f32_16x16x32_bf16 a[96:99], v[92:95], v[16:19], a[96:99]
  ds_read_b64_tr_b16 v[114:115], v5 offset:17408
  s_add_u32 m0, s40, 156672
  s_add_u32 s42, s39, 5013504
  buffer_load_dwordx4 v3, s[32:35], s42 offen lds
  v_mfma_f32_16x16x32_bf16 a[100:103], v[92:95], v[20:23], a[100:103]
  ds_read_b64_tr_b16 v[116:117], v5 offset:16392
  v_mfma_f32_16x16x32_bf16 a[104:107], v[92:95], v[24:27], a[104:107]
  ds_read_b64_tr_b16 v[118:119], v5 offset:17416
  v_mfma_f32_16x16x32_bf16 a[108:111], v[92:95], v[28:31], a[108:111]
  s_add_u32 m0, s40, 139264
  s_add_u32 s42, s39, 4980736
  buffer_load_dwordx4 v3, s[12:15], s42 offen lds
  v_mfma_f32_16x16x32_bf16 a[128:131], v[16:19], v[96:99], a[128:131]
  ds_read_b64_tr_b16 v[120:121], v6 offset:24576
  v_mfma_f32_16x16x32_bf16 a[132:135], v[20:23], v[96:99], a[132:135]
  ds_read_b64_tr_b16 v[122:123], v6 offset:25600
  v_mfma_f32_16x16x32_bf16 a[136:139], v[24:27], v[96:99], a[136:139]
  ds_read_b64_tr_b16 v[124:125], v6 offset:24608
  s_add_u32 m0, s40, 140288
  s_add_u32 s42, s39, 5013504
  buffer_load_dwordx4 v3, s[12:15], s42 offen lds
  v_mfma_f32_16x16x32_bf16 a[140:143], v[28:31], v[96:99], a[140:143]
  v_mfma_f32_16x16x32_bf16 a[160:163], v[16:19], v[100:103], a[160:163]
  ds_read_b64_tr_b16 v[126:127], v6 offset:25632
  v_mfma_f32_16x16x32_bf16 a[164:167], v[20:23], v[100:103], a[164:167]
  v_mfma_f32_16x16x32_bf16 a[168:171], v[24:27], v[100:103], a[168:171]
  v_mfma_f32_16x16x32_bf16 a[172:175], v[28:31], v[100:103], a[172:175]
  s_waitcnt lgkmcnt(0)
  s_waitcnt vmcnt(21)
  s_barrier
  v_mfma_f32_16x16x32_bf16 a[0:3], v[104:107], v[48:51], a[0:3]
  ds_read_b64_tr_b16 v[80:81], v5 offset:40960
  v_mfma_f32_16x16x32_bf16 a[4:7], v[104:107], v[52:55], a[4:7]
  ds_read_b64_tr_b16 v[82:83], v5 offset:41984
  v_mfma_f32_16x16x32_bf16 a[8:11], v[104:107], v[56:59], a[8:11]
  ds_read_b64_tr_b16 v[84:85], v5 offset:40968
  v_mfma_f32_16x16x32_bf16 a[12:15], v[104:107], v[60:63], a[12:15]
  v_mfma_f32_16x16x32_bf16 a[32:35], v[108:111], v[48:51], a[32:35]
  ds_read_b64_tr_b16 v[86:87], v5 offset:41992
  v_mfma_f32_16x16x32_bf16 a[36:39], v[108:111], v[52:55], a[36:39]
  ds_read_b128 v[16:19], v4 offset:32768
  v_mfma_f32_16x16x32_bf16 a[40:43], v[108:111], v[56:59], a[40:43]
  ds_read_b128 v[20:23], v4 offset:33024
  v_mfma_f32_16x16x32_bf16 a[44:47], v[108:111], v[60:63], a[44:47]
  v_mfma_f32_16x16x32_bf16 a[64:67], v[112:115], v[48:51], a[64:67]
  ds_read_b128 v[24:27], v4 offset:34816
  v_mfma_f32_16x16x32_bf16 a[68:71], v[112:115], v[52:55], a[68:71]
  ds_read_b128 v[28:31], v4 offset:35072
  v_mfma_f32_16x16x32_bf16 a[72:75], v[112:115], v[56:59], a[72:75]
  ds_read_b64_tr_b16 v[88:89], v5 offset:49152
  v_mfma_f32_16x16x32_bf16 a[76:79], v[112:115], v[60:63], a[76:79]
  v_mfma_f32_16x16x32_bf16 a[96:99], v[116:119], v[48:51], a[96:99]
  ds_read_b64_tr_b16 v[90:91], v5 offset:50176
  v_mfma_f32_16x16x32_bf16 a[100:103], v[116:119], v[52:55], a[100:103]
  ds_read_b64_tr_b16 v[92:93], v5 offset:49160
  v_mfma_f32_16x16x32_bf16 a[104:107], v[116:119], v[56:59], a[104:107]
  ds_read_b64_tr_b16 v[94:95], v5 offset:50184
  v_mfma_f32_16x16x32_bf16 a[108:111], v[116:119], v[60:63], a[108:111]
  v_mfma_f32_16x16x32_bf16 a[128:131], v[48:51], v[120:123], a[128:131]
  ds_read_b64_tr_b16 v[96:97], v6 offset:57344
  v_mfma_f32_16x16x32_bf16 a[132:135], v[52:55], v[120:123], a[132:135]
  ds_read_b64_tr_b16 v[98:99], v6 offset:58368
  v_mfma_f32_16x16x32_bf16 a[136:139], v[56:59], v[120:123], a[136:139]
  ds_read_b64_tr_b16 v[100:101], v6 offset:57376
  v_mfma_f32_16x16x32_bf16 a[140:143], v[60:63], v[120:123], a[140:143]
  v_mfma_f32_16x16x32_bf16 a[160:163], v[48:51], v[124:127], a[160:163]
  ds_read_b64_tr_b16 v[102:103], v6 offset:58400
  v_mfma_f32_16x16x32_bf16 a[164:167], v[52:55], v[124:127], a[164:167]
  v_mfma_f32_16x16x32_bf16 a[168:171], v[56:59], v[124:127], a[168:171]
  v_mfma_f32_16x16x32_bf16 a[172:175], v[60:63], v[124:127], a[172:175]
  s_waitcnt lgkmcnt(0)
  s_waitcnt vmcnt(14)
  s_barrier
  v_mfma_f32_16x16x32_bf16 a[0:3], v[80:83], v[16:19], a[0:3]
  ds_read_b64_tr_b16 v[104:105], v8 offset:8192
  v_mfma_f32_16x16x32_bf16 a[4:7], v[80:83], v[20:23], a[4:7]
  ds_read_b64_tr_b16 v[106:107], v8 offset:9216
  v_mfma_f32_16x16x32_bf16 a[8:11], v[80:83], v[24:27], a[8:11]
  ds_read_b64_tr_b16 v[108:109], v8 offset:8200
  v_mfma_f32_16x16x32_bf16 a[12:15], v[80:83], v[28:31], a[12:15]
  v_mfma_f32_16x16x32_bf16 a[32:35], v[84:87], v[16:19], a[32:35]
  ds_read_b64_tr_b16 v[110:111], v8 offset:9224
  v_mfma_f32_16x16x32_bf16 a[36:39], v[84:87], v[20:23], a[36:39]
  ds_read_b128 v[48:51], v7 offset:0
  v_mfma_f32_16x16x32_bf16 a[40:43], v[84:87], v[24:27], a[40:43]
  ds_read_b128 v[52:55], v7 offset:256
  v_mfma_f32_16x16x32_bf16 a[44:47], v[84:87], v[28:31], a[44:47]
  v_mfma_f32_16x16x32_bf16 a[64:67], v[88:91], v[16:19], a[64:67]
  ds_read_b128 v[56:59], v7 offset:2048
  v_mfma_f32_16x16x32_bf16 a[68:71], v[88:91], v[20:23], a[68:71]
  ds_read_b128 v[60:63], v7 offset:2304
  v_mfma_f32_16x16x32_bf16 a[72:75], v[88:91], v[24:27], a[72:75]
  ds_read_b64_tr_b16 v[112:113], v8 offset:16384
  v_mfma_f32_16x16x32_bf16 a[76:79], v[88:91], v[28:31], a[76:79]
  v_mfma_f32_16x16x32_bf16 a[96:99], v[92:95], v[16:19], a[96:99]
  ds_read_b64_tr_b16 v[114:115], v8 offset:17408
  v_mfma_f32_16x16x32_bf16 a[100:103], v[92:95], v[20:23], a[100:103]
  ds_read_b64_tr_b16 v[116:117], v8 offset:16392
  v_mfma_f32_16x16x32_bf16 a[104:107], v[92:95], v[24:27], a[104:107]
  ds_read_b64_tr_b16 v[118:119], v8 offset:17416
  v_mfma_f32_16x16x32_bf16 a[108:111], v[92:95], v[28:31], a[108:111]
  v_mfma_f32_16x16x32_bf16 a[128:131], v[16:19], v[96:99], a[128:131]
  ds_read_b64_tr_b16 v[120:121], v9 offset:24576
  v_mfma_f32_16x16x32_bf16 a[132:135], v[20:23], v[96:99], a[132:135]
  ds_read_b64_tr_b16 v[122:123], v9 offset:25600
  v_mfma_f32_16x16x32_bf16 a[136:139], v[24:27], v[96:99], a[136:139]
  ds_read_b64_tr_b16 v[124:125], v9 offset:24608
  v_mfma_f32_16x16x32_bf16 a[140:143], v[28:31], v[96:99], a[140:143]
  v_mfma_f32_16x16x32_bf16 a[160:163], v[16:19], v[100:103], a[160:163]
  ds_read_b64_tr_b16 v[126:127], v9 offset:25632
  v_mfma_f32_16x16x32_bf16 a[164:167], v[20:23], v[100:103], a[164:167]
  v_mfma_f32_16x16x32_bf16 a[168:171], v[24:27], v[100:103], a[168:171]
  v_mfma_f32_16x16x32_bf16 a[172:175], v[28:31], v[100:103], a[172:175]
  s_waitcnt lgkmcnt(0)
  s_waitcnt vmcnt(7)
  s_barrier
  v_mfma_f32_16x16x32_bf16 a[0:3], v[104:107], v[48:51], a[0:3]
  ds_read_b64_tr_b16 v[80:81], v8 offset:40960
  v_mfma_f32_16x16x32_bf16 a[4:7], v[104:107], v[52:55], a[4:7]
  ds_read_b64_tr_b16 v[82:83], v8 offset:41984
  v_mfma_f32_16x16x32_bf16 a[8:11], v[104:107], v[56:59], a[8:11]
  ds_read_b64_tr_b16 v[84:85], v8 offset:40968
  v_mfma_f32_16x16x32_bf16 a[12:15], v[104:107], v[60:63], a[12:15]
  v_mfma_f32_16x16x32_bf16 a[32:35], v[108:111], v[48:51], a[32:35]
  ds_read_b64_tr_b16 v[86:87], v8 offset:41992
  v_mfma_f32_16x16x32_bf16 a[36:39], v[108:111], v[52:55], a[36:39]
  ds_read_b128 v[16:19], v7 offset:32768
  v_mfma_f32_16x16x32_bf16 a[40:43], v[108:111], v[56:59], a[40:43]
  ds_read_b128 v[20:23], v7 offset:33024
  v_mfma_f32_16x16x32_bf16 a[44:47], v[108:111], v[60:63], a[44:47]
  v_mfma_f32_16x16x32_bf16 a[64:67], v[112:115], v[48:51], a[64:67]
  ds_read_b128 v[24:27], v7 offset:34816
  v_mfma_f32_16x16x32_bf16 a[68:71], v[112:115], v[52:55], a[68:71]
  ds_read_b128 v[28:31], v7 offset:35072
  v_mfma_f32_16x16x32_bf16 a[72:75], v[112:115], v[56:59], a[72:75]
  ds_read_b64_tr_b16 v[88:89], v8 offset:49152
  v_mfma_f32_16x16x32_bf16 a[76:79], v[112:115], v[60:63], a[76:79]
  v_mfma_f32_16x16x32_bf16 a[96:99], v[116:119], v[48:51], a[96:99]
  ds_read_b64_tr_b16 v[90:91], v8 offset:50176
  v_mfma_f32_16x16x32_bf16 a[100:103], v[116:119], v[52:55], a[100:103]
  ds_read_b64_tr_b16 v[92:93], v8 offset:49160
  v_mfma_f32_16x16x32_bf16 a[104:107], v[116:119], v[56:59], a[104:107]
  ds_read_b64_tr_b16 v[94:95], v8 offset:50184
  v_mfma_f32_16x16x32_bf16 a[108:111], v[116:119], v[60:63], a[108:111]
  v_mfma_f32_16x16x32_bf16 a[128:131], v[48:51], v[120:123], a[128:131]
  ds_read_b64_tr_b16 v[96:97], v9 offset:57344
  v_mfma_f32_16x16x32_bf16 a[132:135], v[52:55], v[120:123], a[132:135]
  ds_read_b64_tr_b16 v[98:99], v9 offset:58368
  v_mfma_f32_16x16x32_bf16 a[136:139], v[56:59], v[120:123], a[136:139]
  ds_read_b64_tr_b16 v[100:101], v9 offset:57376
  v_mfma_f32_16x16x32_bf16 a[140:143], v[60:63], v[120:123], a[140:143]
  v_mfma_f32_16x16x32_bf16 a[160:163], v[48:51], v[124:127], a[160:163]
  ds_read_b64_tr_b16 v[102:103], v9 offset:58400
  v_mfma_f32_16x16x32_bf16 a[164:167], v[52:55], v[124:127], a[164:167]
  v_mfma_f32_16x16x32_bf16 a[168:171], v[56:59], v[124:127], a[168:171]
  v_mfma_f32_16x16x32_bf16 a[172:175], v[60:63], v[124:127], a[172:175]
  s_waitcnt lgkmcnt(0)
  s_waitcnt vmcnt(0)
  s_barrier
  v_mfma_f32_16x16x32_bf16 a[0:3], v[80:83], v[16:19], a[0:3]
  ds_read_b64_tr_b16 v[104:105], v11 offset:8192
  v_mfma_f32_16x16x32_bf16 a[4:7], v[80:83], v[20:23], a[4:7]
  ds_read_b64_tr_b16 v[106:107], v11 offset:9216
  v_mfma_f32_16x16x32_bf16 a[8:11], v[80:83], v[24:27], a[8:11]
  ds_read_b64_tr_b16 v[108:109], v11 offset:8200
  v_mfma_f32_16x16x32_bf16 a[12:15], v[80:83], v[28:31], a[12:15]
  v_mfma_f32_16x16x32_bf16 a[32:35], v[84:87], v[16:19], a[32:35]
  ds_read_b64_tr_b16 v[110:111], v11 offset:9224
  v_mfma_f32_16x16x32_bf16 a[36:39], v[84:87], v[20:23], a[36:39]
  ds_read_b128 v[48:51], v10 offset:0
  v_mfma_f32_16x16x32_bf16 a[40:43], v[84:87], v[24:27], a[40:43]
  ds_read_b128 v[52:55], v10 offset:256
  v_mfma_f32_16x16x32_bf16 a[44:47], v[84:87], v[28:31], a[44:47]
  v_mfma_f32_16x16x32_bf16 a[64:67], v[88:91], v[16:19], a[64:67]
  ds_read_b128 v[56:59], v10 offset:2048
  v_mfma_f32_16x16x32_bf16 a[68:71], v[88:91], v[20:23], a[68:71]
  ds_read_b128 v[60:63], v10 offset:2304
  v_mfma_f32_16x16x32_bf16 a[72:75], v[88:91], v[24:27], a[72:75]
  ds_read_b64_tr_b16 v[112:113], v11 offset:16384
  v_mfma_f32_16x16x32_bf16 a[76:79], v[88:91], v[28:31], a[76:79]
  v_mfma_f32_16x16x32_bf16 a[96:99], v[92:95], v[16:19], a[96:99]
  ds_read_b64_tr_b16 v[114:115], v11 offset:17408
  v_mfma_f32_16x16x32_bf16 a[100:103], v[92:95], v[20:23], a[100:103]
  ds_read_b64_tr_b16 v[116:117], v11 offset:16392
  v_mfma_f32_16x16x32_bf16 a[104:107], v[92:95], v[24:27], a[104:107]
  ds_read_b64_tr_b16 v[118:119], v11 offset:17416
  v_mfma_f32_16x16x32_bf16 a[108:111], v[92:95], v[28:31], a[108:111]
  v_mfma_f32_16x16x32_bf16 a[128:131], v[16:19], v[96:99], a[128:131]
  ds_read_b64_tr_b16 v[120:121], v12 offset:24576
  v_mfma_f32_16x16x32_bf16 a[132:135], v[20:23], v[96:99], a[132:135]
  ds_read_b64_tr_b16 v[122:123], v12 offset:25600
  v_mfma_f32_16x16x32_bf16 a[136:139], v[24:27], v[96:99], a[136:139]
  ds_read_b64_tr_b16 v[124:125], v12 offset:24608
  v_mfma_f32_16x16x32_bf16 a[140:143], v[28:31], v[96:99], a[140:143]
  v_mfma_f32_16x16x32_bf16 a[160:163], v[16:19], v[100:103], a[160:163]
  ds_read_b64_tr_b16 v[126:127], v12 offset:25632
  v_mfma_f32_16x16x32_bf16 a[164:167], v[20:23], v[100:103], a[164:167]
  v_mfma_f32_16x16x32_bf16 a[168:171], v[24:27], v[100:103], a[168:171]
  v_mfma_f32_16x16x32_bf16 a[172:175], v[28:31], v[100:103], a[172:175]
  s_waitcnt lgkmcnt(0)
  s_barrier
  v_mfma_f32_16x16x32_bf16 a[0:3], v[104:107], v[48:51], a[0:3]
  v_mfma_f32_16x16x32_bf16 a[4:7], v[104:107], v[52:55], a[4:7]
  v_mfma_f32_16x16x32_bf16 a[8:11], v[104:107], v[56:59], a[8:11]
  v_mfma_f32_16x16x32_bf16 a[12:15], v[104:107], v[60:63], a[12:15]
  v_mfma_f32_16x16x32_bf16 a[32:35], v[108:111], v[48:51], a[32:35]
  v_mfma_f32_16x16x32_bf16 a[36:39], v[108:111], v[52:55], a[36:39]
  v_mfma_f32_16x16x32_bf16 a[40:43], v[108:111], v[56:59], a[40:43]
  v_mfma_f32_16x16x32_bf16 a[44:47], v[108:111], v[60:63], a[44:47]
  v_mfma_f32_16x16x32_bf16 a[64:67], v[112:115], v[48:51], a[64:67]
  v_mfma_f32_16x16x32_bf16 a[68:71], v[112:115], v[52:55], a[68:71]
  v_mfma_f32_16x16x32_bf16 a[72:75], v[112:115], v[56:59], a[72:75]
  v_mfma_f32_16x16x32_bf16 a[76:79], v[112:115], v[60:63], a[76:79]
  v_mfma_f32_16x16x32_bf16 a[96:99], v[116:119], v[48:51], a[96:99]
  v_mfma_f32_16x16x32_bf16 a[100:103], v[116:119], v[52:55], a[100:103]
  v_mfma_f32_16x16x32_bf16 a[104:107], v[116:119], v[56:59], a[104:107]
  v_mfma_f32_16x16x32_bf16 a[108:111], v[116:119], v[60:63], a[108:111]
  v_mfma_f32_16x16x32_bf16 a[128:131], v[48:51], v[120:123], a[128:131]
  v_mfma_f32_16x16x32_bf16 a[132:135], v[52:55], v[120:123], a[132:135]
  v_mfma_f32_16x16x32_bf16 a[136:139], v[56:59], v[120:123], a[136:139]
  v_mfma_f32_16x16x32_bf16 a[140:143], v[60:63], v[120:123], a[140:143]
  v_mfma_f32_16x16x32_bf16 a[160:163], v[48:51], v[124:127], a[160:163]
  v_mfma_f32_16x16x32_bf16 a[164:167], v[52:55], v[124:127], a[164:167]
  v_mfma_f32_16x16x32_bf16 a[168:171], v[56:59], v[124:127], a[168:171]
  v_mfma_f32_16x16x32_bf16 a[172:175], v[60:63], v[124:127], a[172:175]
  s_lshl_b32 s41, s36, 5
  s_add_u32 s41, s41, s37
  s_lshl_b32 s41, s41, 13
  s_lshl_b32 s23, s20, 11
  s_add_u32 s41, s41, s23
  s_add_u32 s42, s41, 0x0
  v_accvgpr_read_b32 v20, a64
  v_accvgpr_read_b32 v21, a65
  v_accvgpr_read_b32 v22, a66
  v_accvgpr_read_b32 v23, a67
  v_accvgpr_read_b32 v24, a96
  v_accvgpr_read_b32 v25, a97
  v_accvgpr_read_b32 v26, a98
  v_accvgpr_read_b32 v27, a99
  v_cvt_pk_bf16_f32 v16, v20, v21
  v_cvt_pk_bf16_f32 v17, v22, v23
  v_cvt_pk_bf16_f32 v18, v24, v25
  v_cvt_pk_bf16_f32 v19, v26, v27
  buffer_store_dwordx4 v[16:19], v0, s[4:7], s42 offen offset:0 sc1
  v_accvgpr_read_b32 v32, a68
  v_accvgpr_read_b32 v33, a69
  v_accvgpr_read_b32 v34, a70
  v_accvgpr_read_b32 v35, a71
  v_accvgpr_read_b32 v36, a100
  v_accvgpr_read_b32 v37, a101
  v_accvgpr_read_b32 v38, a102
  v_accvgpr_read_b32 v39, a103
  v_cvt_pk_bf16_f32 v28, v32, v33
  v_cvt_pk_bf16_f32 v29, v34, v35
  v_cvt_pk_bf16_f32 v30, v36, v37
  v_cvt_pk_bf16_f32 v31, v38, v39
  buffer_store_dwordx4 v[28:31], v0, s[4:7], s42 offen offset:1024 sc1
  s_add_u32 s42, s41, 0x40000
  v_accvgpr_read_b32 v44, a72
  v_accvgpr_read_b32 v45, a73
  v_accvgpr_read_b32 v46, a74
  v_accvgpr_read_b32 v47, a75
  v_accvgpr_read_b32 v48, a104
  v_accvgpr_read_b32 v49, a105
  v_accvgpr_read_b32 v50, a106
  v_accvgpr_read_b32 v51, a107
  v_cvt_pk_bf16_f32 v40, v44, v45
  v_cvt_pk_bf16_f32 v41, v46, v47
  v_cvt_pk_bf16_f32 v42, v48, v49
  v_cvt_pk_bf16_f32 v43, v50, v51
  buffer_store_dwordx4 v[40:43], v0, s[4:7], s42 offen offset:0 sc1
  v_accvgpr_read_b32 v56, a76
  v_accvgpr_read_b32 v57, a77
  v_accvgpr_read_b32 v58, a78
  v_accvgpr_read_b32 v59, a79
  v_accvgpr_read_b32 v60, a108
  v_accvgpr_read_b32 v61, a109
  v_accvgpr_read_b32 v62, a110
  v_accvgpr_read_b32 v63, a111
  v_cvt_pk_bf16_f32 v52, v56, v57
  v_cvt_pk_bf16_f32 v53, v58, v59
  v_cvt_pk_bf16_f32 v54, v60, v61
  v_cvt_pk_bf16_f32 v55, v62, v63
  buffer_store_dwordx4 v[52:55], v0, s[4:7], s42 offen offset:1024 sc1
  s_add_u32 s42, s41, 0x2000000
  v_accvgpr_read_b32 v20, a0
  v_accvgpr_read_b32 v21, a1
  v_accvgpr_read_b32 v22, a2
  v_accvgpr_read_b32 v23, a3
  v_accvgpr_read_b32 v24, a32
  v_accvgpr_read_b32 v25, a33
  v_accvgpr_read_b32 v26, a34
  v_accvgpr_read_b32 v27, a35
  v_cvt_pk_bf16_f32 v16, v20, v21
  v_cvt_pk_bf16_f32 v17, v22, v23
  v_cvt_pk_bf16_f32 v18, v24, v25
  v_cvt_pk_bf16_f32 v19, v26, v27
  buffer_store_dwordx4 v[16:19], v0, s[4:7], s42 offen offset:0 sc1
  v_accvgpr_read_b32 v32, a4
  v_accvgpr_read_b32 v33, a5
  v_accvgpr_read_b32 v34, a6
  v_accvgpr_read_b32 v35, a7
  v_accvgpr_read_b32 v36, a36
  v_accvgpr_read_b32 v37, a37
  v_accvgpr_read_b32 v38, a38
  v_accvgpr_read_b32 v39, a39
  v_cvt_pk_bf16_f32 v28, v32, v33
  v_cvt_pk_bf16_f32 v29, v34, v35
  v_cvt_pk_bf16_f32 v30, v36, v37
  v_cvt_pk_bf16_f32 v31, v38, v39
  buffer_store_dwordx4 v[28:31], v0, s[4:7], s42 offen offset:1024 sc1
  s_add_u32 s42, s41, 0x2040000
  v_accvgpr_read_b32 v44, a8
  v_accvgpr_read_b32 v45, a9
  v_accvgpr_read_b32 v46, a10
  v_accvgpr_read_b32 v47, a11
  v_accvgpr_read_b32 v48, a40
  v_accvgpr_read_b32 v49, a41
  v_accvgpr_read_b32 v50, a42
  v_accvgpr_read_b32 v51, a43
  v_cvt_pk_bf16_f32 v40, v44, v45
  v_cvt_pk_bf16_f32 v41, v46, v47
  v_cvt_pk_bf16_f32 v42, v48, v49
  v_cvt_pk_bf16_f32 v43, v50, v51
  buffer_store_dwordx4 v[40:43], v0, s[4:7], s42 offen offset:0 sc1
  v_accvgpr_read_b32 v56, a12
  v_accvgpr_read_b32 v57, a13
  v_accvgpr_read_b32 v58, a14
  v_accvgpr_read_b32 v59, a15
  v_accvgpr_read_b32 v60, a44
  v_accvgpr_read_b32 v61, a45
  v_accvgpr_read_b32 v62, a46
  v_accvgpr_read_b32 v63, a47
  v_cvt_pk_bf16_f32 v52, v56, v57
  v_cvt_pk_bf16_f32 v53, v58, v59
  v_cvt_pk_bf16_f32 v54, v60, v61
  v_cvt_pk_bf16_f32 v55, v62, v63
  buffer_store_dwordx4 v[52:55], v0, s[4:7], s42 offen offset:1024 sc1
  s_add_u32 s42, s41, 0x1000000
  v_accvgpr_read_b32 v20, a128
  v_accvgpr_read_b32 v21, a129
  v_accvgpr_read_b32 v22, a130
  v_accvgpr_read_b32 v23, a131
  v_accvgpr_read_b32 v24, a132
  v_accvgpr_read_b32 v25, a133
  v_accvgpr_read_b32 v26, a134
  v_accvgpr_read_b32 v27, a135
  v_cvt_pk_bf16_f32 v16, v20, v21
  v_cvt_pk_bf16_f32 v17, v22, v23
  v_cvt_pk_bf16_f32 v18, v24, v25
  v_cvt_pk_bf16_f32 v19, v26, v27
  buffer_store_dwordx4 v[16:19], v0, s[4:7], s42 offen offset:0 sc1
  v_accvgpr_read_b32 v32, a160
  v_accvgpr_read_b32 v33, a161
  v_accvgpr_read_b32 v34, a162
  v_accvgpr_read_b32 v35, a163
  v_accvgpr_read_b32 v36, a164
  v_accvgpr_read_b32 v37, a165
  v_accvgpr_read_b32 v38, a166
  v_accvgpr_read_b32 v39, a167
  v_cvt_pk_bf16_f32 v28, v32, v33
  v_cvt_pk_bf16_f32 v29, v34, v35
  v_cvt_pk_bf16_f32 v30, v36, v37
  v_cvt_pk_bf16_f32 v31, v38, v39
  buffer_store_dwordx4 v[28:31], v0, s[4:7], s42 offen offset:1024 sc1
  s_add_u32 s42, s41, 0x1040000
  v_accvgpr_read_b32 v44, a136
  v_accvgpr_read_b32 v45, a137
  v_accvgpr_read_b32 v46, a138
  v_accvgpr_read_b32 v47, a139
  v_accvgpr_read_b32 v48, a140
  v_accvgpr_read_b32 v49, a141
  v_accvgpr_read_b32 v50, a142
  v_accvgpr_read_b32 v51, a143
  v_cvt_pk_bf16_f32 v40, v44, v45
  v_cvt_pk_bf16_f32 v41, v46, v47
  v_cvt_pk_bf16_f32 v42, v48, v49
  v_cvt_pk_bf16_f32 v43, v50, v51
  buffer_store_dwordx4 v[40:43], v0, s[4:7], s42 offen offset:0 sc1
  v_accvgpr_read_b32 v56, a168
  v_accvgpr_read_b32 v57, a169
  v_accvgpr_read_b32 v58, a170
  v_accvgpr_read_b32 v59, a171
  v_accvgpr_read_b32 v60, a172
  v_accvgpr_read_b32 v61, a173
  v_accvgpr_read_b32 v62, a174
  v_accvgpr_read_b32 v63, a175
  v_cvt_pk_bf16_f32 v52, v56, v57
  v_cvt_pk_bf16_f32 v53, v58, v59
  v_cvt_pk_bf16_f32 v54, v60, v61
  v_cvt_pk_bf16_f32 v55, v62, v63
  buffer_store_dwordx4 v[52:55], v0, s[4:7], s42 offen offset:1024 sc1
  s_waitcnt vmcnt(0)
  s_barrier
  s_branch L_tdone
L_t1:
  s_mov_b32 s36, s76
  s_mul_i32 s38, s36, 40960
  s_and_b32 s43, s20, 1
  s_mul_i32 s23, s43, 20480
  s_lshl_b32 s43, s43, 10
  s_add_u32 s38, s38, s23
  s_lshl_b32 s39, s37, 8
  s_lshl_b32 s23, s20, 16
  s_add_u32 s39, s39, s23
  s_lshl_b32 s40, s20, 11
  s_add_u32 m0, s43, 0
  s_add_u32 s42, s38, 0
  buffer_load_dwordx4 v13, s[8:11], s42 offen lds
  s_add_u32 m0, s40, 16384
  s_add_u32 s42, s39, 0
  buffer_load_dwordx4 v3, s[28:31], s42 offen lds
  s_add_u32 m0, s40, 17408
  s_add_u32 s42, s39, 32768
  buffer_load_dwordx4 v3, s[28:31], s42 offen lds
  s_add_u32 m0, s40, 24576
  s_add_u32 s42, s39, 0
  buffer_load_dwordx4 v3, s[32:35], s42 offen lds
  s_add_u32 m0, s40, 25600
  s_add_u32 s42, s39, 32768
  buffer_load_dwordx4 v3, s[32:35], s42 offen lds
  s_add_u32 m0, s40, 8192
  s_add_u32 s42, s39, 0
  buffer_load_dwordx4 v3, s[12:15], s42 offen lds
  s_add_u32 m0, s40, 9216
  s_add_u32 s42, s39, 32768
  buffer_load_dwordx4 v3, s[12:15], s42 offen lds
  s_add_u32 m0, s43, 32768
  s_add_u32 s42, s38, 64
  buffer_load_dwordx4 v13, s[8:11], s42 offen lds
  s_add_u32 m0, s40, 49152
  s_add_u32 s42, s39, 262144
  buffer_load_dwordx4 v3, s[28:31], s42 offen lds
  s_add_u32 m0, s40, 50176
  s_add_u32 s42, s39, 294912
  buffer_load_dwordx4 v3, s[28:31], s42 offen lds
  s_add_u32 m0, s40, 57344
  s_add_u32 s42, s39, 262144
  buffer_load_dwordx4 v3, s[32:35], s42 offen lds
  s_add_u32 m0, s40, 58368
  s_add_u32 s42, s39, 294912
  buffer_load_dwordx4 v3, s[32:35], s42 offen lds
  s_add_u32 m0, s40, 40960
  s_add_u32 s42, s39, 262144
  buffer_load_dwordx4 v3, s[12:15], s42 offen lds
  s_add_u32 m0, s40, 41984
  s_add_u32 s42, s39, 294912
  buffer_load_dwordx4 v3, s[12:15], s42 offen lds
  s_add_u32 m0, s43, 65536
  s_add_u32 s42, s38, 128
  buffer_load_dwordx4 v13, s[8:11], s42 offen lds
  s_add_u32 m0, s40, 81920
  s_add_u32 s42, s39, 524288
  buffer_load_dwordx4 v3, s[28:31], s42 offen lds
  s_add_u32 m0, s40, 82944
  s_add_u32 s42, s39, 557056
  buffer_load_dwordx4 v3, s[28:31], s42 offen lds
  s_add_u32 m0, s40, 90112
  s_add_u32 s42, s39, 524288
  buffer_load_dwordx4 v3, s[32:35], s42 offen lds
  s_add_u32 m0, s40, 91136
  s_add_u32 s42, s39, 557056
  buffer_load_dwordx4 v3, s[32:35], s42 offen lds
  s_add_u32 m0, s40, 73728
  s_add_u32 s42, s39, 524288
  buffer_load_dwordx4 v3, s[12:15], s42 offen lds
  s_add_u32 m0, s40, 74752
  s_add_u32 s42, s39, 557056
  buffer_load_dwordx4 v3, s[12:15], s42 offen lds
  s_add_u32 m0, s43, 98304
  s_add_u32 s42, s38, 192
  buffer_load_dwordx4 v13, s[8:11], s42 offen lds
  s_add_u32 m0, s40, 114688
  s_add_u32 s42, s39, 786432
  buffer_load_dwordx4 v3, s[28:31], s42 offen lds
  s_add_u32 m0, s40, 115712
  s_add_u32 s42, s39, 819200
  buffer_load_dwordx4 v3, s[28:31], s42 offen lds
  s_add_u32 m0, s40, 122880
  s_add_u32 s42, s39, 786432
  buffer_load_dwordx4 v3, s[32:35], s42 offen lds
  s_add_u32 m0, s40, 123904
  s_add_u32 s42, s39, 819200
  buffer_load_dwordx4 v3, s[32:35], s42 offen lds
  s_add_u32 m0, s40, 106496
  s_add_u32 s42, s39, 786432
  buffer_load_dwordx4 v3, s[12:15], s42 offen lds
  s_add_u32 m0, s40, 107520
  s_add_u32 s42, s39, 819200
  buffer_load_dwordx4 v3, s[12:15], s42 offen lds
  s_add_u32 m0, s43, 131072
  s_add_u32 s42, s38, 256
  buffer_load_dwordx4 v13, s[8:11], s42 offen lds
  s_add_u32 m0, s40, 147456
  s_add_u32 s42, s39, 1048576
  buffer_load_dwordx4 v3, s[28:31], s42 offen lds
  s_add_u32 m0, s40, 148480
  s_add_u32 s42, s39, 1081344
  buffer_load_dwordx4 v3, s[28:31], s42 offen lds
  s_add_u32 m0, s40, 155648
  s_add_u32 s42, s39, 1048576
  buffer_load_dwordx4 v3, s[32:35], s42 offen lds
  s_add_u32 m0, s40, 156672
  s_add_u32 s42, s39, 1081344
  buffer_load_dwordx4 v3, s[32:35], s42 offen lds
  s_add_u32 m0, s40, 139264
  s_add_u32 s42, s39, 1048576
  buffer_load_dwordx4 v3, s[12:15], s42 offen lds
  s_add_u32 m0, s40, 140288
  s_add_u32 s42, s39, 1081344
  buffer_load_dwordx4 v3, s[12:15], s42 offen lds
  v_accvgpr_write_b32 a0, 0
  v_accvgpr_write_b32 a1, 0
  v_accvgpr_write_b32 a2, 0
  v_accvgpr_write_b32 a3, 0
  v_accvgpr_write_b32 a4, 0
  v_accvgpr_write_b32 a5, 0
  v_accvgpr_write_b32 a6, 0
  v_accvgpr_write_b32 a7, 0
  v_accvgpr_write_b32 a32, 0
  v_accvgpr_write_b32 a33, 0
  v_accvgpr_write_b32 a34, 0
  v_accvgpr_write_b32 a35, 0
  v_accvgpr_write_b32 a36, 0
  v_accvgpr_write_b32 a37, 0
  v_accvgpr_write_b32 a38, 0
  v_accvgpr_write_b32 a39, 0
  v_accvgpr_write_b32 a64, 0
  v_accvgpr_write_b32 a65, 0
  v_accvgpr_write_b32 a66, 0
  v_accvgpr_write_b32 a67, 0
  v_accvgpr_write_b32 a68, 0
  v_accvgpr_write_b32 a69, 0
  v_accvgpr_write_b32 a70, 0
  v_accvgpr_write_b32 a71, 0
  v_accvgpr_write_b32 a96, 0
  v_accvgpr_write_b32 a97, 0
  v_accvgpr_write_b32 a98, 0
  v_accvgpr_write_b32 a99, 0
  v_accvgpr_write_b32 a100, 0
  v_accvgpr_write_b32 a101, 0
  v_accvgpr_write_b32 a102, 0
  v_accvgpr_write_b32 a103, 0
  v_accvgpr_write_b32 a128, 0
  v_accvgpr_write_b32 a129, 0
  v_accvgpr_write_b32 a130, 0
  v_accvgpr_write_b32 a131, 0
  v_accvgpr_write_b32 a132, 0
  v_accvgpr_write_b32 a133, 0
  v_accvgpr_write_b32 a134, 0
  v_accvgpr_write_b32 a135, 0
  v_accvgpr_write_b32 a160, 0
  v_accvgpr_write_b32 a161, 0
  v_accvgpr_write_b32 a162, 0
  v_accvgpr_write_b32 a163, 0
  v_accvgpr_write_b32 a164, 0
  v_accvgpr_write_b32 a165, 0
  v_accvgpr_write_b32 a166, 0
  v_accvgpr_write_b32 a167, 0
  s_waitcnt vmcnt(28)
  s_barrier
  ds_read_b64_tr_b16 v[80:81], v5 offset:8192
  ds_read_b64_tr_b16 v[82:83], v5 offset:9216
  ds_read_b64_tr_b16 v[84:85], v5 offset:8200
  ds_read_b64_tr_b16 v[86:87], v5 offset:9224
  ds_read_b128 v[16:19], v4 offset:0
  ds_read_b128 v[20:23], v4 offset:256
  ds_read_b64_tr_b16 v[88:89], v5 offset:16384
  ds_read_b64_tr_b16 v[90:91], v5 offset:17408
  ds_read_b64_tr_b16 v[92:93], v5 offset:16392
  ds_read_b64_tr_b16 v[94:95], v5 offset:17416
  ds_read_b64_tr_b16 v[96:97], v6 offset:24576
  ds_read_b64_tr_b16 v[98:99], v6 offset:25600
  ds_read_b64_tr_b16 v[100:101], v6 offset:24608
  ds_read_b64_tr_b16 v[102:103], v6 offset:25632
  s_waitcnt lgkmcnt(0)
  s_waitcnt vmcnt(21)
  s_barrier
  v_mfma_f32_16x16x32_bf16 a[0:3], v[80:83], v[16:19], a[0:3]
  ds_read_b64_tr_b16 v[104:105], v5 offset:40960
  ds_read_b64_tr_b16 v[106:107], v5 offset:41984
  s_add_u32 m0, s43, 0
  s_add_u32 s42, s38, 320
  buffer_load_dwordx4 v13, s[8:11], s42 offen lds
  v_mfma_f32_16x16x32_bf16 a[4:7], v[80:83], v[20:23], a[4:7]
  ds_read_b64_tr_b16 v[108:109], v5 offset:40968
  ds_read_b64_tr_b16 v[110:111], v5 offset:41992
  s_add_u32 m0, s40, 16384
  s_add_u32 s42, s39, 1310720
  buffer_load_dwordx4 v3, s[28:31], s42 offen lds
  v_mfma_f32_16x16x32_bf16 a[32:35], v[84:87], v[16:19], a[32:35]
  ds_read_b128 v[48:51], v4 offset:32768
  ds_read_b128 v[52:55], v4 offset:33024
  v_mfma_f32_16x16x32_bf16 a[36:39], v[84:87], v[20:23], a[36:39]
  ds_read_b64_tr_b16 v[112:113], v5 offset:49152
  ds_read_b64_tr_b16 v[114:115], v5 offset:50176
  s_add_u32 m0, s40, 17408
  s_add_u32 s42, s39, 1343488
  buffer_load_dwordx4 v3, s[28:31], s42 offen lds
  v_mfma_f32_16x16x32_bf16 a[64:67], v[88:91], v[16:19], a[64:67]
  ds_read_b64_tr_b16 v[116:117], v5 offset:49160
  s_add_u32 m0, s40, 24576
  s_add_u32 s42, s39, 1310720
  buffer_load_dwordx4 v3, s[32:35], s42 offen lds
  v_mfma_f32_16x16x32_bf16 a[68:71], v[88:91], v[20:23], a[68:71]
  ds_read_b64_tr_b16 v[118:119], v5 offset:50184
  v_mfma_f32_16x16x32_bf16 a[96:99], v[92:95], v[16:19], a[96:99]
  ds_read_b64_tr_b16 v[120:121], v6 offset:57344
  s_add_u32 m0, s40, 25600
  s_add_u32 s42, s39, 1343488
  buffer_load_dwordx4 v3, s[32:35], s42 offen lds
  v_mfma_f32_16x16x32_bf16 a[100:103], v[92:95], v[20:23], a[100:103]
  ds_read_b64_tr_b16 v[122:123], v6 offset:58368
  s_add_u32 m0, s40, 8192
  s_add_u32 s42, s39, 1310720
  buffer_load_dwordx4 v3, s[12:15], s42 offen lds
  v_mfma_f32_16x16x32_bf16 a[128:131], v[16:19], v[96:99], a[128:131]
  ds_read_b64_tr_b16 v[124:125], v6 offset:57376
  v_mfma_f32_16x16x32_bf16 a[132:135], v[20:23], v[96:99], a[132:135]
  ds_read_b64_tr_b16 v[126:127], v6 offset:58400
  s_add_u32 m0, s40, 9216
  s_add_u32 s42, s39, 1343488
  buffer_load_dwordx4 v3, s[12:15], s42 offen lds
  v_mfma_f32_16x16x32_bf16 a[160:163], v[16:19], v[100:103], a[160:163]
  v_mfma_f32_16x16x32_bf16 a[164:167], v[20:23], v[100:103], a[164:167]
  s_waitcnt lgkmcnt(0)
  s_waitcnt vmcnt(21)
  s_barrier
  v_mfma_f32_16x16x32_bf16 a[0:3], v[104:107], v[48:51], a[0:3]
  ds_read_b64_tr_b16 v[80:81], v8 offset:8192
  ds_read_b64_tr_b16 v[82:83], v8 offset:9216
  s_add_u32 m0, s43, 32768
  s_add_u32 s42, s38, 384
  buffer_load_dwordx4 v13, s[8:11], s42 offen lds
  v_mfma_f32_16x16x32_bf16 a[4:7], v[104:107], v[52:55], a[4:7]
  ds_read_b64_tr_b16 v[84:85], v8 offset:8200
  ds_read_b64_tr_b16 v[86:87], v8 offset:9224
  s_add_u32 m0, s40, 49152
  s_add_u32 s42, s39, 1572864
  buffer_load_dwordx4 v3, s[28:31], s42 offen lds
  v_mfma_f32_16x16x32_bf16 a[32:35], v[108:111], v[48:51], a[32:35]
  ds_read_b128 v[16:19], v7 offset:0
  ds_read_b128 v[20:23], v7 offset:256
  v_mfma_f32_16x16x32_bf16 a[36:39], v[108:111], v[52:55], a[36:39]
  ds_read_b64_tr_b16 v[88:89], v8 offset:16384
  ds_read_b64_tr_b16 v[90:91], v8 offset:17408
  s_add_u32 m0, s40, 50176
  s_add_u32 s42, s39, 1605632
  buffer_load_dwordx4 v3, s[28:31], s42 offen lds
  v_mfma_f32_16x16x32_bf16 a[64:67], v[112:115], v[48:51], a[64:67]
  ds_read_b64_tr_b16 v[92:93], v8 offset:16392
  s_add_u32 m0, s40, 57344
  s_add_u32 s42, s39, 1572864
  buffer_load_dwordx4 v3, s[32:35], s42 offen lds
  v_mfma_f32_16x16x32_bf16 a[68:71], v[112:115], v[52:55], a[68:71]
  ds_read_b64_tr_b16 v[94:95], v8 offset:17416
  v_mfma_f32_16x16x32_bf16 a[96:99], v[116:119], v[48:51], a[96:99]
  ds_read_b64_tr_b16 v[96:97], v9 offset:24576
  s_add_u32 m0, s40, 58368
  s_add_u32 s42, s39, 1605632
  buffer_load_dwordx4 v3, s[32:35], s42 offen lds
  v_mfma_f32_16x16x32_bf16 a[100:103], v[116:119], v[52:55], a[100:103]
  ds_read_b64_tr_b16 v[98:99], v9 offset:25600
  s_add_u32 m0, s40, 40960
  s_add_u32 s42, s39, 1572864
  buffer_load_dwordx4 v3, s[12:15], s42 offen lds
  v_mfma_f32_16x16x32_bf16 a[128:131], v[48:51], v[120:123], a[128:131]
  ds_read_b64_tr_b16 v[100:101], v9 offset:24608
  v_mfma_f32_16x16x32_bf16 a[132:135], v[52:55], v[120:123], a[132:135]
  ds_read_b64_tr_b16 v[102:103], v9 offset:25632
  s_add_u32 m0, s40, 41984
  s_add_u32 s42, s39, 1605632
  buffer_load_dwordx4 v3, s[12:15], s42 offen lds
  v_mfma_f32_16x16x32_bf16 a[160:163], v[48:51], v[124:127], a[160:163]
  v_mfma_f32_16x16x32_bf16 a[164:167], v[52:55], v[124:127], a[164:167]
  s_waitcnt lgkmcnt(0)
  s_waitcnt vmcnt(21)
  s_barrier
  v_mfma_f32_16x16x32_bf16 a[0:3], v[80:83], v[16:19], a[0:3]
  ds_read_b64_tr_b16 v[104:105], v8 offset:40960
  ds_read_b64_tr_b16 v[106:107], v8 offset:41984
  s_add_u32 m0, s43, 65536
  s_add_u32 s42, s38, 448
  buffer_load_dwordx4 v13, s[8:11], s42 offen lds
  v_mfma_f32_16x16x32_bf16 a[4:7], v[80:83], v[20:23], a[4:7]
  ds_read_b64_tr_b16 v[108:109], v8 offset:40968
  ds_read_b64_tr_b16 v[110:111], v8 offset:41992
  s_add_u32 m0, s40, 81920
  s_add_u32 s42, s39, 1835008
  buffer_load_dwordx4 v3, s[28:31], s42 offen lds
  v_mfma_f32_16x16x32_bf16 a[32:35], v[84:87], v[16:19], a[32:35]
  ds_read_b128 v[48:51], v7 offset:32768
  ds_read_b128 v[52:55], v7 offset:33024
  v_mfma_f32_16x16x32_bf16 a[36:39], v[84:87], v[20:23], a[36:39]
  ds_read_b64_tr_b16 v[112:113], v8 offset:49152
  ds_read_b64_tr_b16 v[114:115], v8 offset:50176
  s_add_u32 m0, s40, 82944
  s_add_u32 s42, s39, 1867776
  buffer_load_dwordx4 v3, s[28:31], s42 offen lds
  v_mfma_f32_16x16x32_bf16 a[64:67], v[88:91], v[16:19], a[64:67]
  ds_read_b64_tr_b16 v[116:117], v8 offset:49160
  s_add_u32 m0, s40, 90112
  s_add_u32 s42, s39, 1835008
  buffer_load_dwordx4 v3, s[32:35], s42 offen lds
  v_mfma_f32_16x16x32_bf16 a[68:71], v[88:91], v[20:23], a[68:71]
  ds_read_b64_tr_b16 v[118:119], v8 offset:50184
  v_mfma_f32_16x16x32_bf16 a[96:99], v[92:95], v[16:19], a[96:99]
  ds_read_b64_tr_b16 v[120:121], v9 offset:57344
  s_add_u32 m0, s40, 91136
  s_add_u32 s42, s39, 1867776
  buffer_load_dwordx4 v3, s[32:35], s42 offen lds
  v_mfma_f32_16x16x32_bf16 a[100:103], v[92:95], v[20:23], a[100:103]
  ds_read_b64_tr_b16 v[122:123], v9 offset:58368
  s_add_u32 m0, s40, 73728
  s_add_u32 s42, s39, 1835008
  buffer_load_dwordx4 v3, s[12:15], s42 offen lds
  v_mfma_f32_16x16x32_bf16 a[128:131], v[16:19], v[96:99], a[128:131]
  ds_read_b64_tr_b16 v[124:125], v9 offset:57376
  v_mfma_f32_16x16x32_bf16 a[132:135], v[20:23], v[96:99], a[132:135]
  ds_read_b64_tr_b16 v[126:127], v9 offset:58400
  s_add_u32 m0, s40, 74752
  s_add_u32 s42, s39, 1867776
  buffer_load_dwordx4 v3, s[12:15], s42 offen lds
  v_mfma_f32_16x16x32_bf16 a[160:163], v[16:19], v[100:103], a[160:163]
  v_mfma_f32_16x16x32_bf16 a[164:167], v[20:23], v[100:103], a[164:167]
  s_waitcnt lgkmcnt(0)
  s_waitcnt vmcnt(21)
  s_barrier
  v_mfma_f32_16x16x32_bf16 a[0:3], v[104:107], v[48:51], a[0:3]
  ds_read_b64_tr_b16 v[80:81], v11 offset:8192
  ds_read_b64_tr_b16 v[82:83], v11 offset:9216
  s_add_u32 m0, s43, 98304
  s_add_u32 s42, s38, 512
  buffer_load_dwordx4 v13, s[8:11], s42 offen lds
  v_mfma_f32_16x16x32_bf16 a[4:7], v[104:107], v[52:55], a[4:7]
  ds_read_b64_tr_b16 v[84:85], v11 offset:8200
  ds_read_b64_tr_b16 v[86:87], v11 offset:9224
  s_add_u32 m0, s40, 114688
  s_add_u32 s42, s39, 2097152
  buffer_load_dwordx4 v3, s[28:31], s42 offen lds
  v_mfma_f32_16x16x32_bf16 a[32:35], v[108:111], v[48:51], a[32:35]
  ds_read_b128 v[16:19], v10 offset:0
  ds_read_b128 v[20:23], v10 offset:256
  v_mfma_f32_16x16x32_bf16 a[36:39], v[108:111], v[52:55], a[36:39]
  ds_read_b64_tr_b16 v[88:89], v11 offset:16384
  ds_read_b64_tr_b16 v[90:91], v11 offset:17408
  s_add_u32 m0, s40, 115712
  s_add_u32 s42, s39, 2129920
  buffer_load_dwordx4 v3, s[28:31], s42 offen lds
  v_mfma_f32_16x16x32_bf16 a[64:67], v[112:115], v[48:51], a[64:67]
  ds_read_b64_tr_b16 v[92:93], v11 offset:16392
  s_add_u32 m0, s40, 122880
  s_add_u32 s42, s39, 2097152
  buffer_load_dwordx4 v3, s[32:35], s42 offen lds
  v_mfma_f32_16x16x32_bf16 a[68:71], v[112:115], v[52:55], a[68:71]
  ds_read_b64_tr_b16 v[94:95], v11 offset:17416
  v_mfma_f32_16x16x32_bf16 a[96:99], v[116:119], v[48:51], a[96:99]
  ds_read_b64_tr_b16 v[96:97], v12 offset:24576
  s_add_u32 m0, s40, 123904
  s_add_u32 s42, s39, 2129920
  buffer_load_dwordx4 v3, s[32:35], s42 offen lds
  v_mfma_f32_16x16x32_bf16 a[100:103], v[116:119], v[52:55], a[100:103]
  ds_read_b64_tr_b16 v[98:99], v12 offset:25600
  s_add_u32 m0, s40, 106496
  s_add_u32 s42, s39, 2097152
  buffer_load_dwordx4 v3, s[12:15], s42 offen lds
  v_mfma_f32_16x16x32_bf16 a[128:131], v[48:51], v[120:123], a[128:131]
  ds_read_b64_tr_b16 v[100:101], v12 offset:24608
  v_mfma_f32_16x16x32_bf16 a[132:135], v[52:55], v[120:123], a[132:135]
  ds_read_b64_tr_b16 v[102:103], v12 offset:25632
  s_add_u32 m0, s40, 107520
  s_add_u32 s42, s39, 2129920
  buffer_load_dwordx4 v3, s[12:15], s42 offen lds
  v_mfma_f32_16x16x32_bf16 a[160:163], v[48:51], v[124:127], a[160:163]
  v_mfma_f32_16x16x32_bf16 a[164:167], v[52:55], v[124:127], a[164:167]
  s_waitcnt lgkmcnt(0)
  s_waitcnt vmcnt(21)
  s_barrier
  v_mfma_f32_16x16x32_bf16 a[0:3], v[80:83], v[16:19], a[0:3]
  ds_read_b64_tr_b16 v[104:105], v5 offset:8192
  ds_read_b64_tr_b16 v[106:107], v5 offset:9216
  s_add_u32 m0, s43, 131072
  s_add_u32 s42, s38, 576
  buffer_load_dwordx4 v13, s[8:11], s42 offen lds
  v_mfma_f32_16x16x32_bf16 a[4:7], v[80:83], v[20:23], a[4:7]
  ds_read_b64_tr_b16 v[108:109], v5 offset:8200
  ds_read_b64_tr_b16 v[110:111], v5 offset:9224
  s_add_u32 m0, s40, 147456
  s_add_u32 s42, s39, 2359296
  buffer_load_dwordx4 v3, s[28:31], s42 offen lds
  v_mfma_f32_16x16x32_bf16 a[32:35], v[84:87], v[16:19], a[32:35]
  ds_read_b128 v[48:51], v4 offset:0
  ds_read_b128 v[52:55], v4 offset:256
  v_mfma_f32_16x16x32_bf16 a[36:39], v[84:87], v[20:23], a[36:39]
  ds_read_b64_tr_b16 v[112:113], v5 offset:16384
  ds_read_b64_tr_b16 v[114:115], v5 offset:17408
  s_add_u32 m0, s40, 148480
  s_add_u32 s42, s39, 2392064
  buffer_load_dwordx4 v3, s[28:31], s42 offen lds
  v_mfma_f32_16x16x32_bf16 a[64:67], v[88:91], v[16:19], a[64:67]
  ds_read_b64_tr_b16 v[116:117], v5 offset:16392
  s_add_u32 m0, s40, 155648
  s_add_u32 s42, s39, 2359296
  buffer_load_dwordx4 v3, s[32:35], s42 offen lds
  v_mfma_f32_16x16x32_bf16 a[68:71], v[88:91], v[20:23], a[68:71]
  ds_read_b64_tr_b16 v[118:119], v5 offset:17416
  v_mfma_f32_16x16x32_bf16 a[96:99], v[92:95], v[16:19], a[96:99]
  ds_read_b64_tr_b16 v[120:121], v6 offset:24576
  s_add_u32 m0, s40, 156672
  s_add_u32 s42, s39, 2392064
  buffer_load_dwordx4 v3, s[32:35], s42 offen lds
  v_mfma_f32_16x16x32_bf16 a[100:103], v[92:95], v[20:23], a[100:103]
  ds_read_b64_tr_b16 v[122:123], v6 offset:25600
  s_add_u32 m0, s40, 139264
  s_add_u32 s42, s39, 2359296
  buffer_load_dwordx4 v3, s[12:15], s42 offen lds
  v_mfma_f32_16x16x32_bf16 a[128:131], v[16:19], v[96:99], a[128:131]
  ds_read_b64_tr_b16 v[124:125], v6 offset:24608
  v_mfma_f32_16x16x32_bf16 a[132:135], v[20:23], v[96:99], a[132:135]
  ds_read_b64_tr_b16 v[126:127], v6 offset:25632
  s_add_u32 m0, s40, 140288
  s_add_u32 s42, s39, 2392064
  buffer_load_dwordx4 v3, s[12:15], s42 offen lds
  v_mfma_f32_16x16x32_bf16 a[160:163], v[16:19], v[100:103], a[160:163]
  v_mfma_f32_16x16x32_bf16 a[164:167], v[20:23], v[100:103], a[164:167]
  s_waitcnt lgkmcnt(0)
  s_waitcnt vmcnt(21)
  s_barrier
  v_mfma_f32_16x16x32_bf16 a[0:3], v[104:107], v[48:51], a[0:3]
  ds_read_b64_tr_b16 v[80:81], v5 offset:40960
  ds_read_b64_tr_b16 v[82:83], v5 offset:41984
  s_add_u32 m0, s43, 0
  s_add_u32 s42, s38, 640
  buffer_load_dwordx4 v13, s[8:11], s42 offen lds
  v_mfma_f32_16x16x32_bf16 a[4:7], v[104:107], v[52:55], a[4:7]
  ds_read_b64_tr_b16 v[84:85], v5 offset:40968
  ds_read_b64_tr_b16 v[86:87], v5 offset:41992
  s_add_u32 m0, s40, 16384
  s_add_u32 s42, s39, 2621440
  buffer_load_dwordx4 v3, s[28:31], s42 offen lds
  v_mfma_f32_16x16x32_bf16 a[32:35], v[108:111], v[48:51], a[32:35]
  ds_read_b128 v[16:19], v4 offset:32768
  ds_read_b128 v[20:23], v4 offset:33024
  v_mfma_f32_16x16x32_bf16 a[36:39], v[108:111], v[52:55], a[36:39]
  ds_read_b64_tr_b16 v[88:89], v5 offset:49152
  ds_read_b64_tr_b16 v[90:91], v5 offset:50176
  s_add_u32 m0, s40, 17408
  s_add_u32 s42, s39, 2654208
  buffer_load_dwordx4 v3, s[28:31], s42 offen lds
  v_mfma_f32_16x16x32_bf16 a[64:67], v[112:115], v[48:51], a[64:67]
  ds_read_b64_tr_b16 v[92:93], v5 offset:49160
  s_add_u32 m0, s40, 24576
  s_add_u32 s42, s39, 2621440
  buffer_load_dwordx4 v3, s[32:35], s42 offen lds
  v_mfma_f32_16x16x32_bf16 a[68:71], v[112:115], v[52:55], a[68:71]
  ds_read_b64_tr_b16 v[94:95], v5 offset:50184
  v_mfma_f32_16x16x32_bf16 a[96:99], v[116:119], v[48:51], a[96:99]
  ds_read_b64_tr_b16 v[96:97], v6 offset:57344
  s_add_u32 m0, s40, 25600
  s_add_u32 s42, s39, 2654208
  buffer_load_dwordx4 v3, s[32:35], s42 offen lds
  v_mfma_f32_16x16x32_bf16 a[100:103], v[116:119], v[52:55], a[100:103]
  ds_read_b64_tr_b16 v[98:99], v6 offset:58368
  s_add_u32 m0, s40, 8192
  s_add_u32 s42, s39, 2621440
  buffer_load_dwordx4 v3, s[12:15], s42 offen lds
  v_mfma_f32_16x16x32_bf16 a[128:131], v[48:51], v[120:123], a[128:131]
  ds_read_b64_tr_b16 v[100:101], v6 offset:57376
  v_mfma_f32_16x16x32_bf16 a[132:135], v[52:55], v[120:123], a[132:135]
  ds_read_b64_tr_b16 v[102:103], v6 offset:58400
  s_add_u32 m0, s40, 9216
  s_add_u32 s42, s39, 2654208
  buffer_load_dwordx4 v3, s[12:15], s42 offen lds
  v_mfma_f32_16x16x32_bf16 a[160:163], v[48:51], v[124:127], a[160:163]
  v_mfma_f32_16x16x32_bf16 a[164:167], v[52:55], v[124:127], a[164:167]
  s_waitcnt lgkmcnt(0)
  s_waitcnt vmcnt(21)
  s_barrier
  v_mfma_f32_16x16x32_bf16 a[0:3], v[80:83], v[16:19], a[0:3]
  ds_read_b64_tr_b16 v[104:105], v8 offset:8192
  ds_read_b64_tr_b16 v[106:107], v8 offset:9216
  s_add_u32 m0, s43, 32768
  s_add_u32 s42, s38, 704
  buffer_load_dwordx4 v13, s[8:11], s42 offen lds
  v_mfma_f32_16x16x32_bf16 a[4:7], v[80:83], v[20:23], a[4:7]
  ds_read_b64_tr_b16 v[108:109], v8 offset:8200
  ds_read_b64_tr_b16 v[110:111], v8 offset:9224
  s_add_u32 m0, s40, 49152
  s_add_u32 s42, s39, 2883584
  buffer_load_dwordx4 v3, s[28:31], s42 offen lds
  v_mfma_f32_16x16x32_bf16 a[32:35], v[84:87], v[16:19], a[32:35]
  ds_read_b128 v[48:51], v7 offset:0
  ds_read_b128 v[52:55], v7 offset:256
  v_mfma_f32_16x16x32_bf16 a[36:39], v[84:87], v[20:23], a[36:39]
  ds_read_b64_tr_b16 v[112:113], v8 offset:16384
  ds_read_b64_tr_b16 v[114:115], v8 offset:17408
  s_add_u32 m0, s40, 50176
  s_add_u32 s42, s39, 2916352
  buffer_load_dwordx4 v3, s[28:31], s42 offen lds
  v_mfma_f32_16x16x32_bf16 a[64:67], v[88:91], v[16:19], a[64:67]
  ds_read_b64_tr_b16 v[116:117], v8 offset:16392
  s_add_u32 m0, s40, 57344
  s_add_u32 s42, s39, 2883584
  buffer_load_dwordx4 v3, s[32:35], s42 offen lds
  v_mfma_f32_16x16x32_bf16 a[68:71], v[88:91], v[20:23], a[68:71]
  ds_read_b64_tr_b16 v[118:119], v8 offset:17416
  v_mfma_f32_16x16x32_bf16 a[96:99], v[92:95], v[16:19], a[96:99]
  ds_read_b64_tr_b16 v[120:121], v9 offset:24576
  s_add_u32 m0, s40, 58368
  s_add_u32 s42, s39, 2916352
  buffer_load_dwordx4 v3, s[32:35], s42 offen lds
  v_mfma_f32_16x16x32_bf16 a[100:103], v[92:95], v[20:23], a[100:103]
  ds_read_b64_tr_b16 v[122:123], v9 offset:25600
  s_add_u32 m0, s40, 40960
  s_add_u32 s42, s39, 2883584
  buffer_load_dwordx4 v3, s[12:15], s42 offen lds
  v_mfma_f32_16x16x32_bf16 a[128:131], v[16:19], v[96:99], a[128:131]
  ds_read_b64_tr_b16 v[124:125], v9 offset:24608
  v_mfma_f32_16x16x32_bf16 a[132:135], v[20:23], v[96:99], a[132:135]
  ds_read_b64_tr_b16 v[126:127], v9 offset:25632
  s_add_u32 m0, s40, 41984
  s_add_u32 s42, s39, 2916352
  buffer_load_dwordx4 v3, s[12:15], s42 offen lds
  v_mfma_f32_16x16x32_bf16 a[160:163], v[16:19], v[100:103], a[160:163]
  v_mfma_f32_16x16x32_bf16 a[164:167], v[20:23], v[100:103], a[164:167]
  s_waitcnt lgkmcnt(0)
  s_waitcnt vmcnt(21)
  s_barrier
  v_mfma_f32_16x16x32_bf16 a[0:3], v[104:107], v[48:51], a[0:3]
  ds_read_b64_tr_b16 v[80:81], v8 offset:40960
  ds_read_b64_tr_b16 v[82:83], v8 offset:41984
  s_add_u32 m0, s43, 65536
  s_add_u32 s42, s38, 768
  buffer_load_dwordx4 v13, s[8:11], s42 offen lds
  v_mfma_f32_16x16x32_bf16 a[4:7], v[104:107], v[52:55], a[4:7]
  ds_read_b64_tr_b16 v[84:85], v8 offset:40968
  ds_read_b64_tr_b16 v[86:87], v8 offset:41992
  s_add_u32 m0, s40, 81920
  s_add_u32 s42, s39, 3145728
  buffer_load_dwordx4 v3, s[28:31], s42 offen lds
  v_mfma_f32_16x16x32_bf16 a[32:35], v[108:111], v[48:51], a[32:35]
  ds_read_b128 v[16:19], v7 offset:32768
  ds_read_b128 v[20:23], v7 offset:33024
  v_mfma_f32_16x16x32_bf16 a[36:39], v[108:111], v[52:55], a[36:39]
  ds_read_b64_tr_b16 v[88:89], v8 offset:49152
  ds_read_b64_tr_b16 v[90:91], v8 offset:50176
  s_add_u32 m0, s40, 82944
  s_add_u32 s42, s39, 3178496
  buffer_load_dwordx4 v3, s[28:31], s42 offen lds
  v_mfma_f32_16x16x32_bf16 a[64:67], v[112:115], v[48:51], a[64:67]
  ds_read_b64_tr_b16 v[92:93], v8 offset:49160
  s_add_u32 m0, s40, 90112
  s_add_u32 s42, s39, 3145728
  buffer_load_dwordx4 v3, s[32:35], s42 offen lds
  v_mfma_f32_16x16x32_bf16 a[68:71], v[112:115], v[52:55], a[68:71]
  ds_read_b64_tr_b16 v[94:95], v8 offset:50184
  v_mfma_f32_16x16x32_bf16 a[96:99], v[116:119], v[48:51], a[96:99]
  ds_read_b64_tr_b16 v[96:97], v9 offset:57344
  s_add_u32 m0, s40, 91136
  s_add_u32 s42, s39, 3178496
  buffer_load_dwordx4 v3, s[32:35], s42 offen lds
  v_mfma_f32_16x16x32_bf16 a[100:103], v[116:119], v[52:55], a[100:103]
  ds_read_b64_tr_b16 v[98:99], v9 offset:58368
  s_add_u32 m0, s40, 73728
  s_add_u32 s42, s39, 3145728
  buffer_load_dwordx4 v3, s[12:15], s42 offen lds
  v_mfma_f32_16x16x32_bf16 a[128:131], v[48:51], v[120:123], a[128:131]
  ds_read_b64_tr_b16 v[100:101], v9 offset:57376
  v_mfma_f32_16x16x32_bf16 a[132:135], v[52:55], v[120:123], a[132:135]
  ds_read_b64_tr_b16 v[102:103], v9 offset:58400
  s_add_u32 m0, s40, 74752
  s_add_u32 s42, s39, 3178496
  buffer_load_dwordx4 v3, s[12:15], s42 offen lds
  v_mfma_f32_16x16x32_bf16 a[160:163], v[48:51], v[124:127], a[160:163]
  v_mfma_f32_16x16x32_bf16 a[164:167], v[52:55], v[124:127], a[164:167]
  s_waitcnt lgkmcnt(0)
  s_waitcnt vmcnt(21)
  s_barrier
  v_mfma_f32_16x16x32_bf16 a[0:3], v[80:83], v[16:19], a[0:3]
  ds_read_b64_tr_b16 v[104:105], v11 offset:8192
  ds_read_b64_tr_b16 v[106:107], v11 offset:9216
  s_add_u32 m0, s43, 98304
  s_add_u32 s42, s38, 832
  buffer_load_dwordx4 v13, s[8:11], s42 offen lds
  v_mfma_f32_16x16x32_bf16 a[4:7], v[80:83], v[20:23], a[4:7]
  ds_read_b64_tr_b16 v[108:109], v11 offset:8200
  ds_read_b64_tr_b16 v[110:111], v11 offset:9224
  s_add_u32 m0, s40, 114688
  s_add_u32 s42, s39, 3407872
  buffer_load_dwordx4 v3, s[28:31], s42 offen lds
  v_mfma_f32_16x16x32_bf16 a[32:35], v[84:87], v[16:19], a[32:35]
  ds_read_b128 v[48:51], v10 offset:0
  ds_read_b128 v[52:55], v10 offset:256
  v_mfma_f32_16x16x32_bf16 a[36:39], v[84:87], v[20:23], a[36:39]
  ds_read_b64_tr_b16 v[112:113], v11 offset:16384
  ds_read_b64_tr_b16 v[114:115], v11 offset:17408
  s_add_u32 m0, s40, 115712
  s_add_u32 s42, s39, 3440640
  buffer_load_dwordx4 v3, s[28:31], s42 offen lds
  v_mfma_f32_16x16x32_bf16 a[64:67], v[88:91], v[16:19], a[64:67]
  ds_read_b64_tr_b16 v[116:117], v11 offset:16392
  s_add_u32 m0, s40, 122880
  s_add_u32 s42, s39, 3407872
  buffer_load_dwordx4 v3, s[32:35], s42 offen lds
  v_mfma_f32_16x16x32_bf16 a[68:71], v[88:91], v[20:23], a[68:71]
  ds_read_b64_tr_b16 v[118:119], v11 offset:17416
  v_mfma_f32_16x16x32_bf16 a[96:99], v[92:95], v[16:19], a[96:99]
  ds_read_b64_tr_b16 v[120:121], v12 offset:24576
  s_add_u32 m0, s40, 123904
  s_add_u32 s42, s39, 3440640
  buffer_load_dwordx4 v3, s[32:35], s42 offen lds
  v_mfma_f32_16x16x32_bf16 a[100:103], v[92:95], v[20:23], a[100:103]
  ds_read_b64_tr_b16 v[122:123], v12 offset:25600
  s_add_u32 m0, s40, 106496
  s_add_u32 s42, s39, 3407872
  buffer_load_dwordx4 v3, s[12:15], s42 offen lds
  v_mfma_f32_16x16x32_bf16 a[128:131], v[16:19], v[96:99], a[128:131]
  ds_read_b64_tr_b16 v[124:125], v12 offset:24608
  v_mfma_f32_16x16x32_bf16 a[132:135], v[20:23], v[96:99], a[132:135]
  ds_read_b64_tr_b16 v[126:127], v12 offset:25632
  s_add_u32 m0, s40, 107520
  s_add_u32 s42, s39, 3440640
  buffer_load_dwordx4 v3, s[12:15], s42 offen lds
  v_mfma_f32_16x16x32_bf16 a[160:163], v[16:19], v[100:103], a[160:163]
  v_mfma_f32_16x16x32_bf16 a[164:167], v[20:23], v[100:103], a[164:167]
  s_waitcnt lgkmcnt(0)
  s_waitcnt vmcnt(21)
  s_barrier
  v_mfma_f32_16x16x32_bf16 a[0:3], v[104:107], v[48:51], a[0:3]
  ds_read_b64_tr_b16 v[80:81], v5 offset:8192
  ds_read_b64_tr_b16 v[82:83], v5 offset:9216
  s_add_u32 m0, s43, 131072
  s_add_u32 s42, s38, 896
  buffer_load_dwordx4 v13, s[8:11], s42 offen lds
  v_mfma_f32_16x16x32_bf16 a[4:7], v[104:107], v[52:55], a[4:7]
  ds_read_b64_tr_b16 v[84:85], v5 offset:8200
  ds_read_b64_tr_b16 v[86:87], v5 offset:9224
  s_add_u32 m0, s40, 147456
  s_add_u32 s42, s39, 3670016
  buffer_load_dwordx4 v3, s[28:31], s42 offen lds
  v_mfma_f32_16x16x32_bf16 a[32:35], v[108:111], v[48:51], a[32:35]
  ds_read_b128 v[16:19], v4 offset:0
  ds_read_b128 v[20:23], v4 offset:256
  v_mfma_f32_16x16x32_bf16 a[36:39], v[108:111], v[52:55], a[36:39]
  ds_read_b64_tr_b16 v[88:89], v5 offset:16384
  ds_read_b64_tr_b16 v[90:91], v5 offset:17408
  s_add_u32 m0, s40, 148480
  s_add_u32 s42, s39, 3702784
  buffer_load_dwordx4 v3, s[28:31], s42 offen lds
  v_mfma_f32_16x16x32_bf16 a[64:67], v[112:115], v[48:51], a[64:67]
  ds_read_b64_tr_b16 v[92:93], v5 offset:16392
  s_add_u32 m0, s40, 155648
  s_add_u32 s42, s39, 3670016
  buffer_load_dwordx4 v3, s[32:35], s42 offen lds
  v_mfma_f32_16x16x32_bf16 a[68:71], v[112:115], v[52:55], a[68:71]
  ds_read_b64_tr_b16 v[94:95], v5 offset:17416
  v_mfma_f32_16x16x32_bf16 a[96:99], v[116:119], v[48:51], a[96:99]
  ds_read_b64_tr_b16 v[96:97], v6 offset:24576
  s_add_u32 m0, s40, 156672
  s_add_u32 s42, s39, 3702784
  buffer_load_dwordx4 v3, s[32:35], s42 offen lds
  v_mfma_f32_16x16x32_bf16 a[100:103], v[116:119], v[52:55], a[100:103]
  ds_read_b64_tr_b16 v[98:99], v6 offset:25600
  s_add_u32 m0, s40, 139264
  s_add_u32 s42, s39, 3670016
  buffer_load_dwordx4 v3, s[12:15], s42 offen lds
  v_mfma_f32_16x16x32_bf16 a[128:131], v[48:51], v[120:123], a[128:131]
  ds_read_b64_tr_b16 v[100:101], v6 offset:24608
  v_mfma_f32_16x16x32_bf16 a[132:135], v[52:55], v[120:123], a[132:135]
  ds_read_b64_tr_b16 v[102:103], v6 offset:25632
  s_add_u32 m0, s40, 140288
  s_add_u32 s42, s39, 3702784
  buffer_load_dwordx4 v3, s[12:15], s42 offen lds
  v_mfma_f32_16x16x32_bf16 a[160:163], v[48:51], v[124:127], a[160:163]
  v_mfma_f32_16x16x32_bf16 a[164:167], v[52:55], v[124:127], a[164:167]
  s_waitcnt lgkmcnt(0)
  s_waitcnt vmcnt(21)
  s_barrier
  v_mfma_f32_16x16x32_bf16 a[0:3], v[80:83], v[16:19], a[0:3]
  ds_read_b64_tr_b16 v[104:105], v5 offset:40960
  ds_read_b64_tr_b16 v[106:107], v5 offset:41984
  s_add_u32 m0, s43, 0
  s_add_u32 s42, s38, 960
  buffer_load_dwordx4 v13, s[8:11], s42 offen lds
  v_mfma_f32_16x16x32_bf16 a[4:7], v[80:83], v[20:23], a[4:7]
  ds_read_b64_tr_b16 v[108:109], v5 offset:40968
  ds_read_b64_tr_b16 v[110:111], v5 offset:41992
  s_add_u32 m0, s40, 16384
  s_add_u32 s42, s39, 3932160
  buffer_load_dwordx4 v3, s[28:31], s42 offen lds
  v_mfma_f32_16x16x32_bf16 a[32:35], v[84:87], v[16:19], a[32:35]
  ds_read_b128 v[48:51], v4 offset:32768
  ds_read_b128 v[52:55], v4 offset:33024
  v_mfma_f32_16x16x32_bf16 a[36:39], v[84:87], v[20:23], a[36:39]
  ds_read_b64_tr_b16 v[112:113], v5 offset:49152
  ds_read_b64_tr_b16 v[114:115], v5 offset:50176
  s_add_u32 m0, s40, 17408
  s_add_u32 s42, s39, 3964928
  buffer_load_dwordx4 v3, s[28:31], s42 offen lds
  v_mfma_f32_16x16x32_bf16 a[64:67], v[88:91], v[16:19], a[64:67]
  ds_read_b64_tr_b16 v[116:117], v5 offset:49160
  s_add_u32 m0, s40, 24576
  s_add_u32 s42, s39, 3932160
  buffer_load_dwordx4 v3, s[32:35], s42 offen lds
  v_mfma_f32_16x16x32_bf16 a[68:71], v[88:91], v[20:23], a[68:71]
  ds_read_b64_tr_b16 v[118:119], v5 offset:50184
  v_mfma_f32_16x16x32_bf16 a[96:99], v[92:95], v[16:19], a[96:99]
  ds_read_b64_tr_b16 v[120:121], v6 offset:57344
  s_add_u32 m0, s40, 25600
  s_add_u32 s42, s39, 3964928
  buffer_load_dwordx4 v3, s[32:35], s42 offen lds
  v_mfma_f32_16x16x32_bf16 a[100:103], v[92:95], v[20:23], a[100:103]
  ds_read_b64_tr_b16 v[122:123], v6 offset:58368
  s_add_u32 m0, s40, 8192
  s_add_u32 s42, s39, 3932160
  buffer_load_dwordx4 v3, s[12:15], s42 offen lds
  v_mfma_f32_16x16x32_bf16 a[128:131], v[16:19], v[96:99], a[128:131]
  ds_read_b64_tr_b16 v[124:125], v6 offset:57376
  v_mfma_f32_16x16x32_bf16 a[132:135], v[20:23], v[96:99], a[132:135]
  ds_read_b64_tr_b16 v[126:127], v6 offset:58400
  s_add_u32 m0, s40, 9216
  s_add_u32 s42, s39, 3964928
  buffer_load_dwordx4 v3, s[12:15], s42 offen lds
  v_mfma_f32_16x16x32_bf16 a[160:163], v[16:19], v[100:103], a[160:163]
  v_mfma_f32_16x16x32_bf16 a[164:167], v[20:23], v[100:103], a[164:167]
  s_waitcnt lgkmcnt(0)
  s_waitcnt vmcnt(21)
  s_barrier
  v_mfma_f32_16x16x32_bf16 a[0:3], v[104:107], v[48:51], a[0:3]
  ds_read_b64_tr_b16 v[80:81], v8 offset:8192
  ds_read_b64_tr_b16 v[82:83], v8 offset:9216
  s_add_u32 m0, s43, 32768
  s_add_u32 s42, s38, 1024
  buffer_load_dwordx4 v13, s[8:11], s42 offen lds
  v_mfma_f32_16x16x32_bf16 a[4:7], v[104:107], v[52:55], a[4:7]
  ds_read_b64_tr_b16 v[84:85], v8 offset:8200
  ds_read_b64_tr_b16 v[86:87], v8 offset:9224
  s_add_u32 m0, s40, 49152
  s_add_u32 s42, s39, 4194304
  buffer_load_dwordx4 v3, s[28:31], s42 offen lds
  v_mfma_f32_16x16x32_bf16 a[32:35], v[108:111], v[48:51], a[32:35]
  ds_read_b128 v[16:19], v7 offset:0
  ds_read_b128 v[20:23], v7 offset:256
  v_mfma_f32_16x16x32_bf16 a[36:39], v[108:111], v[52:55], a[36:39]
  ds_read_b64_tr_b16 v[88:89], v8 offset:16384
  ds_read_b64_tr_b16 v[90:91], v8 offset:17408
  s_add_u32 m0, s40, 50176
  s_add_u32 s42, s39, 4227072
  buffer_load_dwordx4 v3, s[28:31], s42 offen lds
  v_mfma_f32_16x16x32_bf16 a[64:67], v[112:115], v[48:51], a[64:67]
  ds_read_b64_tr_b16 v[92:93], v8 offset:16392
  s_add_u32 m0, s40, 57344
  s_add_u32 s42, s39, 4194304
  buffer_load_dwordx4 v3, s[32:35], s42 offen lds
  v_mfma_f32_16x16x32_bf16 a[68:71], v[112:115], v[52:55], a[68:71]
  ds_read_b64_tr_b16 v[94:95], v8 offset:17416
  v_mfma_f32_16x16x32_bf16 a[96:99], v[116:119], v[48:51], a[96:99]
  ds_read_b64_tr_b16 v[96:97], v9 offset:24576
  s_add_u32 m0, s40, 58368
  s_add_u32 s42, s39, 4227072
  buffer_load_dwordx4 v3, s[32:35], s42 offen lds
  v_mfma_f32_16x16x32_bf16 a[100:103], v[116:119], v[52:55], a[100:103]
  ds_read_b64_tr_b16 v[98:99], v9 offset:25600
  s_add_u32 m0, s40, 40960
  s_add_u32 s42, s39, 4194304
  buffer_load_dwordx4 v3, s[12:15], s42 offen lds
  v_mfma_f32_16x16x32_bf16 a[128:131], v[48:51], v[120:123], a[128:131]
  ds_read_b64_tr_b16 v[100:101], v9 offset:24608
  v_mfma_f32_16x16x32_bf16 a[132:135], v[52:55], v[120:123], a[132:135]
  ds_read_b64_tr_b16 v[102:103], v9 offset:25632
  s_add_u32 m0, s40, 41984
  s_add_u32 s42, s39, 4227072
  buffer_load_dwordx4 v3, s[12:15], s42 offen lds
  v_mfma_f32_16x16x32_bf16 a[160:163], v[48:51], v[124:127], a[160:163]
  v_mfma_f32_16x16x32_bf16 a[164:167], v[52:55], v[124:127], a[164:167]
  s_waitcnt lgkmcnt(0)
  s_waitcnt vmcnt(21)
  s_barrier
  v_mfma_f32_16x16x32_bf16 a[0:3], v[80:83], v[16:19], a[0:3]
  ds_read_b64_tr_b16 v[104:105], v8 offset:40960
  ds_read_b64_tr_b16 v[106:107], v8 offset:41984
  s_add_u32 m0, s43, 65536
  s_add_u32 s42, s38, 1088
  buffer_load_dwordx4 v13, s[8:11], s42 offen lds
  v_mfma_f32_16x16x32_bf16 a[4:7], v[80:83], v[20:23], a[4:7]
  ds_read_b64_tr_b16 v[108:109], v8 offset:40968
  ds_read_b64_tr_b16 v[110:111], v8 offset:41992
  s_add_u32 m0, s40, 81920
  s_add_u32 s42, s39, 4456448
  buffer_load_dwordx4 v3, s[28:31], s42 offen lds
  v_mfma_f32_16x16x32_bf16 a[32:35], v[84:87], v[16:19], a[32:35]
  ds_read_b128 v[48:51], v7 offset:32768
  ds_read_b128 v[52:55], v7 offset:33024
  v_mfma_f32_16x16x32_bf16 a[36:39], v[84:87], v[20:23], a[36:39]
  ds_read_b64_tr_b16 v[112:113], v8 offset:49152
  ds_read_b64_tr_b16 v[114:115], v8 offset:50176
  s_add_u32 m0, s40, 82944
  s_add_u32 s42, s39, 4489216
  buffer_load_dwordx4 v3, s[28:31], s42 offen lds
  v_mfma_f32_16x16x32_bf16 a[64:67], v[88:91], v[16:19], a[64:67]
  ds_read_b64_tr_b16 v[116:117], v8 offset:49160
  s_add_u32 m0, s40, 90112
  s_add_u32 s42, s39, 4456448
  buffer_load_dwordx4 v3, s[32:35], s42 offen lds
  v_mfma_f32_16x16x32_bf16 a[68:71], v[88:91], v[20:23], a[68:71]
  ds_read_b64_tr_b16 v[118:119], v8 offset:50184
  v_mfma_f32_16x16x32_bf16 a[96:99], v[92:95], v[16:19], a[96:99]
  ds_read_b64_tr_b16 v[120:121], v9 offset:57344
  s_add_u32 m0, s40, 91136
  s_add_u32 s42, s39, 4489216
  buffer_load_dwordx4 v3, s[32:35], s42 offen lds
  v_mfma_f32_16x16x32_bf16 a[100:103], v[92:95], v[20:23], a[100:103]
  ds_read_b64_tr_b16 v[122:123], v9 offset:58368
  s_add_u32 m0, s40, 73728
  s_add_u32 s42, s39, 4456448
  buffer_load_dwordx4 v3, s[12:15], s42 offen lds
  v_mfma_f32_16x16x32_bf16 a[128:131], v[16:19], v[96:99], a[128:131]
  ds_read_b64_tr_b16 v[124:125], v9 offset:57376
  v_mfma_f32_16x16x32_bf16 a[132:135], v[20:23], v[96:99], a[132:135]
  ds_read_b64_tr_b16 v[126:127], v9 offset:58400
  s_add_u32 m0, s40, 74752
  s_add_u32 s42, s39, 4489216
  buffer_load_dwordx4 v3, s[12:15], s42 offen lds
  v_mfma_f32_16x16x32_bf16 a[160:163], v[16:19], v[100:103], a[160:163]
  v_mfma_f32_16x16x32_bf16 a[164:167], v[20:23], v[100:103], a[164:167]
  s_waitcnt lgkmcnt(0)
  s_waitcnt vmcnt(21)
  s_barrier
  v_mfma_f32_16x16x32_bf16 a[0:3], v[104:107], v[48:51], a[0:3]
  ds_read_b64_tr_b16 v[80:81], v11 offset:8192
  ds_read_b64_tr_b16 v[82:83], v11 offset:9216
  s_add_u32 m0, s43, 98304
  s_add_u32 s42, s38, 1152
  buffer_load_dwordx4 v13, s[8:11], s42 offen lds
  v_mfma_f32_16x16x32_bf16 a[4:7], v[104:107], v[52:55], a[4:7]
  ds_read_b64_tr_b16 v[84:85], v11 offset:8200
  ds_read_b64_tr_b16 v[86:87], v11 offset:9224
  s_add_u32 m0, s40, 114688
  s_add_u32 s42, s39, 4718592
  buffer_load_dwordx4 v3, s[28:31], s42 offen lds
  v_mfma_f32_16x16x32_bf16 a[32:35], v[108:111], v[48:51], a[32:35]
  ds_read_b128 v[16:19], v10 offset:0
  ds_read_b128 v[20:23], v10 offset:256
  v_mfma_f32_16x16x32_bf16 a[36:39], v[108:111], v[52:55], a[36:39]
  ds_read_b64_tr_b16 v[88:89], v11 offset:16384
  ds_read_b64_tr_b16 v[90:91], v11 offset:17408
  s_add_u32 m0, s40, 115712
  s_add_u32 s42, s39, 4751360
  buffer_load_dwordx4 v3, s[28:31], s42 offen lds
  v_mfma_f32_16x16x32_bf16 a[64:67], v[112:115], v[48:51], a[64:67]
  ds_read_b64_tr_b16 v[92:93], v11 offset:16392
  s_add_u32 m0, s40, 122880
  s_add_u32 s42, s39, 4718592
  buffer_load_dwordx4 v3, s[32:35], s42 offen lds
  v_mfma_f32_16x16x32_bf16 a[68:71], v[112:115], v[52:55], a[68:71]
  ds_read_b64_tr_b16 v[94:95], v11 offset:17416
  v_mfma_f32_16x16x32_bf16 a[96:99], v[116:119], v[48:51], a[96:99]
  ds_read_b64_tr_b16 v[96:97], v12 offset:24576
  s_add_u32 m0, s40, 123904
  s_add_u32 s42, s39, 4751360
  buffer_load_dwordx4 v3, s[32:35], s42 offen lds
  v_mfma_f32_16x16x32_bf16 a[100:103], v[116:119], v[52:55], a[100:103]
  ds_read_b64_tr_b16 v[98:99], v12 offset:25600
  s_add_u32 m0, s40, 106496
  s_add_u32 s42, s39, 4718592
  buffer_load_dwordx4 v3, s[12:15], s42 offen lds
  v_mfma_f32_16x16x32_bf16 a[128:131], v[48:51], v[120:123], a[128:131]
  ds_read_b64_tr_b16 v[100:101], v12 offset:24608
  v_mfma_f32_16x16x32_bf16 a[132:135], v[52:55], v[120:123], a[132:135]
  ds_read_b64_tr_b16 v[102:103], v12 offset:25632
  s_add_u32 m0, s40, 107520
  s_add_u32 s42, s39, 4751360
  buffer_load_dwordx4 v3, s[12:15], s42 offen lds
  v_mfma_f32_16x16x32_bf16 a[160:163], v[48:51], v[124:127], a[160:163]
  v_mfma_f32_16x16x32_bf16 a[164:167], v[52:55], v[124:127], a[164:167]
  s_waitcnt lgkmcnt(0)
  s_waitcnt vmcnt(21)
  s_barrier
  v_mfma_f32_16x16x32_bf16 a[0:3], v[80:83], v[16:19], a[0:3]
  ds_read_b64_tr_b16 v[104:105], v5 offset:8192
  ds_read_b64_tr_b16 v[106:107], v5 offset:9216
  s_add_u32 m0, s43, 131072
  s_add_u32 s42, s38, 1216
  buffer_load_dwordx4 v13, s[8:11], s42 offen lds
  v_mfma_f32_16x16x32_bf16 a[4:7], v[80:83], v[20:23], a[4:7]
  ds_read_b64_tr_b16 v[108:109], v5 offset:8200
  ds_read_b64_tr_b16 v[110:111], v5 offset:9224
  s_add_u32 m0, s40, 147456
  s_add_u32 s42, s39, 4980736
  buffer_load_dwordx4 v3, s[28:31], s42 offen lds
  v_mfma_f32_16x16x32_bf16 a[32:35], v[84:87], v[16:19], a[32:35]
  ds_read_b128 v[48:51], v4 offset:0
  ds_read_b128 v[52:55], v4 offset:256
  v_mfma_f32_16x16x32_bf16 a[36:39], v[84:87], v[20:23], a[36:39]
  ds_read_b64_tr_b16 v[112:113], v5 offset:16384
  ds_read_b64_tr_b16 v[114:115], v5 offset:17408
  s_add_u32 m0, s40, 148480
  s_add_u32 s42, s39, 5013504
  buffer_load_dwordx4 v3, s[28:31], s42 offen lds
  v_mfma_f32_16x16x32_bf16 a[64:67], v[88:91], v[16:19], a[64:67]
  ds_read_b64_tr_b16 v[116:117], v5 offset:16392
  s_add_u32 m0, s40, 155648
  s_add_u32 s42, s39, 4980736
  buffer_load_dwordx4 v3, s[32:35], s42 offen lds
  v_mfma_f32_16x16x32_bf16 a[68:71], v[88:91], v[20:23], a[68:71]
  ds_read_b64_tr_b16 v[118:119], v5 offset:17416
  v_mfma_f32_16x16x32_bf16 a[96:99], v[92:95], v[16:19], a[96:99]
  ds_read_b64_tr_b16 v[120:121], v6 offset:24576
  s_add_u32 m0, s40, 156672
  s_add_u32 s42, s39, 5013504
  buffer_load_dwordx4 v3, s[32:35], s42 offen lds
  v_mfma_f32_16x16x32_bf16 a[100:103], v[92:95], v[20:23], a[100:103]
  ds_read_b64_tr_b16 v[122:123], v6 offset:25600
  s_add_u32 m0, s40, 139264
  s_add_u32 s42, s39, 4980736
  buffer_load_dwordx4 v3, s[12:15], s42 offen lds
  v_mfma_f32_16x16x32_bf16 a[128:131], v[16:19], v[96:99], a[128:131]
  ds_read_b64_tr_b16 v[124:125], v6 offset:24608
  v_mfma_f32_16x16x32_bf16 a[132:135], v[20:23], v[96:99], a[132:135]
  ds_read_b64_tr_b16 v[126:127], v6 offset:25632
  s_add_u32 m0, s40, 140288
  s_add_u32 s42, s39, 5013504
  buffer_load_dwordx4 v3, s[12:15], s42 offen lds
  v_mfma_f32_16x16x32_bf16 a[160:163], v[16:19], v[100:103], a[160:163]
  v_mfma_f32_16x16x32_bf16 a[164:167], v[20:23], v[100:103], a[164:167]
  s_waitcnt lgkmcnt(0)
  s_waitcnt vmcnt(21)
  s_barrier
  v_mfma_f32_16x16x32_bf16 a[0:3], v[104:107], v[48:51], a[0:3]
  ds_read_b64_tr_b16 v[80:81], v5 offset:40960
  ds_read_b64_tr_b16 v[82:83], v5 offset:41984
  v_mfma_f32_16x16x32_bf16 a[4:7], v[104:107], v[52:55], a[4:7]
  ds_read_b64_tr_b16 v[84:85], v5 offset:40968
  ds_read_b64_tr_b16 v[86:87], v5 offset:41992
  v_mfma_f32_16x16x32_bf16 a[32:35], v[108:111], v[48:51], a[32:35]
  ds_read_b128 v[16:19], v4 offset:32768
  ds_read_b128 v[20:23], v4 offset:33024
  v_mfma_f32_16x16x32_bf16 a[36:39], v[108:111], v[52:55], a[36:39]
  ds_read_b64_tr_b16 v[88:89], v5 offset:49152
  ds_read_b64_tr_b16 v[90:91], v5 offset:50176
  v_mfma_f32_16x16x32_bf16 a[64:67], v[112:115], v[48:51], a[64:67]
  ds_read_b64_tr_b16 v[92:93], v5 offset:49160
  v_mfma_f32_16x16x32_bf16 a[68:71], v[112:115], v[52:55], a[68:71]
  ds_read_b64_tr_b16 v[94:95], v5 offset:50184
  v_mfma_f32_16x16x32_bf16 a[96:99], v[116:119], v[48:51], a[96:99]
  ds_read_b64_tr_b16 v[96:97], v6 offset:57344
  v_mfma_f32_16x16x32_bf16 a[100:103], v[116:119], v[52:55], a[100:103]
  ds_read_b64_tr_b16 v[98:99], v6 offset:58368
  v_mfma_f32_16x16x32_bf16 a[128:131], v[48:51], v[120:123], a[128:131]
  ds_read_b64_tr_b16 v[100:101], v6 offset:57376
  v_mfma_f32_16x16x32_bf16 a[132:135], v[52:55], v[120:123], a[132:135]
  ds_read_b64_tr_b16 v[102:103], v6 offset:58400
  v_mfma_f32_16x16x32_bf16 a[160:163], v[48:51], v[124:127], a[160:163]
  v_mfma_f32_16x16x32_bf16 a[164:167], v[52:55], v[124:127], a[164:167]
  s_waitcnt lgkmcnt(0)
  s_waitcnt vmcnt(14)
  s_barrier
  v_mfma_f32_16x16x32_bf16 a[0:3], v[80:83], v[16:19], a[0:3]
  ds_read_b64_tr_b16 v[104:105], v8 offset:8192
  ds_read_b64_tr_b16 v[106:107], v8 offset:9216
  v_mfma_f32_16x16x32_bf16 a[4:7], v[80:83], v[20:23], a[4:7]
  ds_read_b64_tr_b16 v[108:109], v8 offset:8200
  ds_read_b64_tr_b16 v[110:111], v8 offset:9224
  v_mfma_f32_16x16x32_bf16 a[32:35], v[84:87], v[16:19], a[32:35]
  ds_read_b128 v[48:51], v7 offset:0
  ds_read_b128 v[52:55], v7 offset:256
  v_mfma_f32_16x16x32_bf16 a[36:39], v[84:87], v[20:23], a[36:39]
  ds_read_b64_tr_b16 v[112:113], v8 offset:16384
  ds_read_b64_tr_b16 v[114:115], v8 offset:17408
  v_mfma_f32_16x16x32_bf16 a[64:67], v[88:91], v[16:19], a[64:67]
  ds_read_b64_tr_b16 v[116:117], v8 offset:16392
  v_mfma_f32_16x16x32_bf16 a[68:71], v[88:91], v[20:23], a[68:71]
  ds_read_b64_tr_b16 v[118:119], v8 offset:17416
  v_mfma_f32_16x16x32_bf16 a[96:99], v[92:95], v[16:19], a[96:99]
  ds_read_b64_tr_b16 v[120:121], v9 offset:24576
  v_mfma_f32_16x16x32_bf16 a[100:103], v[92:95], v[20:23], a[100:103]
  ds_read_b64_tr_b16 v[122:123], v9 offset:25600
  v_mfma_f32_16x16x32_bf16 a[128:131], v[16:19], v[96:99], a[128:131]
  ds_read_b64_tr_b16 v[124:125], v9 offset:24608
  v_mfma_f32_16x16x32_bf16 a[132:135], v[20:23], v[96:99], a[132:135]
  ds_read_b64_tr_b16 v[126:127], v9 offset:25632
  v_mfma_f32_16x16x32_bf16 a[160:163], v[16:19], v[100:103], a[160:163]
  v_mfma_f32_16x16x32_bf16 a[164:167], v[20:23], v[100:103], a[164:167]
  s_waitcnt lgkmcnt(0)
  s_waitcnt vmcnt(7)
  s_barrier
  v_mfma_f32_16x16x32_bf16 a[0:3], v[104:107], v[48:51], a[0:3]
  ds_read_b64_tr_b16 v[80:81], v8 offset:40960
  ds_read_b64_tr_b16 v[82:83], v8 offset:41984
  v_mfma_f32_16x16x32_bf16 a[4:7], v[104:107], v[52:55], a[4:7]
  ds_read_b64_tr_b16 v[84:85], v8 offset:40968
  ds_read_b64_tr_b16 v[86:87], v8 offset:41992
  v_mfma_f32_16x16x32_bf16 a[32:35], v[108:111], v[48:51], a[32:35]
  ds_read_b128 v[16:19], v7 offset:32768
  ds_read_b128 v[20:23], v7 offset:33024
  v_mfma_f32_16x16x32_bf16 a[36:39], v[108:111], v[52:55], a[36:39]
  ds_read_b64_tr_b16 v[88:89], v8 offset:49152
  ds_read_b64_tr_b16 v[90:91], v8 offset:50176
  v_mfma_f32_16x16x32_bf16 a[64:67], v[112:115], v[48:51], a[64:67]
  ds_read_b64_tr_b16 v[92:93], v8 offset:49160
  v_mfma_f32_16x16x32_bf16 a[68:71], v[112:115], v[52:55], a[68:71]
  ds_read_b64_tr_b16 v[94:95], v8 offset:50184
  v_mfma_f32_16x16x32_bf16 a[96:99], v[116:119], v[48:51], a[96:99]
  ds_read_b64_tr_b16 v[96:97], v9 offset:57344
  v_mfma_f32_16x16x32_bf16 a[100:103], v[116:119], v[52:55], a[100:103]
  ds_read_b64_tr_b16 v[98:99], v9 offset:58368
  v_mfma_f32_16x16x32_bf16 a[128:131], v[48:51], v[120:123], a[128:131]
  ds_read_b64_tr_b16 v[100:101], v9 offset:57376
  v_mfma_f32_16x16x32_bf16 a[132:135], v[52:55], v[120:123], a[132:135]
  ds_read_b64_tr_b16 v[102:103], v9 offset:58400
  v_mfma_f32_16x16x32_bf16 a[160:163], v[48:51], v[124:127], a[160:163]
  v_mfma_f32_16x16x32_bf16 a[164:167], v[52:55], v[124:127], a[164:167]
  s_waitcnt lgkmcnt(0)
  s_waitcnt vmcnt(0)
  s_barrier
  v_mfma_f32_16x16x32_bf16 a[0:3], v[80:83], v[16:19], a[0:3]
  ds_read_b64_tr_b16 v[104:105], v11 offset:8192
  ds_read_b64_tr_b16 v[106:107], v11 offset:9216
  v_mfma_f32_16x16x32_bf16 a[4:7], v[80:83], v[20:23], a[4:7]
  ds_read_b64_tr_b16 v[108:109], v11 offset:8200
  ds_read_b64_tr_b16 v[110:111], v11 offset:9224
  v_mfma_f32_16x16x32_bf16 a[32:35], v[84:87], v[16:19], a[32:35]
  ds_read_b128 v[48:51], v10 offset:0
  ds_read_b128 v[52:55], v10 offset:256
  v_mfma_f32_16x16x32_bf16 a[36:39], v[84:87], v[20:23], a[36:39]
  ds_read_b64_tr_b16 v[112:113], v11 offset:16384
  ds_read_b64_tr_b16 v[114:115], v11 offset:17408
  v_mfma_f32_16x16x32_bf16 a[64:67], v[88:91], v[16:19], a[64:67]
  ds_read_b64_tr_b16 v[116:117], v11 offset:16392
  v_mfma_f32_16x16x32_bf16 a[68:71], v[88:91], v[20:23], a[68:71]
  ds_read_b64_tr_b16 v[118:119], v11 offset:17416
  v_mfma_f32_16x16x32_bf16 a[96:99], v[92:95], v[16:19], a[96:99]
  ds_read_b64_tr_b16 v[120:121], v12 offset:24576
  v_mfma_f32_16x16x32_bf16 a[100:103], v[92:95], v[20:23], a[100:103]
  ds_read_b64_tr_b16 v[122:123], v12 offset:25600
  v_mfma_f32_16x16x32_bf16 a[128:131], v[16:19], v[96:99], a[128:131]
  ds_read_b64_tr_b16 v[124:125], v12 offset:24608
  v_mfma_f32_16x16x32_bf16 a[132:135], v[20:23], v[96:99], a[132:135]
  ds_read_b64_tr_b16 v[126:127], v12 offset:25632
  v_mfma_f32_16x16x32_bf16 a[160:163], v[16:19], v[100:103], a[160:163]
  v_mfma_f32_16x16x32_bf16 a[164:167], v[20:23], v[100:103], a[164:167]
  s_waitcnt lgkmcnt(0)
  s_barrier
  v_mfma_f32_16x16x32_bf16 a[0:3], v[104:107], v[48:51], a[0:3]
  v_mfma_f32_16x16x32_bf16 a[4:7], v[104:107], v[52:55], a[4:7]
  v_mfma_f32_16x16x32_bf16 a[32:35], v[108:111], v[48:51], a[32:35]
  v_mfma_f32_16x16x32_bf16 a[36:39], v[108:111], v[52:55], a[36:39]
  v_mfma_f32_16x16x32_bf16 a[64:67], v[112:115], v[48:51], a[64:67]
  v_mfma_f32_16x16x32_bf16 a[68:71], v[112:115], v[52:55], a[68:71]
  v_mfma_f32_16x16x32_bf16 a[96:99], v[116:119], v[48:51], a[96:99]
  v_mfma_f32_16x16x32_bf16 a[100:103], v[116:119], v[52:55], a[100:103]
  v_mfma_f32_16x16x32_bf16 a[128:131], v[48:51], v[120:123], a[128:131]
  v_mfma_f32_16x16x32_bf16 a[132:135], v[52:55], v[120:123], a[132:135]
  v_mfma_f32_16x16x32_bf16 a[160:163], v[48:51], v[124:127], a[160:163]
  v_mfma_f32_16x16x32_bf16 a[164:167], v[52:55], v[124:127], a[164:167]
  s_lshl_b32 s41, s36, 5
  s_add_u32 s41, s41, s37
  s_lshl_b32 s41, s41, 13
  s_lshl_b32 s23, s20, 11
  s_add_u32 s41, s41, s23
  s_add_u32 s42, s41, 0x0
  v_accvgpr_read_b32 v20, a64
  v_accvgpr_read_b32 v21, a65
  v_accvgpr_read_b32 v22, a66
  v_accvgpr_read_b32 v23, a67
  v_accvgpr_read_b32 v24, a96
  v_accvgpr_read_b32 v25, a97
  v_accvgpr_read_b32 v26, a98
  v_accvgpr_read_b32 v27, a99
  v_cvt_pk_bf16_f32 v16, v20, v21
  v_cvt_pk_bf16_f32 v17, v22, v23
  v_cvt_pk_bf16_f32 v18, v24, v25
  v_cvt_pk_bf16_f32 v19, v26, v27
  buffer_store_dwordx4 v[16:19], v0, s[4:7], s42 offen offset:0 sc1
  v_accvgpr_read_b32 v32, a68
  v_accvgpr_read_b32 v33, a69
  v_accvgpr_read_b32 v34, a70
  v_accvgpr_read_b32 v35, a71
  v_accvgpr_read_b32 v36, a100
  v_accvgpr_read_b32 v37, a101
  v_accvgpr_read_b32 v38, a102
  v_accvgpr_read_b32 v39, a103
  v_cvt_pk_bf16_f32 v28, v32, v33
  v_cvt_pk_bf16_f32 v29, v34, v35
  v_cvt_pk_bf16_f32 v30, v36, v37
  v_cvt_pk_bf16_f32 v31, v38, v39
  buffer_store_dwordx4 v[28:31], v0, s[4:7], s42 offen offset:1024 sc1
  s_add_u32 s42, s41, 0x2000000
  v_accvgpr_read_b32 v44, a0
  v_accvgpr_read_b32 v45, a1
  v_accvgpr_read_b32 v46, a2
  v_accvgpr_read_b32 v47, a3
  v_accvgpr_read_b32 v48, a32
  v_accvgpr_read_b32 v49, a33
  v_accvgpr_read_b32 v50, a34
  v_accvgpr_read_b32 v51, a35
  v_cvt_pk_bf16_f32 v40, v44, v45
  v_cvt_pk_bf16_f32 v41, v46, v47
  v_cvt_pk_bf16_f32 v42, v48, v49
  v_cvt_pk_bf16_f32 v43, v50, v51
  buffer_store_dwordx4 v[40:43], v0, s[4:7], s42 offen offset:0 sc1
  v_accvgpr_read_b32 v56, a4
  v_accvgpr_read_b32 v57, a5
  v_accvgpr_read_b32 v58, a6
  v_accvgpr_read_b32 v59, a7
  v_accvgpr_read_b32 v60, a36
  v_accvgpr_read_b32 v61, a37
  v_accvgpr_read_b32 v62, a38
  v_accvgpr_read_b32 v63, a39
  v_cvt_pk_bf16_f32 v52, v56, v57
  v_cvt_pk_bf16_f32 v53, v58, v59
  v_cvt_pk_bf16_f32 v54, v60, v61
  v_cvt_pk_bf16_f32 v55, v62, v63
  buffer_store_dwordx4 v[52:55], v0, s[4:7], s42 offen offset:1024 sc1
  s_add_u32 s42, s41, 0x1000000
  v_accvgpr_read_b32 v20, a128
  v_accvgpr_read_b32 v21, a129
  v_accvgpr_read_b32 v22, a130
  v_accvgpr_read_b32 v23, a131
  v_accvgpr_read_b32 v24, a132
  v_accvgpr_read_b32 v25, a133
  v_accvgpr_read_b32 v26, a134
  v_accvgpr_read_b32 v27, a135
  v_cvt_pk_bf16_f32 v16, v20, v21
  v_cvt_pk_bf16_f32 v17, v22, v23
  v_cvt_pk_bf16_f32 v18, v24, v25
  v_cvt_pk_bf16_f32 v19, v26, v27
  buffer_store_dwordx4 v[16:19], v0, s[4:7], s42 offen offset:0 sc1
  v_accvgpr_read_b32 v32, a160
  v_accvgpr_read_b32 v33, a161
  v_accvgpr_read_b32 v34, a162
  v_accvgpr_read_b32 v35, a163
  v_accvgpr_read_b32 v36, a164
  v_accvgpr_read_b32 v37, a165
  v_accvgpr_read_b32 v38, a166
  v_accvgpr_read_b32 v39, a167
  v_cvt_pk_bf16_f32 v28, v32, v33
  v_cvt_pk_bf16_f32 v29, v34, v35
  v_cvt_pk_bf16_f32 v30, v36, v37
  v_cvt_pk_bf16_f32 v31, v38, v39
  buffer_store_dwordx4 v[28:31], v0, s[4:7], s42 offen offset:1024 sc1
  s_waitcnt vmcnt(0)
  s_barrier
L_tdone:
  s_cmp_lg_u32 s20, 0
  s_cbranch_scc1 L_tnosig
  s_lshl_b32 s23, s76, 2
  s_add_u32 s23, s23, 64
  v_mov_b32 v128, s23
  v_mov_b32 v129, 1
  s_mov_b64 exec, 1
  global_atomic_add v128, v129, s[16:17] sc1
  s_mov_b64 exec, -1
L_tnosig:
  s_add_u32 s75, s75, 32
  s_branch L_task
L_engine:
  s_cmp_ge_u32 s71, 32
  s_cbranch_scc1 L_end
  s_mov_b32 s28, s70
  s_mov_b32 s29, s71
  s_load_dwordx2 s[8:9], s[0:1], 40
  s_waitcnt lgkmcnt(0)
  s_and_b32 s9, s9, 0xffff
  s_mov_b32 s10, 5242880
  s_mov_b32 s11, 0x00020000
  s_load_dwordx2 s[12:13], s[0:1], 56
  s_waitcnt lgkmcnt(0)
  s_and_b32 s13, s13, 0xffff
  s_mov_b32 s14, 2621440
  s_mov_b32 s15, 0x00020000
  v_lshrrev_b32 v16, 4, v0
  v_lshrrev_b32 v1, 2, v0
  v_and_b32 v17, 15, v16
  v_lshrrev_b32 v18, 4, v16
  v_lshrrev_b32 v19, 2, v17
  v_and_b32 v20, 3, v17
  s_mul_i32 s32, s29, 163840
  s_mul_i32 s33, s20, 40960
  s_add_u32 s32, s32, s33
  s_add_u32 m0, s33, 0
  s_add_u32 s34, s32, 0
  buffer_load_dwordx4 v0, s[8:11], s34 offen offset:0 lds
  buffer_load_dwordx4 v0, s[8:11], s34 offen offset:1024 lds
  buffer_load_dwordx4 v0, s[8:11], s34 offen offset:2048 lds
  buffer_load_dwordx4 v0, s[8:11], s34 offen offset:3072 lds
  s_add_u32 m0, s33, 4096
  s_add_u32 s34, s32, 4096
  buffer_load_dwordx4 v0, s[8:11], s34 offen offset:0 lds
  buffer_load_dwordx4 v0, s[8:11], s34 offen offset:1024 lds
  buffer_load_dwordx4 v0, s[8:11], s34 offen offset:2048 lds
  buffer_load_dwordx4 v0, s[8:11], s34 offen offset:3072 lds
  s_add_u32 m0, s33, 8192
  s_add_u32 s34, s32, 8192
  buffer_load_dwordx4 v0, s[8:11], s34 offen offset:0 lds
  buffer_load_dwordx4 v0, s[8:11], s34 offen offset:1024 lds
  buffer_load_dwordx4 v0, s[8:11], s34 offen offset:2048 lds
  buffer_load_dwordx4 v0, s[8:11], s34 offen offset:3072 lds
  s_add_u32 m0, s33, 12288
  s_add_u32 s34, s32, 12288
  buffer_load_dwordx4 v0, s[8:11], s34 offen offset:0 lds
  buffer_load_dwordx4 v0, s[8:11], s34 offen offset:1024 lds
  buffer_load_dwordx4 v0, s[8:11], s34 offen offset:2048 lds
  buffer_load_dwordx4 v0, s[8:11], s34 offen offset:3072 lds
  s_add_u32 m0, s33, 16384
  s_add_u32 s34, s32, 16384
  buffer_load_dwordx4 v0, s[8:11], s34 offen offset:0 lds
  buffer_load_dwordx4 v0, s[8:11], s34 offen offset:1024 lds
  buffer_load_dwordx4 v0, s[8:11], s34 offen offset:2048 lds
  buffer_load_dwordx4 v0, s[8:11], s34 offen offset:3072 lds
  s_add_u32 m0, s33, 20480
  s_add_u32 s34, s32, 20480
  buffer_load_dwordx4 v0, s[8:11], s34 offen offset:0 lds
  buffer_load_dwordx4 v0, s[8:11], s34 offen offset:1024 lds
  buffer_load_dwordx4 v0, s[8:11], s34 offen offset:2048 lds
  buffer_load_dwordx4 v0, s[8:11], s34 offen offset:3072 lds
  s_add_u32 m0, s33, 24576
  s_add_u32 s34, s32, 24576
  buffer_load_dwordx4 v0, s[8:11], s34 offen offset:0 lds
  buffer_load_dwordx4 v0, s[8:11], s34 offen offset:1024 lds
  buffer_load_dwordx4 v0, s[8:11], s34 offen offset:2048 lds
  buffer_load_dwordx4 v0, s[8:11], s34 offen offset:3072 lds
  s_add_u32 m0, s33, 28672
  s_add_u32 s34, s32, 28672
  buffer_load_dwordx4 v0, s[8:11], s34 offen offset:0 lds
  buffer_load_dwordx4 v0, s[8:11], s34 offen offset:1024 lds
  buffer_load_dwordx4 v0, s[8:11], s34 offen offset:2048 lds
  buffer_load_dwordx4 v0, s[8:11], s34 offen offset:3072 lds
  s_add_u32 m0, s33, 32768
  s_add_u32 s34, s32, 32768
  buffer_load_dwordx4 v0, s[8:11], s34 offen offset:0 lds
  buffer_load_dwordx4 v0, s[8:11], s34 offen offset:1024 lds
  buffer_load_dwordx4 v0, s[8:11], s34 offen offset:2048 lds
  buffer_load_dwordx4 v0, s[8:11], s34 offen offset:3072 lds
  s_add_u32 m0, s33, 36864
  s_add_u32 s34, s32, 36864
  buffer_load_dwordx4 v0, s[8:11], s34 offen offset:0 lds
  buffer_load_dwordx4 v0, s[8:11], s34 offen offset:1024 lds
  buffer_load_dwordx4 v0, s[8:11], s34 offen offset:2048 lds
  buffer_load_dwordx4 v0, s[8:11], s34 offen offset:3072 lds
  v_and_b32 v21, 1, v19
  v_lshlrev_b32 v21, 2, v21
  v_lshrrev_b32 v22, 3, v17
  v_lshl_add_u32 v21, v22, 1, v21
  v_and_b32 v22, 1, v17
  v_add_u32 v21, v21, v22
  v_lshlrev_b32 v2, 7, v18
  v_lshl_add_u32 v2, v21, 4, v2
  v_lshrrev_b32 v21, 1, v18
  v_and_b32 v22, 1, v18
  v_lshlrev_b32 v3, 8, v21
  v_lshl_add_u32 v3, v17, 4, v3
  v_lshl_add_u32 v3, v22, 3, v3
  s_and_b32 s34, s20, 1
  s_lshl_b32 s35, s34, 10
  s_lshr_b32 s23, s20, 1
  s_lshl_b32 s23, s23, 12
  s_add_u32 s35, s35, s23
  v_add_u32 v3, s35, v3
  v_lshlrev_b32 v4, 6, v17
  v_lshl_add_u32 v4, v18, 4, v4
  s_mov_b32 s23, 40960
  v_mul_lo_u32 v5, v18, s23
  v_lshl_add_u32 v5, v17, 4, v5
  s_movk_i32 s23, 1280
  v_mul_lo_u32 v6, v19, s23
  v_lshl_add_u32 v6, v20, 4, v6
  v_lshl_add_u32 v6, v18, 3, v6
  v_and_b32 v21, 7, v17
  v_mov_b32 v22, 0x3F80
  v_mov_b32 v23, 0x3F800000
  v_mov_b32 v12, 0
  v_mov_b32 v13, 0
  v_mov_b32 v14, 0
  v_mov_b32 v15, 0
  v_cmp_eq_u32 vcc, 0, v21
  s_nop 1
  v_cndmask_b32 v12, v12, v22, vcc
  v_cmp_eq_u32 vcc, 1, v21
  s_nop 1
  v_cndmask_b32 v12, v12, v23, vcc
  v_cmp_eq_u32 vcc, 2, v21
  s_nop 1
  v_cndmask_b32 v13, v13, v22, vcc
  v_cmp_eq_u32 vcc, 3, v21
  s_nop 1
  v_cndmask_b32 v13, v13, v23, vcc
  v_cmp_eq_u32 vcc, 4, v21
  s_nop 1
  v_cndmask_b32 v14, v14, v22, vcc
  v_cmp_eq_u32 vcc, 5, v21
  s_nop 1
  v_cndmask_b32 v14, v14, v23, vcc
  v_cmp_eq_u32 vcc, 6, v21
  s_nop 1
  v_cndmask_b32 v15, v15, v22, vcc
  v_cmp_eq_u32 vcc, 7, v21
  s_nop 1
  v_cndmask_b32 v15, v15, v23, vcc
  v_sub_u32 v21, v19, v18
  v_lshlrev_b32 v21, 3, v21
  v_add_u32 v21, v21, v20
  s_lshl_b32 s23, s34, 2
  v_add_u32 v21, s23, v21
  v_cmp_le_i32 s[36:37], 0, v21
  v_cmp_le_i32 s[38:39], 1, v21
  v_cmp_le_i32 s[40:41], 2, v21
  v_cmp_le_i32 s[42:43], 3, v21
  v_cmp_le_i32 s[44:45], 4, v21
  v_cmp_le_i32 s[46:47], 5, v21
  v_cmp_le_i32 s[48:49], 6, v21
  v_cmp_le_i32 s[50:51], 7, v21
  s_mov_b32 s52, 0x3e0293ee
  s_mov_b32 s56, -1
  s_mov_b32 s57, 0
  v_lshlrev_b32 v21, 3, v18
  v_add_u32 v21, v21, v19
  s_movk_i32 s23, 1280
  v_mul_lo_u32 v21, v21, s23
  v_lshl_add_u32 v21, v20, 4, v21
  s_mul_i32 s23, s20, 320
  v_add_u32 v21, s23, v21
  s_waitcnt vmcnt(0)
  s_barrier
  ds_read_b64_tr_b16 v[96:97], v21 offset:0
  ds_read_b64_tr_b16 v[98:99], v21 offset:5120
  ds_read_b64_tr_b16 v[112:113], v21 offset:8
  ds_read_b64_tr_b16 v[114:115], v21 offset:5128
  ds_read_b64_tr_b16 v[128:129], v21 offset:64
  ds_read_b64_tr_b16 v[130:131], v21 offset:5184
  ds_read_b64_tr_b16 v[144:145], v21 offset:72
  ds_read_b64_tr_b16 v[146:147], v21 offset:5192
  ds_read_b64_tr_b16 v[160:161], v21 offset:128
  ds_read_b64_tr_b16 v[162:163], v21 offset:5248
  ds_read_b64_tr_b16 v[176:177], v21 offset:136
  ds_read_b64_tr_b16 v[178:179], v21 offset:5256
  ds_read_b64_tr_b16 v[192:193], v21 offset:192
  ds_read_b64_tr_b16 v[194:195], v21 offset:5312
  ds_read_b64_tr_b16 v[208:209], v21 offset:200
  ds_read_b64_tr_b16 v[210:211], v21 offset:5320
  ds_read_b64_tr_b16 v[224:225], v21 offset:256
  ds_read_b64_tr_b16 v[226:227], v21 offset:5376
  ds_read_b64_tr_b16 v[240:241], v21 offset:264
  ds_read_b64_tr_b16 v[242:243], v21 offset:5384
  v_add_u32 v21, 40960, v21
  ds_read_b64_tr_b16 v[100:101], v21 offset:0
  ds_read_b64_tr_b16 v[102:103], v21 offset:5120
  ds_read_b64_tr_b16 v[116:117], v21 offset:8
  ds_read_b64_tr_b16 v[118:119], v21 offset:5128
  ds_read_b64_tr_b16 v[132:133], v21 offset:64
  ds_read_b64_tr_b16 v[134:135], v21 offset:5184
  ds_read_b64_tr_b16 v[148:149], v21 offset:72
  ds_read_b64_tr_b16 v[150:151], v21 offset:5192
  ds_read_b64_tr_b16 v[164:165], v21 offset:128
  ds_read_b64_tr_b16 v[166:167], v21 offset:5248
  ds_read_b64_tr_b16 v[180:181], v21 offset:136
  ds_read_b64_tr_b16 v[182:183], v21 offset:5256
  ds_read_b64_tr_b16 v[196:197], v21 offset:192
  ds_read_b64_tr_b16 v[198:199], v21 offset:5312
  ds_read_b64_tr_b16 v[212:213], v21 offset:200
  ds_read_b64_tr_b16 v[214:215], v21 offset:5320
  ds_read_b64_tr_b16 v[228:229], v21 offset:256
  ds_read_b64_tr_b16 v[230:231], v21 offset:5376
  ds_read_b64_tr_b16 v[244:245], v21 offset:264
  ds_read_b64_tr_b16 v[246:247], v21 offset:5384
  v_add_u32 v21, 40960, v21
  ds_read_b64_tr_b16 v[104:105], v21 offset:0
  ds_read_b64_tr_b16 v[106:107], v21 offset:5120
  ds_read_b64_tr_b16 v[120:121], v21 offset:8
  ds_read_b64_tr_b16 v[122:123], v21 offset:5128
  ds_read_b64_tr_b16 v[136:137], v21 offset:64
  ds_read_b64_tr_b16 v[138:139], v21 offset:5184
  ds_read_b64_tr_b16 v[152:153], v21 offset:72
  ds_read_b64_tr_b16 v[154:155], v21 offset:5192
  ds_read_b64_tr_b16 v[168:169], v21 offset:128
  ds_read_b64_tr_b16 v[170:171], v21 offset:5248
  ds_read_b64_tr_b16 v[184:185], v21 offset:136
  ds_read_b64_tr_b16 v[186:187], v21 offset:5256
  ds_read_b64_tr_b16 v[200:201], v21 offset:192
  ds_read_b64_tr_b16 v[202:203], v21 offset:5312
  ds_read_b64_tr_b16 v[216:217], v21 offset:200
  ds_read_b64_tr_b16 v[218:219], v21 offset:5320
  ds_read_b64_tr_b16 v[232:233], v21 offset:256
  ds_read_b64_tr_b16 v[234:235], v21 offset:5376
  ds_read_b64_tr_b16 v[248:249], v21 offset:264
  ds_read_b64_tr_b16 v[250:251], v21 offset:5384
  v_add_u32 v21, 40960, v21
  ds_read_b64_tr_b16 v[108:109], v21 offset:0
  ds_read_b64_tr_b16 v[110:111], v21 offset:5120
  ds_read_b64_tr_b16 v[124:125], v21 offset:8
  ds_read_b64_tr_b16 v[126:127], v21 offset:5128
  ds_read_b64_tr_b16 v[140:141], v21 offset:64
  ds_read_b64_tr_b16 v[142:143], v21 offset:5184
  ds_read_b64_tr_b16 v[156:157], v21 offset:72
  ds_read_b64_tr_b16 v[158:159], v21 offset:5192
  ds_read_b64_tr_b16 v[172:173], v21 offset:128
  ds_read_b64_tr_b16 v[174:175], v21 offset:5248
  ds_read_b64_tr_b16 v[188:189], v21 offset:136
  ds_read_b64_tr_b16 v[190:191], v21 offset:5256
  ds_read_b64_tr_b16 v[204:205], v21 offset:192
  ds_read_b64_tr_b16 v[206:207], v21 offset:5312
  ds_read_b64_tr_b16 v[220:221], v21 offset:200
  ds_read_b64_tr_b16 v[222:223], v21 offset:5320
  ds_read_b64_tr_b16 v[236:237], v21 offset:256
  ds_read_b64_tr_b16 v[238:239], v21 offset:5376
  ds_read_b64_tr_b16 v[252:253], v21 offset:264
  ds_read_b64_tr_b16 v[254:255], v21 offset:5384
  s_waitcnt lgkmcnt(0)
  s_barrier
  s_lshl_b32 s54, s28, 22
  s_add_u32 s54, s54, 0x6000000
  s_mul_i32 s53, s29, 40960
  s_mul_i32 s23, s20, 5120
  s_add_u32 s53, s53, s23
  s_add_u32 s53, s53, s54
  s_mov_b32 s30, s28
  s_mov_b32 s31, 0
  s_lshl_b32 s66, s29, 7
  s_lshl_b32 s23, s28, 12
  s_add_u32 s66, s66, s23
  s_add_u32 s66, s66, 0x4170000
  s_lshl_b32 s67, s28, 7
  s_add_u32 s67, s67, 0x4180000
  s_cmp_lg_u32 s20, 0
  s_cbranch_scc1 L_en_s1
  s_lshl_b32 s32, s28, 2
  s_add_u32 s32, s32, 192
  s_mov_b32 s33, 32
  v_mov_b32 v8, s32
  s_mov_b32 s22, 0
L_en_i1:
  global_load_dword v9, v8, s[16:17] sc1
  s_add_u32 s22, s22, 1
  s_cmp_gt_u32 s22, 200000
  s_cbranch_scc1 L_fail
  s_waitcnt vmcnt(0)
  v_readfirstlane_b32 s23, v9
  s_cmp_ge_u32 s23, s33
  s_cbranch_scc1 L_en_i1_ok
  s_sleep 8
  s_branch L_en_i1
L_en_i1_ok:
  s_mov_b32 s32, 52
  s_mov_b32 s33, 64
  v_mov_b32 v8, s32
  s_mov_b32 s22, 0
L_en_i2:
  global_load_dword v9, v8, s[16:17] sc1
  s_add_u32 s22, s22, 1
  s_cmp_gt_u32 s22, 200000
  s_cbranch_scc1 L_fail
  s_waitcnt vmcnt(0)
  v_readfirstlane_b32 s23, v9
  s_cmp_ge_u32 s23, s33
  s_cbranch_scc1 L_en_i2_ok
  s_sleep 8
  s_branch L_en_i2
L_en_i2_ok:
L_en_s1:
L_en_loop:
  s_cmp_ge_u32 s30, 64
  s_cbranch_scc1 L_end
  s_cmp_lg_u32 s20, 0
  s_cbranch_scc1 L_en_go
  s_sub_u32 s23, s30, 18
  s_lshr_b32 s23, s23, 2
  s_add_u32 s32, s23, 12
  s_add_u32 s23, s30, 6
  s_lshr_b32 s23, s23, 1
  s_cmp_lt_u32 s30, 18
  s_cselect_b32 s32, s23, s32
  s_cmp_lt_u32 s30, 6
  s_cselect_b32 s32, s30, s32
  s_lshl_b32 s32, s32, 2
  s_add_u32 s32, s32, 64
  s_mov_b32 s33, 32
  v_mov_b32 v8, s32
  s_mov_b32 s22, 0
L_en_w1:
  global_load_dword v9, v8, s[16:17] sc1
  s_add_u32 s22, s22, 1
  s_cmp_gt_u32 s22, 200000
  s_cbranch_scc1 L_fail
  s_waitcnt vmcnt(0)
  v_readfirstlane_b32 s23, v9
  s_cmp_ge_u32 s23, s33
  s_cbranch_scc1 L_en_w1_ok
  s_sleep 16
  s_branch L_en_w1
L_en_w1_ok:
L_en_go:
  s_barrier
  s_lshl_b32 s32, s30, 5
  s_add_u32 s32, s32, s29
  s_lshl_b32 s33, s32, 11
  s_lshl_b32 s32, s32, 13
  s_add_u32 s58, s32, 4096
  buffer_load_dwordx4 v[16:19], v0, s[4:7], s32 offen offset:0 sc1
  buffer_load_dwordx4 v[20:23], v0, s[4:7], s32 offen offset:1024 sc1
  buffer_load_dwordx4 v[24:27], v0, s[4:7], s32 offen offset:2048 sc1
  buffer_load_dwordx4 v[28:31], v0, s[4:7], s32 offen offset:3072 sc1
  buffer_load_dwordx4 v[32:35], v0, s[4:7], s58 offen offset:0 sc1
  buffer_load_dwordx4 v[36:39], v0, s[4:7], s58 offen offset:1024 sc1
  buffer_load_dwordx4 v[40:43], v0, s[4:7], s58 offen offset:2048 sc1
  buffer_load_dwordx4 v[44:47], v0, s[4:7], s58 offen offset:3072 sc1
  s_and_b32 s23, s20, 1
  s_lshl_b32 s23, s23, 10
  s_add_u32 s59, s32, s23
  s_add_u32 s59, s59, 0x2000000
  s_add_u32 s60, s59, 4096
  buffer_load_dwordx4 v[48:51], v0, s[4:7], s59 offen offset:0 sc1
  buffer_load_dwordx4 v[52:55], v0, s[4:7], s59 offen offset:2048 sc1
  buffer_load_dwordx4 v[56:59], v0, s[4:7], s60 offen offset:0 sc1
  buffer_load_dwordx4 v[60:63], v0, s[4:7], s60 offen offset:2048 sc1
  s_lshr_b32 s23, s20, 1
  s_lshl_b32 s62, s23, 10
  s_lshl_b32 s23, s23, 12
  s_add_u32 s61, s32, s23
  s_add_u32 s61, s61, 0x1000000
  buffer_load_dwordx4 v[80:83], v0, s[4:7], s61 offen offset:0 sc1
  buffer_load_dwordx4 v[84:87], v0, s[4:7], s61 offen offset:1024 sc1
  buffer_load_dwordx4 v[88:91], v0, s[4:7], s61 offen offset:2048 sc1
  buffer_load_dwordx4 v[92:95], v0, s[4:7], s61 offen offset:3072 sc1
  s_cmp_lg_u32 s20, 0
  s_cbranch_scc1 L_en_go2
  s_add_u32 s35, s30, 1
  s_mov_b32 s22, 0
  s_mov_b64 exec, 0x3
L_en_w2:
  buffer_load_dword v9, v1, s[4:7], s66 offen sc1
  s_add_u32 s22, s22, 1
  s_cmp_gt_u32 s22, 200000
  s_cbranch_scc1 L_fail
  s_waitcnt vmcnt(0)
  v_cmp_gt_u32 vcc, s35, v9
  s_cbranch_vccz L_en_w2_ok
  s_sleep 3
  s_branch L_en_w2
L_en_w2_ok:
  s_mov_b64 exec, -1
L_en_go2:
  s_barrier
  s_add_u32 s63, s33, 0x3000000
  buffer_load_dwordx4 v[64:67], v2, s[4:7], s63 offen offset:0 sc1
  buffer_load_dwordx4 v[68:71], v2, s[4:7], s63 offen offset:512 sc1
  buffer_load_dwordx4 v[72:75], v2, s[4:7], s63 offen offset:1024 sc1
  buffer_load_dwordx4 v[76:79], v2, s[4:7], s63 offen offset:1536 sc1
  s_add_u32 s62, s62, s33
  s_add_u32 s62, s62, 0x3400000
  v_accvgpr_write_b32 a97, 0
  v_accvgpr_write_b32 a99, 0
  v_accvgpr_write_b32 a101, 0
  v_accvgpr_write_b32 a103, 0
  buffer_load_dword a96, v1, s[4:7], s62 offen offset:0 sc1
  buffer_load_dword a98, v1, s[4:7], s62 offen offset:256 sc1
  buffer_load_dword a100, v1, s[4:7], s62 offen offset:512 sc1
  buffer_load_dword a102, v1, s[4:7], s62 offen offset:768 sc1
  s_waitcnt vmcnt(15)
  v_mfma_f32_16x16x32_bf16 a[104:107], v[16:19], v[48:51], 0
  v_mfma_f32_16x16x32_bf16 a[108:111], v[20:23], v[48:51], 0
  s_waitcnt vmcnt(14)
  v_mfma_f32_16x16x32_bf16 a[104:107], v[24:27], v[52:55], a[104:107]
  v_mfma_f32_16x16x32_bf16 a[108:111], v[28:31], v[52:55], a[108:111]
  s_waitcnt vmcnt(13)
  v_mfma_f32_16x16x32_bf16 a[104:107], v[32:35], v[56:59], a[104:107]
  v_mfma_f32_16x16x32_bf16 a[108:111], v[36:39], v[56:59], a[108:111]
  s_waitcnt vmcnt(12)
  v_mfma_f32_16x16x32_bf16 a[104:107], v[40:43], v[60:63], a[104:107]
  v_mfma_f32_16x16x32_bf16 a[108:111], v[44:47], v[60:63], a[108:111]
  s_waitcnt vmcnt(7)
  v_mfma_f32_16x16x32_bf16 a[112:115], v[64:67], v[48:51], 0
  s_waitcnt vmcnt(6)
  v_mfma_f32_16x16x32_bf16 a[112:115], v[68:71], v[52:55], a[112:115]
  s_waitcnt vmcnt(5)
  v_mfma_f32_16x16x32_bf16 a[112:115], v[72:75], v[56:59], a[112:115]
  s_waitcnt vmcnt(4)
  v_mfma_f32_16x16x32_bf16 a[112:115], v[76:79], v[60:63], a[112:115]
  v_mov_b32 v10, 0xf149f2ca
  v_accvgpr_read_b32 v16, a104
  v_accvgpr_read_b32 v17, a105
  v_accvgpr_read_b32 v18, a106
  v_accvgpr_read_b32 v19, a107
  v_accvgpr_read_b32 v20, a108
  v_accvgpr_read_b32 v21, a109
  v_accvgpr_read_b32 v22, a110
  v_accvgpr_read_b32 v23, a111
  v_accvgpr_read_b32 v24, a112
  v_accvgpr_read_b32 v25, a113
  v_cndmask_b32 v16, v10, v16, s[36:37]
  v_cndmask_b32 v17, v10, v17, s[38:39]
  v_cndmask_b32 v18, v10, v18, s[40:41]
  v_cndmask_b32 v19, v10, v19, s[42:43]
  v_cndmask_b32 v20, v10, v20, s[44:45]
  v_cndmask_b32 v21, v10, v21, s[46:47]
  v_cndmask_b32 v22, v10, v22, s[48:49]
  v_cndmask_b32 v23, v10, v23, s[50:51]
  v_max3_f32 v8, v16, v17, v18
  v_max3_f32 v9, v19, v20, v21
  v_max3_f32 v8, v8, v22, v23
  v_max3_f32 v9, v9, v24, v25
  v_max_f32 v8, v8, v9
  v_mov_b32 v9, v8
  s_nop 1
  v_permlane16_swap_b32 v8, v9
  v_max_f32 v8, v8, v9
  v_mov_b32 v9, v8
  s_nop 1
  v_permlane32_swap_b32 v8, v9
  v_max_f32 v8, v8, v9
  v_mul_f32 v8, s52, v8
  v_fma_f32 v16, v16, s52, -v8
  v_fma_f32 v17, v17, s52, -v8
  v_fma_f32 v18, v18, s52, -v8
  v_fma_f32 v19, v19, s52, -v8
  v_fma_f32 v20, v20, s52, -v8
  v_fma_f32 v21, v21, s52, -v8
  v_fma_f32 v22, v22, s52, -v8
  v_fma_f32 v23, v23, s52, -v8
  v_fma_f32 v24, v24, s52, -v8
  v_fma_f32 v25, v25, s52, -v8
  v_exp_f32 v16, v16
  v_exp_f32 v17, v17
  v_exp_f32 v18, v18
  v_exp_f32 v19, v19
  v_exp_f32 v20, v20
  v_exp_f32 v21, v21
  v_exp_f32 v22, v22
  v_exp_f32 v23, v23
  v_exp_f32 v24, v24
  v_exp_f32 v25, v25
  v_cvt_pk_bf16_f32 v28, v16, v17
  v_cvt_pk_bf16_f32 v29, v18, v19
  v_cvt_pk_bf16_f32 v30, v20, v21
  v_cvt_pk_bf16_f32 v31, v22, v23
  v_cvt_pk_bf16_f32 v32, v24, v25
  v_mov_b32 v33, 0
  v_add_f32 v8, v16, v17
  v_add_f32 v8, v8, v18
  v_add_f32 v8, v8, v19
  v_add_f32 v8, v8, v20
  v_add_f32 v8, v8, v21
  v_add_f32 v8, v8, v22
  v_add_f32 v8, v8, v23
  v_add_f32 v8, v8, v24
  v_add_f32 v8, v8, v25
  s_waitcnt vmcnt(0)
  v_mfma_f32_16x16x32_bf16 v[48:51], v[80:83], v[28:31], 0
  v_mfma_f32_16x16x32_bf16 v[52:55], v[84:87], v[28:31], 0
  v_mfma_f32_16x16x32_bf16 v[56:59], v[88:91], v[28:31], 0
  v_mfma_f32_16x16x32_bf16 v[60:63], v[92:95], v[28:31], 0
  v_mfma_f32_16x16x16_bf16 v[64:67], a[96:97], v[32:33], 0
  v_mfma_f32_16x16x16_bf16 v[68:71], a[98:99], v[32:33], 0
  v_mfma_f32_16x16x16_bf16 v[72:75], a[100:101], v[32:33], 0
  v_mfma_f32_16x16x16_bf16 v[76:79], a[102:103], v[32:33], 0
  v_mov_b32 v9, v8
  s_nop 1
  v_permlane16_swap_b32 v8, v9
  v_add_f32 v8, v8, v9
  v_mov_b32 v9, v8
  s_nop 1
  v_permlane32_swap_b32 v8, v9
  v_add_f32 v8, v8, v9
  v_rcp_f32 v8, v8
  v_add_f32 v48, v48, v64
  v_mul_f32 v48, v48, v8
  v_add_f32 v49, v49, v65
  v_mul_f32 v49, v49, v8
  v_add_f32 v50, v50, v66
  v_mul_f32 v50, v50, v8
  v_add_f32 v51, v51, v67
  v_mul_f32 v51, v51, v8
  v_cvt_pk_bf16_f32 v48, v48, v49
  v_cvt_pk_bf16_f32 v49, v50, v51
  ds_write_b64 v3, v[48:49] offset:0
  v_add_f32 v52, v52, v68
  v_mul_f32 v52, v52, v8
  v_add_f32 v53, v53, v69
  v_mul_f32 v53, v53, v8
  v_add_f32 v54, v54, v70
  v_mul_f32 v54, v54, v8
  v_add_f32 v55, v55, v71
  v_mul_f32 v55, v55, v8
  v_cvt_pk_bf16_f32 v52, v52, v53
  v_cvt_pk_bf16_f32 v53, v54, v55
  ds_write_b64 v3, v[52:53] offset:512
  v_add_f32 v56, v56, v72
  v_mul_f32 v56, v56, v8
  v_add_f32 v57, v57, v73
  v_mul_f32 v57, v57, v8
  v_add_f32 v58, v58, v74
  v_mul_f32 v58, v58, v8
  v_add_f32 v59, v59, v75
  v_mul_f32 v59, v59, v8
  v_cvt_pk_bf16_f32 v56, v56, v57
  v_cvt_pk_bf16_f32 v57, v58, v59
  ds_write_b64 v3, v[56:57] offset:2048
  v_add_f32 v60, v60, v76
  v_mul_f32 v60, v60, v8
  v_add_f32 v61, v61, v77
  v_mul_f32 v61, v61, v8
  v_add_f32 v62, v62, v78
  v_mul_f32 v62, v62, v8
  v_add_f32 v63, v63, v79
  v_mul_f32 v63, v63, v8
  v_cvt_pk_bf16_f32 v60, v60, v61
  v_cvt_pk_bf16_f32 v61, v62, v63
  ds_write_b64 v3, v[60:61] offset:2560
  s_waitcnt lgkmcnt(0)
  s_barrier
  ds_read_b128 v[16:19], v0 offset:0
  ds_read_b128 v[20:23], v0 offset:1024
  ds_read_b128 v[24:27], v0 offset:2048
  ds_read_b128 v[28:31], v0 offset:3072
  ds_read_b128 v[32:35], v0 offset:4096
  ds_read_b128 v[36:39], v0 offset:5120
  ds_read_b128 v[40:43], v0 offset:6144
  ds_read_b128 v[44:47], v0 offset:7168
  s_add_u32 s58, s53, 4096
  s_add_u32 s59, s53, 20480
  s_add_u32 s60, s53, 24576
  s_waitcnt lgkmcnt(7)
  v_mfma_f32_16x16x32_bf16 a[0:3], v[96:99], v[16:19], 0
  v_mfma_f32_16x16x32_bf16 a[4:7], v[112:115], v[16:19], 0
  s_waitcnt lgkmcnt(6)
  v_mfma_f32_16x16x32_bf16 a[8:11], v[96:99], v[20:23], 0
  v_mfma_f32_16x16x32_bf16 a[12:15], v[112:115], v[20:23], 0
  s_waitcnt lgkmcnt(5)
  v_mfma_f32_16x16x32_bf16 a[0:3], v[100:103], v[24:27], a[0:3]
  v_mfma_f32_16x16x32_bf16 a[4:7], v[116:119], v[24:27], a[4:7]
  s_waitcnt lgkmcnt(4)
  v_mfma_f32_16x16x32_bf16 a[8:11], v[100:103], v[28:31], a[8:11]
  v_mfma_f32_16x16x32_bf16 a[12:15], v[116:119], v[28:31], a[12:15]
  s_waitcnt lgkmcnt(3)
  v_mfma_f32_16x16x32_bf16 a[0:3], v[104:107], v[32:35], a[0:3]
  v_mfma_f32_16x16x32_bf16 a[4:7], v[120:123], v[32:35], a[4:7]
  s_waitcnt lgkmcnt(2)
  v_mfma_f32_16x16x32_bf16 a[8:11], v[104:107], v[36:39], a[8:11]
  v_mfma_f32_16x16x32_bf16 a[12:15], v[120:123], v[36:39], a[12:15]
  s_waitcnt lgkmcnt(1)
  v_mfma_f32_16x16x32_bf16 a[0:3], v[108:111], v[40:43], a[0:3]
  v_mfma_f32_16x16x32_bf16 a[4:7], v[124:127], v[40:43], a[4:7]
  s_waitcnt lgkmcnt(0)
  v_mfma_f32_16x16x32_bf16 a[8:11], v[108:111], v[44:47], a[8:11]
  v_mfma_f32_16x16x32_bf16 a[12:15], v[124:127], v[44:47], a[12:15]
  v_mfma_f32_16x16x32_bf16 a[16:19], v[128:131], v[16:19], 0
  v_mfma_f32_16x16x32_bf16 a[20:23], v[144:147], v[16:19], 0
  v_mfma_f32_16x16x32_bf16 a[24:27], v[128:131], v[20:23], 0
  s_nop 0
  v_accvgpr_read_b32 v52, a0
  v_accvgpr_read_b32 v53, a1
  v_mfma_f32_16x16x32_bf16 a[28:31], v[144:147], v[20:23], 0
  v_accvgpr_read_b32 v54, a2
  v_accvgpr_read_b32 v55, a3
  v_mfma_f32_16x16x32_bf16 a[16:19], v[132:135], v[24:27], a[16:19]
  v_accvgpr_read_b32 v56, a4
  v_accvgpr_read_b32 v57, a5
  v_mfma_f32_16x16x32_bf16 a[20:23], v[148:151], v[24:27], a[20:23]
  v_accvgpr_read_b32 v58, a6
  v_accvgpr_read_b32 v59, a7
  v_mfma_f32_16x16x32_bf16 a[24:27], v[132:135], v[28:31], a[24:27]
  v_cvt_pk_bf16_f32 v48, v52, v53
  v_cvt_pk_bf16_f32 v49, v54, v55
  v_mfma_f32_16x16x32_bf16 a[28:31], v[148:151], v[28:31], a[28:31]
  v_cvt_pk_bf16_f32 v50, v56, v57
  v_cvt_pk_bf16_f32 v51, v58, v59
  v_mfma_f32_16x16x32_bf16 a[16:19], v[136:139], v[32:35], a[16:19]
  buffer_store_dwordx4 v[48:51], v4, s[4:7], s53 offen offset:0
  v_accvgpr_read_b32 v64, a8
  v_mfma_f32_16x16x32_bf16 a[20:23], v[152:155], v[32:35], a[20:23]
  v_accvgpr_read_b32 v65, a9
  v_accvgpr_read_b32 v66, a10
  v_mfma_f32_16x16x32_bf16 a[24:27], v[136:139], v[36:39], a[24:27]
  v_accvgpr_read_b32 v67, a11
  v_accvgpr_read_b32 v68, a12
  v_mfma_f32_16x16x32_bf16 a[28:31], v[152:155], v[36:39], a[28:31]
  v_accvgpr_read_b32 v69, a13
  v_accvgpr_read_b32 v70, a14
  v_mfma_f32_16x16x32_bf16 a[16:19], v[140:143], v[40:43], a[16:19]
  v_accvgpr_read_b32 v71, a15
  v_cvt_pk_bf16_f32 v60, v64, v65
  v_mfma_f32_16x16x32_bf16 a[20:23], v[156:159], v[40:43], a[20:23]
  v_cvt_pk_bf16_f32 v61, v66, v67
  v_cvt_pk_bf16_f32 v62, v68, v69
  v_mfma_f32_16x16x32_bf16 a[24:27], v[140:143], v[44:47], a[24:27]
  v_cvt_pk_bf16_f32 v63, v70, v71
  buffer_store_dwordx4 v[60:63], v4, s[4:7], s59 offen offset:0
  v_mfma_f32_16x16x32_bf16 a[28:31], v[156:159], v[44:47], a[28:31]
  v_mfma_f32_16x16x32_bf16 a[32:35], v[160:163], v[16:19], 0
  v_mfma_f32_16x16x32_bf16 a[36:39], v[176:179], v[16:19], 0
  v_mfma_f32_16x16x32_bf16 a[40:43], v[160:163], v[20:23], 0
  v_accvgpr_read_b32 v76, a16
  v_accvgpr_read_b32 v77, a17
  v_mfma_f32_16x16x32_bf16 a[44:47], v[176:179], v[20:23], 0
  v_accvgpr_read_b32 v78, a18
  v_accvgpr_read_b32 v79, a19
  v_mfma_f32_16x16x32_bf16 a[32:35], v[164:167], v[24:27], a[32:35]
  v_accvgpr_read_b32 v80, a20
  v_accvgpr_read_b32 v81, a21
  v_mfma_f32_16x16x32_bf16 a[36:39], v[180:183], v[24:27], a[36:39]
  v_accvgpr_read_b32 v82, a22
  v_accvgpr_read_b32 v83, a23
  v_mfma_f32_16x16x32_bf16 a[40:43], v[164:167], v[28:31], a[40:43]
  v_cvt_pk_bf16_f32 v72, v76, v77
  v_cvt_pk_bf16_f32 v73, v78, v79
  v_mfma_f32_16x16x32_bf16 a[44:47], v[180:183], v[28:31], a[44:47]
  v_cvt_pk_bf16_f32 v74, v80, v81
  v_cvt_pk_bf16_f32 v75, v82, v83
  v_mfma_f32_16x16x32_bf16 a[32:35], v[168:171], v[32:35], a[32:35]
  buffer_store_dwordx4 v[72:75], v4, s[4:7], s53 offen offset:1024
  v_accvgpr_read_b32 v88, a24
  v_mfma_f32_16x16x32_bf16 a[36:39], v[184:187], v[32:35], a[36:39]
  v_accvgpr_read_b32 v89, a25
  v_accvgpr_read_b32 v90, a26
  v_mfma_f32_16x16x32_bf16 a[40:43], v[168:171], v[36:39], a[40:43]
  v_accvgpr_read_b32 v91, a27
  v_accvgpr_read_b32 v92, a28
  v_mfma_f32_16x16x32_bf16 a[44:47], v[184:187], v[36:39], a[44:47]
  v_accvgpr_read_b32 v93, a29
  v_accvgpr_read_b32 v94, a30
  v_mfma_f32_16x16x32_bf16 a[32:35], v[172:175], v[40:43], a[32:35]
  v_accvgpr_read_b32 v95, a31
  v_cvt_pk_bf16_f32 v84, v88, v89
  v_mfma_f32_16x16x32_bf16 a[36:39], v[188:191], v[40:43], a[36:39]
  v_cvt_pk_bf16_f32 v85, v90, v91
  v_cvt_pk_bf16_f32 v86, v92, v93
  v_mfma_f32_16x16x32_bf16 a[40:43], v[172:175], v[44:47], a[40:43]
  v_cvt_pk_bf16_f32 v87, v94, v95
  buffer_store_dwordx4 v[84:87], v4, s[4:7], s59 offen offset:1024
  v_mfma_f32_16x16x32_bf16 a[44:47], v[188:191], v[44:47], a[44:47]
  v_mfma_f32_16x16x32_bf16 a[48:51], v[192:195], v[16:19], 0
  v_mfma_f32_16x16x32_bf16 a[52:55], v[208:211], v[16:19], 0
  v_mfma_f32_16x16x32_bf16 a[56:59], v[192:195], v[20:23], 0
  v_accvgpr_read_b32 v52, a32
  v_accvgpr_read_b32 v53, a33
  v_mfma_f32_16x16x32_bf16 a[60:63], v[208:211], v[20:23], 0
  v_accvgpr_read_b32 v54, a34
  v_accvgpr_read_b32 v55, a35
  v_mfma_f32_16x16x32_bf16 a[48:51], v[196:199], v[24:27], a[48:51]
  v_accvgpr_read_b32 v56, a36
  v_accvgpr_read_b32 v57, a37
  v_mfma_f32_16x16x32_bf16 a[52:55], v[212:215], v[24:27], a[52:55]
  v_accvgpr_read_b32 v58, a38
  v_accvgpr_read_b32 v59, a39
  v_mfma_f32_16x16x32_bf16 a[56:59], v[196:199], v[28:31], a[56:59]
  v_cvt_pk_bf16_f32 v48, v52, v53
  v_cvt_pk_bf16_f32 v49, v54, v55
  v_mfma_f32_16x16x32_bf16 a[60:63], v[212:215], v[28:31], a[60:63]
  v_cvt_pk_bf16_f32 v50, v56, v57
  v_cvt_pk_bf16_f32 v51, v58, v59
  v_mfma_f32_16x16x32_bf16 a[48:51], v[200:203], v[32:35], a[48:51]
  buffer_store_dwordx4 v[48:51], v4, s[4:7], s53 offen offset:2048
  v_accvgpr_read_b32 v64, a40
  v_mfma_f32_16x16x32_bf16 a[52:55], v[216:219], v[32:35], a[52:55]
  v_accvgpr_read_b32 v65, a41
  v_accvgpr_read_b32 v66, a42
  v_mfma_f32_16x16x32_bf16 a[56:59], v[200:203], v[36:39], a[56:59]
  v_accvgpr_read_b32 v67, a43
  v_accvgpr_read_b32 v68, a44
  v_mfma_f32_16x16x32_bf16 a[60:63], v[216:219], v[36:39], a[60:63]
  v_accvgpr_read_b32 v69, a45
  v_accvgpr_read_b32 v70, a46
  v_mfma_f32_16x16x32_bf16 a[48:51], v[204:207], v[40:43], a[48:51]
  v_accvgpr_read_b32 v71, a47
  v_cvt_pk_bf16_f32 v60, v64, v65
  v_mfma_f32_16x16x32_bf16 a[52:55], v[220:223], v[40:43], a[52:55]
  v_cvt_pk_bf16_f32 v61, v66, v67
  v_cvt_pk_bf16_f32 v62, v68, v69
  v_mfma_f32_16x16x32_bf16 a[56:59], v[204:207], v[44:47], a[56:59]
  v_cvt_pk_bf16_f32 v63, v70, v71
  buffer_store_dwordx4 v[60:63], v4, s[4:7], s59 offen offset:2048
  v_mfma_f32_16x16x32_bf16 a[60:63], v[220:223], v[44:47], a[60:63]
  v_mfma_f32_16x16x32_bf16 a[64:67], v[224:227], v[16:19], 0
  v_mfma_f32_16x16x32_bf16 a[68:71], v[240:243], v[16:19], 0
  v_mfma_f32_16x16x32_bf16 a[72:75], v[224:227], v[20:23], 0
  v_accvgpr_read_b32 v76, a48
  v_accvgpr_read_b32 v77, a49
  v_mfma_f32_16x16x32_bf16 a[76:79], v[240:243], v[20:23], 0
  v_accvgpr_read_b32 v78, a50
  v_accvgpr_read_b32 v79, a51
  v_mfma_f32_16x16x32_bf16 a[64:67], v[228:231], v[24:27], a[64:67]
  v_accvgpr_read_b32 v80, a52
  v_accvgpr_read_b32 v81, a53
  v_mfma_f32_16x16x32_bf16 a[68:71], v[244:247], v[24:27], a[68:71]
  v_accvgpr_read_b32 v82, a54
  v_accvgpr_read_b32 v83, a55
  v_mfma_f32_16x16x32_bf16 a[72:75], v[228:231], v[28:31], a[72:75]
  v_cvt_pk_bf16_f32 v72, v76, v77
  v_cvt_pk_bf16_f32 v73, v78, v79
  v_mfma_f32_16x16x32_bf16 a[76:79], v[244:247], v[28:31], a[76:79]
  v_cvt_pk_bf16_f32 v74, v80, v81
  v_cvt_pk_bf16_f32 v75, v82, v83
  v_mfma_f32_16x16x32_bf16 a[64:67], v[232:235], v[32:35], a[64:67]
  buffer_store_dwordx4 v[72:75], v4, s[4:7], s53 offen offset:3072
  v_accvgpr_read_b32 v88, a56
  v_mfma_f32_16x16x32_bf16 a[68:71], v[248:251], v[32:35], a[68:71]
  v_accvgpr_read_b32 v89, a57
  v_accvgpr_read_b32 v90, a58
  v_mfma_f32_16x16x32_bf16 a[72:75], v[232:235], v[36:39], a[72:75]
  v_accvgpr_read_b32 v91, a59
  v_accvgpr_read_b32 v92, a60
  v_mfma_f32_16x16x32_bf16 a[76:79], v[248:251], v[36:39], a[76:79]
  v_accvgpr_read_b32 v93, a61
  v_accvgpr_read_b32 v94, a62
  v_mfma_f32_16x16x32_bf16 a[64:67], v[236:239], v[40:43], a[64:67]
  v_accvgpr_read_b32 v95, a63
  v_cvt_pk_bf16_f32 v84, v88, v89
  v_mfma_f32_16x16x32_bf16 a[68:71], v[252:255], v[40:43], a[68:71]
  v_cvt_pk_bf16_f32 v85, v90, v91
  v_cvt_pk_bf16_f32 v86, v92, v93
  v_mfma_f32_16x16x32_bf16 a[72:75], v[236:239], v[44:47], a[72:75]
  v_cvt_pk_bf16_f32 v87, v94, v95
  buffer_store_dwordx4 v[84:87], v4, s[4:7], s59 offen offset:3072
  v_mfma_f32_16x16x32_bf16 a[76:79], v[252:255], v[44:47], a[76:79]
  v_accvgpr_read_b32 v52, a64
  v_accvgpr_read_b32 v53, a65
  v_accvgpr_read_b32 v54, a66
  v_accvgpr_read_b32 v55, a67
  v_accvgpr_read_b32 v56, a68
  v_accvgpr_read_b32 v57, a69
  v_accvgpr_read_b32 v58, a70
  v_accvgpr_read_b32 v59, a71
  v_cvt_pk_bf16_f32 v48, v52, v53
  v_cvt_pk_bf16_f32 v49, v54, v55
  v_cvt_pk_bf16_f32 v50, v56, v57
  v_cvt_pk_bf16_f32 v51, v58, v59
  buffer_store_dwordx4 v[48:51], v4, s[4:7], s58 offen offset:0
  v_accvgpr_read_b32 v64, a72
  v_accvgpr_read_b32 v65, a73
  v_accvgpr_read_b32 v66, a74
  v_accvgpr_read_b32 v67, a75
  v_accvgpr_read_b32 v68, a76
  v_accvgpr_read_b32 v69, a77
  v_accvgpr_read_b32 v70, a78
  v_accvgpr_read_b32 v71, a79
  v_cvt_pk_bf16_f32 v60, v64, v65
  v_cvt_pk_bf16_f32 v61, v66, v67
  v_cvt_pk_bf16_f32 v62, v68, v69
  v_cvt_pk_bf16_f32 v63, v70, v71
  buffer_store_dwordx4 v[60:63], v4, s[4:7], s60 offen offset:0
  s_waitcnt vmcnt(0)
  s_barrier
  s_add_u32 s31, s31, 1
  s_cmp_lg_u32 s20, 0
  s_cbranch_scc1 L_en_nosig
  s_lshl_b32 s32, s29, 2
  s_add_u32 s32, s32, s67
  v_mov_b32 v8, s31
  s_mov_b64 exec, 1
  buffer_store_dword v8, v1, s[4:7], s32 offen
  s_mov_b32 s22, 0
  s_mov_b64 exec, 0xffffffff
L_en_w3:
  buffer_load_dword v9, v1, s[4:7], s67 offen sc1
  s_add_u32 s22, s22, 1
  s_cmp_gt_u32 s22, 200000
  s_cbranch_scc1 L_fail
  s_waitcnt vmcnt(0)
  v_cmp_gt_u32 vcc, s31, v9
  s_cbranch_vccz L_en_w3_ok
  s_sleep 1
  s_branch L_en_w3
L_en_w3_ok:
  s_mov_b64 exec, -1
L_en_nosig:
  s_barrier
  s_lshl_b32 s55, s29, 2
  s_add_u32 s55, s55, s20
L_en_job:
  s_lshl_b32 s32, s55, 8
  s_add_u32 s32, s32, s54
  buffer_load_dwordx4 v[16:19], v5, s[4:7], s32 offen sc1
  s_add_u32 s32, s32, 163840
  buffer_load_dwordx4 v[20:23], v5, s[4:7], s32 offen sc1
  s_add_u32 s32, s32, 163840
  buffer_load_dwordx4 v[24:27], v5, s[4:7], s32 offen sc1
  s_add_u32 s32, s32, 163840
  buffer_load_dwordx4 v[28:31], v5, s[4:7], s32 offen sc1
  s_add_u32 s32, s32, 163840
  buffer_load_dwordx4 v[32:35], v5, s[4:7], s32 offen sc1
  s_add_u32 s32, s32, 163840
  buffer_load_dwordx4 v[36:39], v5, s[4:7], s32 offen sc1
  s_add_u32 s32, s32, 163840
  buffer_load_dwordx4 v[40:43], v5, s[4:7], s32 offen sc1
  s_add_u32 s32, s32, 163840
  buffer_load_dwordx4 v[44:47], v5, s[4:7], s32 offen sc1
  s_lshr_b32 s33, s55, 2
  s_cmp_ge_u32 s33, 20
  s_cselect_b32 s34, 4, 0
  s_cselect_b32 s35, 20, 0
  s_sub_u32 s33, s33, s35
  s_and_b32 s35, s55, 3
  s_lshl_b32 s35, s35, 3
  s_add_u32 s34, s34, s35
  s_lshl_b32 s35, s30, 5
  s_add_u32 s34, s34, s35
  s_mul_i32 s34, s34, 1280
  s_lshl_b32 s33, s33, 6
  s_add_u32 s34, s34, s33
  s_waitcnt vmcnt(7)
  v_mfma_f32_16x16x32_bf16 v[48:51], v[12:15], v[16:19], 0
  s_waitcnt vmcnt(6)
  v_mfma_f32_16x16x32_bf16 v[48:51], v[12:15], v[20:23], v[48:51]
  s_waitcnt vmcnt(5)
  v_mfma_f32_16x16x32_bf16 v[48:51], v[12:15], v[24:27], v[48:51]
  s_waitcnt vmcnt(4)
  v_mfma_f32_16x16x32_bf16 v[48:51], v[12:15], v[28:31], v[48:51]
  s_waitcnt vmcnt(3)
  v_mfma_f32_16x16x32_bf16 v[48:51], v[12:15], v[32:35], v[48:51]
  s_waitcnt vmcnt(2)
  v_mfma_f32_16x16x32_bf16 v[48:51], v[12:15], v[36:39], v[48:51]
  s_waitcnt vmcnt(1)
  v_mfma_f32_16x16x32_bf16 v[48:51], v[12:15], v[40:43], v[48:51]
  s_waitcnt vmcnt(0)
  v_mfma_f32_16x16x32_bf16 v[48:51], v[12:15], v[44:47], v[48:51]
  s_nop 7
  v_cvt_pk_bf16_f32 v48, v48, v49
  v_cvt_pk_bf16_f32 v49, v50, v51
  s_mov_b64 exec, s[56:57]
  buffer_store_dwordx2 v[48:49], v6, s[12:15], s34 offen
  s_mov_b64 exec, -1
  s_add_u32 s55, s55, 128
  s_cmp_lt_u32 s55, 160
  s_cbranch_scc1 L_en_job
  s_lshl_b32 s32, s29, 2
  s_add_u32 s32, s32, s20
  s_cmp_lg_u32 s32, 127
  s_cbranch_scc1 L_en_nowb
  buffer_wbl2 sc1
L_en_nowb:
  s_xor_b32 s53, s53, 0x200000
  s_xor_b32 s54, s54, 0x200000
  s_add_u32 s30, s30, 6
  s_branch L_en_loop
L_fail:
  s_mov_b64 exec, 1
  v_mov_b32 v1, 44
  v_mov_b32 v2, 1000
  global_store_dword v1, v2, s[16:17]
L_end:
  s_waitcnt vmcnt(0) lgkmcnt(0)
  s_endpgm
.section .rodata,"a"
.p2align 6
.amdhsa_kernel standalone__memory_aug_recurrent_mem_tr__prompt_kernel
  .amdhsa_next_free_vgpr 512
  .amdhsa_next_free_sgpr 102
  .amdhsa_accum_offset 256
  .amdhsa_group_segment_fixed_size 0
  .amdhsa_kernarg_size 80
  .amdhsa_user_sgpr_count 2
  .amdhsa_user_sgpr_kernarg_segment_ptr 1
  .amdhsa_system_sgpr_workgroup_id_x 1
.end_amdhsa_kernel
```
